```python
import torch

def _softmax(x, axis=-1):
    return torch.softmax(x, dim=axis)

def _gelu(x):
    return torch.nn.functional.gelu(x, approximate='tanh')

def _silu(x):
    return torch.nn.functional.silu(x)

def _sigmoid(x):
    return torch.sigmoid(x)

def _layernorm(x, axis=-1, eps=1e-05):
    m = x.mean(dim=axis, keepdim=True)
    v = x.var(dim=axis, keepdim=True, unbiased=False)
    return (x - m) / torch.sqrt(v + eps)

def _scatter_add(tgt, idx, src, axis=0):
    return tgt.clone().index_add_(axis, idx, src)

def _segment_sum(src, seg, n):
    out = torch.zeros((n,) + src.shape[1:], dtype=src.dtype)
    return out.index_add_(0, seg, src)

def _pad(x, pw):
    flat = tuple((v for pair in reversed(pw) for v in pair))
    return torch.nn.functional.pad(x, flat)
kernel_name = 'adaLN_cond__ssm_conv_s4d__mixer_channel_mlp__prompt'

def setup_inputs():

    _w = lambda a: (lambda t: t.to(torch.bfloat16) if t.is_floating_point() else t)(torch.as_tensor(a))

    def _A_setup():
        Bsz, L, D, N = (1, 2048, 576, 128)
        return {'u': _w((lambda *s: torch.randn(*s, dtype=torch.bfloat16) * 0.05)(Bsz, L, D)), 'log_A_real': _w((lambda *s: torch.randn(*s, dtype=torch.bfloat16) * 3.2)(D, N) * 0.5), 'A_imag': _w((lambda *s: torch.randn(*s, dtype=torch.bfloat16) * 0.05)(D, N) * 3.14), 'C_real': _w((lambda *s: torch.randn(*s, dtype=torch.bfloat16) * 0.2)(D, N) / N ** 0.5), 'C_imag': _w((lambda *s: torch.randn(*s, dtype=torch.bfloat16) * 0.2)(D, N) / N ** 0.5), 'log_dt': _w((lambda *s: torch.randn(*s, dtype=torch.bfloat16) * 0.05)(D) * 0.5 - 4.0), 'D_skip': _w((lambda *s: torch.randn(*s, dtype=torch.bfloat16) * 0.05)(D))}
    _A_in = _A_setup()

    def _B_setup():
        B, S, D, F = (1, 2048, 576, 4608)
        return {'x': _w((lambda *s: torch.randn(*s, dtype=torch.bfloat16) * 0.05)(B, S, D)), 'w1': _w((lambda *s: torch.randn(*s, dtype=torch.bfloat16) * 3.2)(D, F) * D ** (-0.5)), 'b1': _w((lambda *s: torch.randn(*s, dtype=torch.bfloat16) * 1.6)(F)), 'w2': _w((lambda *s: torch.randn(*s, dtype=torch.bfloat16) * 1.6)(F, D) * F ** (-0.5)), 'b2': _w((lambda *s: torch.randn(*s, dtype=torch.bfloat16) * 1.6)(D))}
    _B_in = _B_setup()
    return {'A_u': _A_in['u'], 'A_log_A_real': _A_in['log_A_real'], 'A_A_imag': _A_in['A_imag'], 'A_C_real': _A_in['C_real'], 'A_C_imag': _A_in['C_imag'], 'A_log_dt': _A_in['log_dt'], 'A_D_skip': _A_in['D_skip'], 'B_x': _B_in['x'], 'B_w1': _B_in['w1'], 'B_b1': _B_in['b1'], 'B_w2': _B_in['w2'], 'B_b2': _B_in['b2'], 'c': _w((lambda *s: torch.randn(*s, dtype=torch.bfloat16) * 0.2)(1, 576) * 8.0), 'w_mod': _w((lambda *s: torch.randn(*s, dtype=torch.bfloat16) * 0.2)(576, 6 * 576) * 576 ** (-0.5) * 8.0)}

def reference(A_u, A_log_A_real, A_A_imag, A_C_real, A_C_imag, A_log_dt, A_D_skip, B_x, B_w1, B_b1, B_w2, B_b2, c, w_mod):

    def _A_ref(u, log_A_real, A_imag, C_real, C_imag, log_dt, D_skip):
        L = u.shape[1]
        dt = torch.exp(log_dt)
        A = -torch.exp(log_A_real) + 1j * A_imag
        C = (C_real + 1j * C_imag) * dt[:, None]
        pos = (lambda x, dt: x.to(dt))(torch.arange(L), log_dt.dtype)
        P = torch.exp((A * dt[:, None])[:, :, None] * pos[None, None, :])
        K = 2.0 * torch.einsum('dn,dnl->dl', C, P).real
        L2 = 2 * L
        u_t = (lambda x, *d: x.permute(*d))(u, 0, 2, 1)
        Kf = (lambda x, *a, **k: torch.fft.rfft(x.float(), *a, **k))(K, L2)
        Uf = (lambda x, *a, **k: torch.fft.rfft(x.float(), *a, **k))(u_t, L2)
        y = (lambda x, *a, **k: torch.fft.irfft(x, *a, **k).to(torch.bfloat16))(Uf * Kf[None, :, :], L2)[:, :, :L]
        y = (lambda x, *d: x.permute(*d))(y, 0, 2, 1)
        return y + u * D_skip[None, None, :]

    def _B_ref(x, w1, b1, w2, b2):
        y = _layernorm(x, axis=-1)
        h = _gelu(torch.einsum('bsd,df->bsf', y, w1) + b1)
        return torch.einsum('bsf,fd->bsd', h, w2) + b2
    x = A_u
    mod = (_silu(c) @ w_mod).reshape(c.shape[0], 6, 1, -1)
    sa, ca, ga, sb, cb, gb = (mod[:, 0].clone(), mod[:, 1].clone(), mod[:, 2].clone(), mod[:, 3].clone(), mod[:, 4].clone(), mod[:, 5].clone())
    h = _layernorm(x, axis=-1) * (1 + ca) + sa
    x = x + ga * _A_ref(h, A_log_A_real, A_A_imag, A_C_real, A_C_imag, A_log_dt, A_D_skip)
    h = _layernorm(x, axis=-1) * (1 + cb) + sb
    x = x + gb * _B_ref(h, B_w1, B_b1, B_w2, B_b2)
    return x
```

```asm
; @launch kernel=k1_prep_kernel grid=(812,1,1) block=(256,1,1) lds=38912
; @launch kernel=k2_conv_kernel grid=(144,1,1) block=(512,1,1) lds=142656
; @launch kernel=k4_mlp_kernel grid=(256,1,1) block=(256,1,1) lds=149888
.amdgcn_target "amdgcn-amd-amdhsa--gfx950"
.text
.globl k1_prep_kernel
.p2align 8
.type k1_prep_kernel,@function
k1_prep_kernel:
    s_cmp_ge_u32 s2, 812
    s_cbranch_scc1 K1_END
    s_load_dwordx2 s[4:5], s[0:1], 128
    v_lshrrev_b32 v1, 6, v0
    v_and_b32 v2, 63, v0
    v_readfirstlane_b32 s20, v1
    s_cmp_lt_u32 s2, 788
    s_cbranch_scc1 K1_NOPF
    s_getpc_b64 s[30:31]
K1_PC:
    s_add_u32 s30, s30, k2_conv_kernel-K1_PC
    s_addc_u32 s31, s31, 0
    s_sub_u32 s16, s2, 788
    s_lshr_b32 s16, s16, 3
    s_lshl_b32 s16, s16, 12
    s_add_u32 s30, s30, s16
    s_addc_u32 s31, s31, 0
    v_lshlrev_b32 v3, 4, v0
    v_mov_b32 v5, s31
    v_add_co_u32 v4, vcc, s30, v3
    s_nop 1
    v_addc_co_u32 v5, vcc, 0, v5, vcc
    global_load_dwordx4 v[68:71], v[4:5], off
K1_NOPF:
    s_cmp_ge_u32 s2, 704
    s_cbranch_scc1 K1_MOD
    s_cmp_ge_u32 s2, 576
    s_cbranch_scc1 K1_LN
    s_load_dwordx8 s[36:43], s[0:1], 8
    s_load_dwordx2 s[44:45], s[0:1], 40
    s_mov_b32 s21, s2
    s_getpc_b64 s[30:31]
K1_PC2:
    s_add_u32 s30, s30, K1_TABLE-K1_PC2
    s_addc_u32 s31, s31, 0
    v_lshlrev_b32 v3, 4, v0
    v_mov_b32 v5, s31
    v_add_co_u32 v4, vcc, s30, v3
    s_nop 1
    v_addc_co_u32 v5, vcc, 0, v5, vcc
    v_and_b32 v6, 31, v2
    s_lshl_b32 s16, s20, 5
    v_add_u32 v7, s16, v6
    v_lshlrev_b32 v7, 1, v7
    s_lshl_b32 s16, s21, 8
    s_waitcnt lgkmcnt(0)
    s_mov_b32 s8, s4
    s_and_b32 s9, s5, 0xffff
    s_mov_b32 s10, 0x29ba000
    s_mov_b32 s11, 0x20000
    s_mov_b32 s48, s36
    s_and_b32 s49, s37, 0xffff
    s_mov_b32 s50, 0x24000
    s_mov_b32 s51, 0x20000
    buffer_load_ushort v8, v7, s[48:51], s16 offen
    s_mov_b32 s52, s38
    s_and_b32 s53, s39, 0xffff
    s_mov_b32 s54, 0x24000
    s_mov_b32 s55, 0x20000
    buffer_load_ushort v9, v7, s[52:55], s16 offen
    s_mov_b32 s56, s40
    s_and_b32 s57, s41, 0xffff
    s_mov_b32 s58, 0x24000
    s_mov_b32 s59, 0x20000
    buffer_load_ushort v10, v7, s[56:59], s16 offen
    s_mov_b32 s60, s42
    s_and_b32 s61, s43, 0xffff
    s_mov_b32 s62, 0x24000
    s_mov_b32 s63, 0x20000
    buffer_load_ushort v11, v7, s[60:63], s16 offen
    s_mov_b32 s64, s44
    s_and_b32 s65, s45, 0xffff
    s_mov_b32 s66, 0x480
    s_mov_b32 s67, 0x20000
    s_lshl_b32 s17, s21, 1
    v_mov_b32 v12, 0
    buffer_load_ushort v12, v12, s[64:67], s17 offen
    global_load_dwordx4 v[64:67], v[4:5], off
    v_lshrrev_b32 v13, 5, v2
    v_cmp_eq_u32 vcc, 0, v13
    v_mov_b32 v16, 0x43800000
    v_mov_b32 v14, 0x00000000
    v_cndmask_b32 v16, v16, v14, vcc
    v_mov_b32 v17, 0x44000000
    v_mov_b32 v14, 0x00000000
    v_cndmask_b32 v17, v17, v14, vcc
    v_mov_b32 v18, 0x40800000
    v_mov_b32 v14, 0x3f800000
    v_cndmask_b32 v18, v18, v14, vcc
    v_mov_b32 v19, 0x41000000
    v_mov_b32 v14, 0x3f800000
    v_cndmask_b32 v19, v19, v14, vcc
    v_mov_b32 v20, 0x43fa0000
    v_mov_b32 v14, 0x3f800000
    v_cndmask_b32 v20, v20, v14, vcc
    v_mov_b32 v21, 0x43fc0000
    v_mov_b32 v14, 0x3f800000
    v_cndmask_b32 v21, v21, v14, vcc
    v_mul_u32_u24 v15, 2304, v13
    v_lshlrev_b32 v14, 2, v6
    v_add_u32 v15, v15, v14
    s_mul_i32 s16, s20, 9216
    v_add_u32 v15, s16, v15
    s_waitcnt vmcnt(1)
    v_lshlrev_b32 v12, 16, v12
    v_mul_f32 v12, 0x3fb8aa3b, v12
    v_exp_f32 v12, v12
    s_nop 0
    v_cvt_pk_bf16_f32 v12, v12, v12
    v_lshlrev_b32 v12, 16, v12
    v_lshlrev_b32 v8, 16, v8
    v_lshlrev_b32 v9, 16, v9
    v_lshlrev_b32 v10, 16, v10
    v_lshlrev_b32 v11, 16, v11
    v_mul_f32 v8, 0x3fb8aa3b, v8
    v_exp_f32 v8, v8
    s_nop 0
    v_cvt_pk_bf16_f32 v8, v8, v8
    v_lshlrev_b32 v8, 16, v8
    v_mul_f32 v8, v8, v12
    v_mul_f32 v8, 0xbfb8aa3b, v8
    v_mul_f32 v9, v9, v12
    v_mul_f32 v9, 0x3e22f983, v9
    v_mul_f32 v10, v10, v12
    v_mul_f32 v10, 2.0, v10
    v_mul_f32 v11, v11, v12
    v_mul_f32 v11, 2.0, v11
    v_mul_f32 v60, v16, v8
    v_mul_f32 v23, v16, v9
    v_exp_f32 v60, v60
    v_fract_f32 v23, v23
    v_cos_f32 v22, v23
    v_sin_f32 v23, v23
    v_mul_f32 v22, v60, v22
    v_mul_f32 v23, v60, v23
    v_mul_f32 v60, v17, v8
    v_mul_f32 v25, v17, v9
    v_exp_f32 v60, v60
    v_fract_f32 v25, v25
    v_cos_f32 v24, v25
    v_sin_f32 v25, v25
    v_mul_f32 v24, v60, v24
    v_mul_f32 v25, v60, v25
    v_mul_f32 v60, 0x41800000, v8
    v_mul_f32 v27, 0x41800000, v9
    v_exp_f32 v60, v60
    v_fract_f32 v27, v27
    v_cos_f32 v26, v27
    v_sin_f32 v27, v27
    v_mul_f32 v26, v60, v26
    v_mul_f32 v27, v60, v27
    v_mul_f32 v60, v18, v8
    v_mul_f32 v29, v18, v9
    v_exp_f32 v60, v60
    v_fract_f32 v29, v29
    v_cos_f32 v28, v29
    v_sin_f32 v29, v29
    v_mul_f32 v28, v60, v28
    v_mul_f32 v29, v60, v29
    v_mul_f32 v60, v19, v8
    v_mul_f32 v31, v19, v9
    v_exp_f32 v60, v60
    v_fract_f32 v31, v31
    v_cos_f32 v30, v31
    v_sin_f32 v31, v31
    v_mul_f32 v30, v60, v30
    v_mul_f32 v31, v60, v31
    v_mul_f32 v60, v20, v8
    v_mul_f32 v33, v20, v9
    v_exp_f32 v60, v60
    v_fract_f32 v33, v33
    v_cos_f32 v32, v33
    v_sin_f32 v33, v33
    v_mul_f32 v32, v60, v32
    v_mul_f32 v33, v60, v33
    v_mul_f32 v60, v21, v8
    v_mul_f32 v35, v21, v9
    v_exp_f32 v60, v60
    v_fract_f32 v35, v35
    v_cos_f32 v34, v35
    v_sin_f32 v35, v35
    v_mul_f32 v34, v60, v34
    v_mul_f32 v35, v60, v35
    v_mul_f32 v36, v10, v22
    v_mul_f32 v37, v10, v23
    v_fma_f32 v38, -v11, v23, v36
    v_fma_f32 v23, v11, v22, v37
    v_mov_b32 v22, v38
    v_cvt_pk_bf16_f32 v36, v22, v23
    v_cvt_pk_bf16_f32 v37, v24, -v25
    ds_write_b32 v15, v36 offset:0
    ds_write_b32 v15, v37 offset:4608
    v_mul_f32 v42, v23, v27
    v_mul_f32 v43, v23, v26
    v_mul_f32 v44, v25, v29
    v_mul_f32 v45, v25, v28
    v_fma_f32 v43, v22, v27, v43
    v_fma_f32 v45, v24, v29, v45
    v_fma_f32 v42, v22, v26, -v42
    v_fma_f32 v44, v24, v28, -v44
    v_cvt_pk_bf16_f32 v36, v42, v43
    v_cvt_pk_bf16_f32 v37, v44, -v45
    ds_write_b32 v15, v36 offset:144
    ds_write_b32 v15, v37 offset:4752
    v_mul_f32 v22, v43, v27
    v_mul_f32 v23, v43, v26
    v_mul_f32 v24, v45, v29
    v_mul_f32 v25, v45, v28
    v_fma_f32 v23, v42, v27, v23
    v_fma_f32 v25, v44, v29, v25
    v_fma_f32 v22, v42, v26, -v22
    v_fma_f32 v24, v44, v28, -v24
    v_cvt_pk_bf16_f32 v36, v22, v23
    v_cvt_pk_bf16_f32 v37, v24, -v25
    ds_write_b32 v15, v36 offset:288
    ds_write_b32 v15, v37 offset:4896
    v_mul_f32 v42, v23, v27
    v_mul_f32 v43, v23, v26
    v_mul_f32 v44, v25, v29
    v_mul_f32 v45, v25, v28
    v_fma_f32 v43, v22, v27, v43
    v_fma_f32 v45, v24, v29, v45
    v_fma_f32 v42, v22, v26, -v42
    v_fma_f32 v44, v24, v28, -v44
    v_cvt_pk_bf16_f32 v36, v42, v43
    v_cvt_pk_bf16_f32 v37, v44, -v45
    ds_write_b32 v15, v36 offset:432
    ds_write_b32 v15, v37 offset:5040
    v_mul_f32 v22, v43, v27
    v_mul_f32 v23, v43, v26
    v_mul_f32 v24, v45, v33
    v_mul_f32 v25, v45, v32
    v_fma_f32 v23, v42, v27, v23
    v_fma_f32 v25, v44, v33, v25
    v_fma_f32 v22, v42, v26, -v22
    v_fma_f32 v24, v44, v32, -v24
    v_cvt_pk_bf16_f32 v36, v22, v23
    v_cvt_pk_bf16_f32 v37, v24, -v25
    ds_write_b32 v15, v36 offset:576
    ds_write_b32 v15, v37 offset:5184
    v_mul_f32 v42, v23, v27
    v_mul_f32 v43, v23, v26
    v_mul_f32 v44, v25, v31
    v_mul_f32 v45, v25, v30
    v_fma_f32 v43, v22, v27, v43
    v_fma_f32 v45, v24, v31, v45
    v_fma_f32 v42, v22, v26, -v42
    v_fma_f32 v44, v24, v30, -v44
    v_cvt_pk_bf16_f32 v36, v42, v43
    v_cvt_pk_bf16_f32 v37, v44, -v45
    ds_write_b32 v15, v36 offset:720
    ds_write_b32 v15, v37 offset:5328
    v_mul_f32 v22, v43, v27
    v_mul_f32 v23, v43, v26
    v_mul_f32 v24, v45, v35
    v_mul_f32 v25, v45, v34
    v_fma_f32 v23, v42, v27, v23
    v_fma_f32 v25, v44, v35, v25
    v_fma_f32 v22, v42, v26, -v22
    v_fma_f32 v24, v44, v34, -v24
    v_cvt_pk_bf16_f32 v36, v22, v23
    v_cvt_pk_bf16_f32 v37, v24, -v25
    ds_write_b32 v15, v36 offset:864
    ds_write_b32 v15, v37 offset:5472
    v_mul_f32 v42, v23, v27
    v_mul_f32 v43, v23, v26
    v_mul_f32 v44, v25, v31
    v_mul_f32 v45, v25, v30
    v_fma_f32 v43, v22, v27, v43
    v_fma_f32 v45, v24, v31, v45
    v_fma_f32 v42, v22, v26, -v42
    v_fma_f32 v44, v24, v30, -v44
    v_cvt_pk_bf16_f32 v36, v42, v43
    v_cvt_pk_bf16_f32 v37, v44, -v45
    ds_write_b32 v15, v36 offset:1008
    ds_write_b32 v15, v37 offset:5616
    v_mul_f32 v22, v43, v27
    v_mul_f32 v23, v43, v26
    v_mul_f32 v24, v45, v31
    v_mul_f32 v25, v45, v30
    v_fma_f32 v23, v42, v27, v23
    v_fma_f32 v25, v44, v31, v25
    v_fma_f32 v22, v42, v26, -v22
    v_fma_f32 v24, v44, v30, -v24
    v_cvt_pk_bf16_f32 v36, v22, v23
    v_cvt_pk_bf16_f32 v37, v24, -v25
    ds_write_b32 v15, v36 offset:1152
    ds_write_b32 v15, v37 offset:5760
    v_mul_f32 v42, v23, v27
    v_mul_f32 v43, v23, v26
    v_mul_f32 v44, v25, v31
    v_mul_f32 v45, v25, v30
    v_fma_f32 v43, v22, v27, v43
    v_fma_f32 v45, v24, v31, v45
    v_fma_f32 v42, v22, v26, -v42
    v_fma_f32 v44, v24, v30, -v44
    v_cvt_pk_bf16_f32 v36, v42, v43
    v_cvt_pk_bf16_f32 v37, v44, -v45
    ds_write_b32 v15, v36 offset:1296
    ds_write_b32 v15, v37 offset:5904
    v_mul_f32 v22, v43, v27
    v_mul_f32 v23, v43, v26
    v_mul_f32 v24, v45, v31
    v_mul_f32 v25, v45, v30
    v_fma_f32 v23, v42, v27, v23
    v_fma_f32 v25, v44, v31, v25
    v_fma_f32 v22, v42, v26, -v22
    v_fma_f32 v24, v44, v30, -v24
    v_cvt_pk_bf16_f32 v36, v22, v23
    v_cvt_pk_bf16_f32 v37, v24, -v25
    ds_write_b32 v15, v36 offset:1440
    ds_write_b32 v15, v37 offset:6048
    v_mul_f32 v42, v23, v27
    v_mul_f32 v43, v23, v26
    v_mul_f32 v44, v25, v31
    v_mul_f32 v45, v25, v30
    v_fma_f32 v43, v22, v27, v43
    v_fma_f32 v45, v24, v31, v45
    v_fma_f32 v42, v22, v26, -v42
    v_fma_f32 v44, v24, v30, -v44
    v_cvt_pk_bf16_f32 v36, v42, v43
    v_cvt_pk_bf16_f32 v37, v44, -v45
    ds_write_b32 v15, v36 offset:1584
    ds_write_b32 v15, v37 offset:6192
    v_mul_f32 v22, v43, v27
    v_mul_f32 v23, v43, v26
    v_mul_f32 v24, v45, v31
    v_mul_f32 v25, v45, v30
    v_fma_f32 v23, v42, v27, v23
    v_fma_f32 v25, v44, v31, v25
    v_fma_f32 v22, v42, v26, -v22
    v_fma_f32 v24, v44, v30, -v24
    v_cvt_pk_bf16_f32 v36, v22, v23
    v_cvt_pk_bf16_f32 v37, v24, -v25
    ds_write_b32 v15, v36 offset:1728
    ds_write_b32 v15, v37 offset:6336
    v_mul_f32 v42, v23, v27
    v_mul_f32 v43, v23, v26
    v_mul_f32 v44, v25, v31
    v_mul_f32 v45, v25, v30
    v_fma_f32 v43, v22, v27, v43
    v_fma_f32 v45, v24, v31, v45
    v_fma_f32 v42, v22, v26, -v42
    v_fma_f32 v44, v24, v30, -v44
    v_cvt_pk_bf16_f32 v36, v42, v43
    v_cvt_pk_bf16_f32 v37, v44, -v45
    ds_write_b32 v15, v36 offset:1872
    ds_write_b32 v15, v37 offset:6480
    v_mul_f32 v22, v43, v27
    v_mul_f32 v23, v43, v26
    v_mul_f32 v24, v45, v31
    v_mul_f32 v25, v45, v30
    v_fma_f32 v23, v42, v27, v23
    v_fma_f32 v25, v44, v31, v25
    v_fma_f32 v22, v42, v26, -v22
    v_fma_f32 v24, v44, v30, -v24
    v_cvt_pk_bf16_f32 v36, v22, v23
    v_cvt_pk_bf16_f32 v37, v24, -v25
    ds_write_b32 v15, v36 offset:2016
    ds_write_b32 v15, v37 offset:6624
    v_mul_f32 v42, v23, v27
    v_mul_f32 v43, v23, v26
    v_mul_f32 v44, v25, v31
    v_mul_f32 v45, v25, v30
    v_fma_f32 v43, v22, v27, v43
    v_fma_f32 v45, v24, v31, v45
    v_fma_f32 v42, v22, v26, -v42
    v_fma_f32 v44, v24, v30, -v44
    v_cvt_pk_bf16_f32 v36, v42, v43
    v_cvt_pk_bf16_f32 v37, v44, -v45
    ds_write_b32 v15, v36 offset:2160
    ds_write_b32 v15, v37 offset:6768
    v_mul_u32_u24 v14, 144, v6
    v_lshlrev_b32 v13, 4, v13
    v_add_u32 v14, v14, v13
    s_mul_i32 s16, s20, 9216
    v_add_u32 v14, s16, v14
    s_waitcnt lgkmcnt(0)
    ds_read_b128 v[16:19], v14 offset:0
    ds_read_b128 v[20:23], v14 offset:4608
    ds_read_b128 v[24:27], v14 offset:32
    ds_read_b128 v[28:31], v14 offset:4640
    ds_read_b128 v[32:35], v14 offset:64
    ds_read_b128 v[36:39], v14 offset:4672
    ds_read_b128 v[40:43], v14 offset:96
    ds_read_b128 v[44:47], v14 offset:4704
    s_waitcnt lgkmcnt(6)
    v_mfma_f32_32x32x16_bf16 v[48:63], v[16:19], v[20:23], 0
    s_waitcnt lgkmcnt(4)
    v_mfma_f32_32x32x16_bf16 v[48:63], v[24:27], v[28:31], v[48:63]
    s_waitcnt lgkmcnt(2)
    v_mfma_f32_32x32x16_bf16 v[48:63], v[32:35], v[36:39], v[48:63]
    s_waitcnt lgkmcnt(0)
    v_mfma_f32_32x32x16_bf16 v[48:63], v[40:43], v[44:47], v[48:63]
    v_lshlrev_b32 v3, 4, v2
    s_mul_i32 s16, s20, 9216
    v_add_u32 v4, s16, v3
    s_nop 8
    ds_write_b128 v4, v[48:51] offset:0
    ds_write_b128 v4, v[52:55] offset:1024
    ds_write_b128 v4, v[56:59] offset:2048
    ds_write_b128 v4, v[60:63] offset:3072
    s_lshl_b32 s16, s20, 10
    v_add_u32 v4, s16, v3
    s_waitcnt lgkmcnt(0)
    s_barrier
    ds_read_b128 v[12:15], v4 offset:0
    ds_read_b128 v[16:19], v4 offset:9216
    ds_read_b128 v[20:23], v4 offset:18432
    ds_read_b128 v[24:27], v4 offset:27648
    v_and_b32 v5, 31, v2
    v_lshlrev_b32 v5, 6, v5
    v_lshrrev_b32 v6, 5, v2
    v_lshlrev_b32 v6, 3, v6
    v_add_u32 v5, v5, v6
    s_lshl_b32 s16, s20, 4
    v_add_u32 v5, s16, v5
    s_waitcnt lgkmcnt(0)
    v_add_f32 v12, v12, v16
    v_add_f32 v20, v20, v24
    v_add_f32 v13, v13, v17
    v_add_f32 v21, v21, v25
    v_add_f32 v14, v14, v18
    v_add_f32 v22, v22, v26
    v_add_f32 v15, v15, v19
    v_add_f32 v23, v23, v27
    v_add_f32 v12, v12, v20
    v_add_f32 v13, v13, v21
    v_add_f32 v14, v14, v22
    v_add_f32 v15, v15, v23
    v_cvt_pk_bf16_f32 v12, v12, v13
    v_cvt_pk_bf16_f32 v13, v14, v15
    ds_write_b64 v5, v[12:13] offset:36864
    s_waitcnt vmcnt(0)
    v_and_b32 v12, 0xffff, v64
    v_lshrrev_b32 v13, 16, v64
    v_and_b32 v14, 0xffff, v65
    v_lshrrev_b32 v15, 16, v65
    v_and_b32 v16, 0xffff, v66
    v_lshrrev_b32 v17, 16, v66
    v_and_b32 v18, 0xffff, v67
    v_lshrrev_b32 v19, 16, v67
    s_waitcnt lgkmcnt(0)
    s_barrier
    ds_read_u16 v24, v12 offset:36864
    ds_read_u16 v25, v13 offset:36864
    ds_read_u16 v26, v14 offset:36864
    ds_read_u16 v27, v15 offset:36864
    ds_read_u16 v28, v16 offset:36864
    ds_read_u16 v29, v17 offset:36864
    ds_read_u16 v30, v18 offset:36864
    ds_read_u16 v31, v19 offset:36864
    v_lshlrev_b32 v3, 4, v0
    s_lshl_b32 s16, s21, 12
    s_add_u32 s16, s16, 0x12000
    s_waitcnt lgkmcnt(0)
    v_lshl_or_b32 v20, v25, 16, v24
    v_lshl_or_b32 v21, v27, 16, v26
    v_lshl_or_b32 v22, v29, 16, v28
    v_lshl_or_b32 v23, v31, 16, v30
    buffer_store_dwordx4 v[20:23], v3, s[8:11], s16 offen sc1
    s_endpgm
K1_LN:
    s_load_dwordx2 s[6:7], s[0:1], 0
    s_sub_u32 s21, s2, 576
    v_lshrrev_b32 v3, 4, v0
    v_and_b32 v4, 15, v0
    s_lshl_b32 s16, s21, 4
    v_add_u32 v5, s16, v3
    v_mul_u32_u24 v5, 1152, v5
    v_lshlrev_b32 v6, 3, v4
    v_add_u32 v5, v5, v6
    v_mul_u32_u24 v7, 1184, v3
    v_add_u32 v7, v7, v6
    s_waitcnt lgkmcnt(0)
    s_mov_b32 s8, s4
    s_and_b32 s9, s5, 0xffff
    s_mov_b32 s10, 0x29ba000
    s_mov_b32 s11, 0x20000
    s_mov_b32 s12, s6
    s_and_b32 s13, s7, 0xffff
    s_mov_b32 s14, 0x240000
    s_mov_b32 s15, 0x20000
    buffer_load_dwordx2 v[8:9], v5, s[12:15], 0 offen offset:0
    buffer_load_dwordx2 v[10:11], v5, s[12:15], 0 offen offset:128
    buffer_load_dwordx2 v[12:13], v5, s[12:15], 0 offen offset:256
    buffer_load_dwordx2 v[14:15], v5, s[12:15], 0 offen offset:384
    buffer_load_dwordx2 v[16:17], v5, s[12:15], 0 offen offset:512
    buffer_load_dwordx2 v[18:19], v5, s[12:15], 0 offen offset:640
    buffer_load_dwordx2 v[20:21], v5, s[12:15], 0 offen offset:768
    buffer_load_dwordx2 v[22:23], v5, s[12:15], 0 offen offset:896
    buffer_load_dwordx2 v[24:25], v5, s[12:15], 0 offen offset:1024
    s_waitcnt vmcnt(8)
    v_lshlrev_b32 v26, 16, v8
    v_and_b32 v27, 0xffff0000, v8
    v_lshlrev_b32 v28, 16, v9
    v_and_b32 v29, 0xffff0000, v9
    s_waitcnt vmcnt(7)
    v_lshlrev_b32 v30, 16, v10
    v_and_b32 v31, 0xffff0000, v10
    v_lshlrev_b32 v32, 16, v11
    v_and_b32 v33, 0xffff0000, v11
    s_waitcnt vmcnt(6)
    v_lshlrev_b32 v34, 16, v12
    v_and_b32 v35, 0xffff0000, v12
    v_lshlrev_b32 v36, 16, v13
    v_and_b32 v37, 0xffff0000, v13
    s_waitcnt vmcnt(5)
    v_lshlrev_b32 v38, 16, v14
    v_and_b32 v39, 0xffff0000, v14
    v_lshlrev_b32 v40, 16, v15
    v_and_b32 v41, 0xffff0000, v15
    s_waitcnt vmcnt(4)
    v_lshlrev_b32 v42, 16, v16
    v_and_b32 v43, 0xffff0000, v16
    v_lshlrev_b32 v44, 16, v17
    v_and_b32 v45, 0xffff0000, v17
    s_waitcnt vmcnt(3)
    v_lshlrev_b32 v46, 16, v18
    v_and_b32 v47, 0xffff0000, v18
    v_lshlrev_b32 v48, 16, v19
    v_and_b32 v49, 0xffff0000, v19
    s_waitcnt vmcnt(2)
    v_lshlrev_b32 v50, 16, v20
    v_and_b32 v51, 0xffff0000, v20
    v_lshlrev_b32 v52, 16, v21
    v_and_b32 v53, 0xffff0000, v21
    s_waitcnt vmcnt(1)
    v_lshlrev_b32 v54, 16, v22
    v_and_b32 v55, 0xffff0000, v22
    v_lshlrev_b32 v56, 16, v23
    v_and_b32 v57, 0xffff0000, v23
    s_waitcnt vmcnt(0)
    v_lshlrev_b32 v58, 16, v24
    v_and_b32 v59, 0xffff0000, v24
    v_lshlrev_b32 v60, 16, v25
    v_and_b32 v61, 0xffff0000, v25
    v_add_f32 v62, v26, v27
    v_add_f32 v62, v62, v28
    v_add_f32 v62, v62, v29
    v_add_f32 v62, v62, v30
    v_add_f32 v62, v62, v31
    v_add_f32 v62, v62, v32
    v_add_f32 v62, v62, v33
    v_add_f32 v62, v62, v34
    v_add_f32 v62, v62, v35
    v_add_f32 v62, v62, v36
    v_add_f32 v62, v62, v37
    v_add_f32 v62, v62, v38
    v_add_f32 v62, v62, v39
    v_add_f32 v62, v62, v40
    v_add_f32 v62, v62, v41
    v_add_f32 v62, v62, v42
    v_add_f32 v62, v62, v43
    v_add_f32 v62, v62, v44
    v_add_f32 v62, v62, v45
    v_add_f32 v62, v62, v46
    v_add_f32 v62, v62, v47
    v_add_f32 v62, v62, v48
    v_add_f32 v62, v62, v49
    v_add_f32 v62, v62, v50
    v_add_f32 v62, v62, v51
    v_add_f32 v62, v62, v52
    v_add_f32 v62, v62, v53
    v_add_f32 v62, v62, v54
    v_add_f32 v62, v62, v55
    v_add_f32 v62, v62, v56
    v_add_f32 v62, v62, v57
    v_add_f32 v62, v62, v58
    v_add_f32 v62, v62, v59
    v_add_f32 v62, v62, v60
    v_add_f32 v62, v62, v61
    s_nop 1
    v_add_f32_dpp v62, v62, v62 quad_perm:[1,0,3,2] row_mask:0xf bank_mask:0xf
    s_nop 1
    v_add_f32_dpp v62, v62, v62 quad_perm:[2,3,0,1] row_mask:0xf bank_mask:0xf
    s_nop 1
    v_add_f32_dpp v62, v62, v62 row_half_mirror row_mask:0xf bank_mask:0xf
    s_nop 1
    v_add_f32_dpp v62, v62, v62 row_mirror row_mask:0xf bank_mask:0xf
    v_mul_f32 v62, 0x3ae38e39, v62
    v_sub_f32 v26, v26, v62
    v_sub_f32 v27, v27, v62
    v_sub_f32 v28, v28, v62
    v_sub_f32 v29, v29, v62
    v_sub_f32 v30, v30, v62
    v_sub_f32 v31, v31, v62
    v_sub_f32 v32, v32, v62
    v_sub_f32 v33, v33, v62
    v_sub_f32 v34, v34, v62
    v_sub_f32 v35, v35, v62
    v_sub_f32 v36, v36, v62
    v_sub_f32 v37, v37, v62
    v_sub_f32 v38, v38, v62
    v_sub_f32 v39, v39, v62
    v_sub_f32 v40, v40, v62
    v_sub_f32 v41, v41, v62
    v_sub_f32 v42, v42, v62
    v_sub_f32 v43, v43, v62
    v_sub_f32 v44, v44, v62
    v_sub_f32 v45, v45, v62
    v_sub_f32 v46, v46, v62
    v_sub_f32 v47, v47, v62
    v_sub_f32 v48, v48, v62
    v_sub_f32 v49, v49, v62
    v_sub_f32 v50, v50, v62
    v_sub_f32 v51, v51, v62
    v_sub_f32 v52, v52, v62
    v_sub_f32 v53, v53, v62
    v_sub_f32 v54, v54, v62
    v_sub_f32 v55, v55, v62
    v_sub_f32 v56, v56, v62
    v_sub_f32 v57, v57, v62
    v_sub_f32 v58, v58, v62
    v_sub_f32 v59, v59, v62
    v_sub_f32 v60, v60, v62
    v_sub_f32 v61, v61, v62
    v_mul_f32 v62, v26, v26
    v_fmac_f32 v62, v27, v27
    v_fmac_f32 v62, v28, v28
    v_fmac_f32 v62, v29, v29
    v_fmac_f32 v62, v30, v30
    v_fmac_f32 v62, v31, v31
    v_fmac_f32 v62, v32, v32
    v_fmac_f32 v62, v33, v33
    v_fmac_f32 v62, v34, v34
    v_fmac_f32 v62, v35, v35
    v_fmac_f32 v62, v36, v36
    v_fmac_f32 v62, v37, v37
    v_fmac_f32 v62, v38, v38
    v_fmac_f32 v62, v39, v39
    v_fmac_f32 v62, v40, v40
    v_fmac_f32 v62, v41, v41
    v_fmac_f32 v62, v42, v42
    v_fmac_f32 v62, v43, v43
    v_fmac_f32 v62, v44, v44
    v_fmac_f32 v62, v45, v45
    v_fmac_f32 v62, v46, v46
    v_fmac_f32 v62, v47, v47
    v_fmac_f32 v62, v48, v48
    v_fmac_f32 v62, v49, v49
    v_fmac_f32 v62, v50, v50
    v_fmac_f32 v62, v51, v51
    v_fmac_f32 v62, v52, v52
    v_fmac_f32 v62, v53, v53
    v_fmac_f32 v62, v54, v54
    v_fmac_f32 v62, v55, v55
    v_fmac_f32 v62, v56, v56
    v_fmac_f32 v62, v57, v57
    v_fmac_f32 v62, v58, v58
    v_fmac_f32 v62, v59, v59
    v_fmac_f32 v62, v60, v60
    v_fmac_f32 v62, v61, v61
    s_nop 1
    v_add_f32_dpp v62, v62, v62 quad_perm:[1,0,3,2] row_mask:0xf bank_mask:0xf
    s_nop 1
    v_add_f32_dpp v62, v62, v62 quad_perm:[2,3,0,1] row_mask:0xf bank_mask:0xf
    s_nop 1
    v_add_f32_dpp v62, v62, v62 row_half_mirror row_mask:0xf bank_mask:0xf
    s_nop 1
    v_add_f32_dpp v62, v62, v62 row_mirror row_mask:0xf bank_mask:0xf
    v_mul_f32 v62, 0x3ae38e39, v62
    v_add_f32 v62, 0x3727c5ac, v62
    v_rsq_f32 v62, v62
    ds_write_b64 v7, v[8:9] offset:18944
    ds_write_b64 v7, v[10:11] offset:19072
    ds_write_b64 v7, v[12:13] offset:19200
    ds_write_b64 v7, v[14:15] offset:19328
    ds_write_b64 v7, v[16:17] offset:19456
    ds_write_b64 v7, v[18:19] offset:19584
    ds_write_b64 v7, v[20:21] offset:19712
    ds_write_b64 v7, v[22:23] offset:19840
    ds_write_b64 v7, v[24:25] offset:19968
    v_mul_f32 v63, v62, v26
    v_mul_f32 v64, v62, v27
    v_cvt_pk_bf16_f32 v26, v63, v64
    v_mul_f32 v63, v62, v28
    v_mul_f32 v64, v62, v29
    v_cvt_pk_bf16_f32 v27, v63, v64
    ds_write_b64 v7, v[26:27] offset:0
    v_mul_f32 v63, v62, v30
    v_mul_f32 v64, v62, v31
    v_cvt_pk_bf16_f32 v28, v63, v64
    v_mul_f32 v63, v62, v32
    v_mul_f32 v64, v62, v33
    v_cvt_pk_bf16_f32 v29, v63, v64
    ds_write_b64 v7, v[28:29] offset:128
    v_mul_f32 v63, v62, v34
    v_mul_f32 v64, v62, v35
    v_cvt_pk_bf16_f32 v30, v63, v64
    v_mul_f32 v63, v62, v36
    v_mul_f32 v64, v62, v37
    v_cvt_pk_bf16_f32 v31, v63, v64
    ds_write_b64 v7, v[30:31] offset:256
    v_mul_f32 v63, v62, v38
    v_mul_f32 v64, v62, v39
    v_cvt_pk_bf16_f32 v32, v63, v64
    v_mul_f32 v63, v62, v40
    v_mul_f32 v64, v62, v41
    v_cvt_pk_bf16_f32 v33, v63, v64
    ds_write_b64 v7, v[32:33] offset:384
    s_waitcnt lgkmcnt(4)
    v_mul_f32 v63, v62, v42
    v_mul_f32 v64, v62, v43
    v_cvt_pk_bf16_f32 v34, v63, v64
    v_mul_f32 v63, v62, v44
    v_mul_f32 v64, v62, v45
    v_cvt_pk_bf16_f32 v35, v63, v64
    ds_write_b64 v7, v[34:35] offset:512
    v_mul_f32 v63, v62, v46
    v_mul_f32 v64, v62, v47
    v_cvt_pk_bf16_f32 v36, v63, v64
    v_mul_f32 v63, v62, v48
    v_mul_f32 v64, v62, v49
    v_cvt_pk_bf16_f32 v37, v63, v64
    ds_write_b64 v7, v[36:37] offset:640
    v_mul_f32 v63, v62, v50
    v_mul_f32 v64, v62, v51
    v_cvt_pk_bf16_f32 v38, v63, v64
    v_mul_f32 v63, v62, v52
    v_mul_f32 v64, v62, v53
    v_cvt_pk_bf16_f32 v39, v63, v64
    ds_write_b64 v7, v[38:39] offset:768
    v_mul_f32 v63, v62, v54
    v_mul_f32 v64, v62, v55
    v_cvt_pk_bf16_f32 v40, v63, v64
    v_mul_f32 v63, v62, v56
    v_mul_f32 v64, v62, v57
    v_cvt_pk_bf16_f32 v41, v63, v64
    ds_write_b64 v7, v[40:41] offset:896
    v_mul_f32 v63, v62, v58
    v_mul_f32 v64, v62, v59
    v_cvt_pk_bf16_f32 v42, v63, v64
    v_mul_f32 v63, v62, v60
    v_mul_f32 v64, v62, v61
    v_cvt_pk_bf16_f32 v43, v63, v64
    ds_write_b64 v7, v[42:43] offset:1024
    v_lshrrev_b32 v3, 4, v2
    v_lshlrev_b32 v3, 2, v3
    v_bfe_u32 v4, v2, 2, 2
    v_add_u32 v3, v3, v4
    v_mul_u32_u24 v3, 1184, v3
    v_and_b32 v4, 3, v2
    v_lshlrev_b32 v4, 3, v4
    v_add_u32 v3, v3, v4
    s_mul_i32 s16, s20, 288
    v_add_u32 v3, s16, v3
    v_and_b32 v4, 15, v2
    v_lshlrev_b32 v4, 5, v4
    v_lshrrev_b32 v5, 4, v2
    v_lshlrev_b32 v5, 3, v5
    v_add_u32 v4, v4, v5
    s_mul_i32 s16, s21, 18432
    s_mul_i32 s17, s20, 4608
    s_add_u32 s16, s16, s17
    s_add_u32 s16, s16, 0x252000
    s_waitcnt lgkmcnt(0)
    s_barrier
    s_add_u32 s18, s16, 0x240000
    ds_read_b64_tr_b16 v[8:9], v3 offset:0
    ds_read_b64_tr_b16 v[10:11], v3 offset:32
    ds_read_b64_tr_b16 v[12:13], v3 offset:64
    ds_read_b64_tr_b16 v[14:15], v3 offset:96
    ds_read_b64_tr_b16 v[16:17], v3 offset:128
    ds_read_b64_tr_b16 v[18:19], v3 offset:160
    ds_read_b64_tr_b16 v[20:21], v3 offset:192
    ds_read_b64_tr_b16 v[22:23], v3 offset:224
    ds_read_b64_tr_b16 v[24:25], v3 offset:256
    s_waitcnt lgkmcnt(8)
    buffer_store_dwordx2 v[8:9], v4, s[8:11], s16 offen offset:0 sc1
    s_waitcnt lgkmcnt(7)
    buffer_store_dwordx2 v[10:11], v4, s[8:11], s16 offen offset:512 sc1
    s_waitcnt lgkmcnt(6)
    buffer_store_dwordx2 v[12:13], v4, s[8:11], s16 offen offset:1024 sc1
    s_waitcnt lgkmcnt(5)
    buffer_store_dwordx2 v[14:15], v4, s[8:11], s16 offen offset:1536 sc1
    s_waitcnt lgkmcnt(4)
    buffer_store_dwordx2 v[16:17], v4, s[8:11], s16 offen offset:2048 sc1
    s_waitcnt lgkmcnt(3)
    buffer_store_dwordx2 v[18:19], v4, s[8:11], s16 offen offset:2560 sc1
    s_waitcnt lgkmcnt(2)
    buffer_store_dwordx2 v[20:21], v4, s[8:11], s16 offen offset:3072 sc1
    s_waitcnt lgkmcnt(1)
    buffer_store_dwordx2 v[22:23], v4, s[8:11], s16 offen offset:3584 sc1
    s_waitcnt lgkmcnt(0)
    s_add_u32 s16, s16, 4096
    buffer_store_dwordx2 v[24:25], v4, s[8:11], s16 offen offset:0 sc1
    ds_read_b64_tr_b16 v[26:27], v3 offset:18944
    ds_read_b64_tr_b16 v[28:29], v3 offset:18976
    ds_read_b64_tr_b16 v[30:31], v3 offset:19008
    ds_read_b64_tr_b16 v[32:33], v3 offset:19040
    ds_read_b64_tr_b16 v[34:35], v3 offset:19072
    ds_read_b64_tr_b16 v[36:37], v3 offset:19104
    ds_read_b64_tr_b16 v[38:39], v3 offset:19136
    ds_read_b64_tr_b16 v[40:41], v3 offset:19168
    ds_read_b64_tr_b16 v[42:43], v3 offset:19200
    s_waitcnt lgkmcnt(8)
    buffer_store_dwordx2 v[26:27], v4, s[8:11], s18 offen offset:0 sc1
    s_waitcnt lgkmcnt(7)
    buffer_store_dwordx2 v[28:29], v4, s[8:11], s18 offen offset:512 sc1
    s_waitcnt lgkmcnt(6)
    buffer_store_dwordx2 v[30:31], v4, s[8:11], s18 offen offset:1024 sc1
    s_waitcnt lgkmcnt(5)
    buffer_store_dwordx2 v[32:33], v4, s[8:11], s18 offen offset:1536 sc1
    s_waitcnt lgkmcnt(4)
    buffer_store_dwordx2 v[34:35], v4, s[8:11], s18 offen offset:2048 sc1
    s_waitcnt lgkmcnt(3)
    buffer_store_dwordx2 v[36:37], v4, s[8:11], s18 offen offset:2560 sc1
    s_waitcnt lgkmcnt(2)
    buffer_store_dwordx2 v[38:39], v4, s[8:11], s18 offen offset:3072 sc1
    s_waitcnt lgkmcnt(1)
    buffer_store_dwordx2 v[40:41], v4, s[8:11], s18 offen offset:3584 sc1
    s_waitcnt lgkmcnt(0)
    s_add_u32 s18, s18, 4096
    buffer_store_dwordx2 v[42:43], v4, s[8:11], s18 offen offset:0 sc1
    s_endpgm
K1_MOD:
    s_load_dwordx2 s[6:7], s[0:1], 104
    s_load_dwordx2 s[18:19], s[0:1], 96
    s_sub_u32 s21, s2, 704
    s_mul_hi_u32 s22, s21, 0x097b425f
    s_mul_i32 s23, s22, 27
    s_sub_u32 s23, s21, s23
    v_lshrrev_b32 v3, 4, v0
    v_and_b32 v4, 15, v0
    s_mul_i32 s16, s22, 144
    v_add_u32 v5, s16, v3
    v_lshlrev_b32 v6, 1, v5
    v_mul_u32_u24 v5, 6912, v5
    v_lshlrev_b32 v7, 4, v4
    v_add_u32 v5, v5, v7
    s_lshl_b32 s16, s23, 8
    s_waitcnt lgkmcnt(0)
    s_mov_b32 s8, s4
    s_and_b32 s9, s5, 0xffff
    s_mov_b32 s10, 0x29ba000
    s_mov_b32 s11, 0x20000
    s_mov_b32 s12, s6
    s_and_b32 s13, s7, 0xffff
    s_mov_b32 s14, 0x3cc000
    s_mov_b32 s15, 0x20000
    s_mov_b32 s24, s18
    s_and_b32 s25, s19, 0xffff
    s_mov_b32 s26, 0x480
    s_mov_b32 s27, 0x20000
    buffer_load_ushort v8, v6, s[24:27], 0 offen offset:0
    buffer_load_ushort v9, v6, s[24:27], 0 offen offset:32
    buffer_load_ushort v10, v6, s[24:27], 0 offen offset:64
    buffer_load_ushort v11, v6, s[24:27], 0 offen offset:96
    buffer_load_ushort v12, v6, s[24:27], 0 offen offset:128
    buffer_load_ushort v13, v6, s[24:27], 0 offen offset:160
    buffer_load_ushort v14, v6, s[24:27], 0 offen offset:192
    buffer_load_ushort v15, v6, s[24:27], 0 offen offset:224
    buffer_load_ushort v16, v6, s[24:27], 0 offen offset:256
    buffer_load_dwordx4 v[20:23], v5, s[12:15], s16 offen
    s_add_u32 s16, s16, 110592
    buffer_load_dwordx4 v[24:27], v5, s[12:15], s16 offen
    s_add_u32 s16, s16, 110592
    buffer_load_dwordx4 v[28:31], v5, s[12:15], s16 offen
    s_add_u32 s16, s16, 110592
    buffer_load_dwordx4 v[32:35], v5, s[12:15], s16 offen
    s_add_u32 s16, s16, 110592
    buffer_load_dwordx4 v[36:39], v5, s[12:15], s16 offen
    s_add_u32 s16, s16, 110592
    buffer_load_dwordx4 v[40:43], v5, s[12:15], s16 offen
    s_add_u32 s16, s16, 110592
    buffer_load_dwordx4 v[44:47], v5, s[12:15], s16 offen
    s_add_u32 s16, s16, 110592
    buffer_load_dwordx4 v[48:51], v5, s[12:15], s16 offen
    s_add_u32 s16, s16, 110592
    buffer_load_dwordx4 v[52:55], v5, s[12:15], s16 offen
    s_add_u32 s16, s16, 110592
    s_waitcnt vmcnt(9)
    v_lshlrev_b32 v8, 16, v8
    v_mul_f32 v18, 0xbfb8aa3b, v8
    v_exp_f32 v18, v18
    s_nop 0
    v_add_f32 v18, 1.0, v18
    v_rcp_f32 v18, v18
    s_nop 0
    v_mul_f32 v18, v8, v18
    v_cvt_pk_bf16_f32 v18, v18, v18
    v_lshlrev_b32 v8, 16, v18
    v_lshlrev_b32 v9, 16, v9
    v_mul_f32 v18, 0xbfb8aa3b, v9
    v_exp_f32 v18, v18
    s_nop 0
    v_add_f32 v18, 1.0, v18
    v_rcp_f32 v18, v18
    s_nop 0
    v_mul_f32 v18, v9, v18
    v_cvt_pk_bf16_f32 v18, v18, v18
    v_lshlrev_b32 v9, 16, v18
    v_lshlrev_b32 v10, 16, v10
    v_mul_f32 v18, 0xbfb8aa3b, v10
    v_exp_f32 v18, v18
    s_nop 0
    v_add_f32 v18, 1.0, v18
    v_rcp_f32 v18, v18
    s_nop 0
    v_mul_f32 v18, v10, v18
    v_cvt_pk_bf16_f32 v18, v18, v18
    v_lshlrev_b32 v10, 16, v18
    v_lshlrev_b32 v11, 16, v11
    v_mul_f32 v18, 0xbfb8aa3b, v11
    v_exp_f32 v18, v18
    s_nop 0
    v_add_f32 v18, 1.0, v18
    v_rcp_f32 v18, v18
    s_nop 0
    v_mul_f32 v18, v11, v18
    v_cvt_pk_bf16_f32 v18, v18, v18
    v_lshlrev_b32 v11, 16, v18
    v_lshlrev_b32 v12, 16, v12
    v_mul_f32 v18, 0xbfb8aa3b, v12
    v_exp_f32 v18, v18
    s_nop 0
    v_add_f32 v18, 1.0, v18
    v_rcp_f32 v18, v18
    s_nop 0
    v_mul_f32 v18, v12, v18
    v_cvt_pk_bf16_f32 v18, v18, v18
    v_lshlrev_b32 v12, 16, v18
    v_lshlrev_b32 v13, 16, v13
    v_mul_f32 v18, 0xbfb8aa3b, v13
    v_exp_f32 v18, v18
    s_nop 0
    v_add_f32 v18, 1.0, v18
    v_rcp_f32 v18, v18
    s_nop 0
    v_mul_f32 v18, v13, v18
    v_cvt_pk_bf16_f32 v18, v18, v18
    v_lshlrev_b32 v13, 16, v18
    v_lshlrev_b32 v14, 16, v14
    v_mul_f32 v18, 0xbfb8aa3b, v14
    v_exp_f32 v18, v18
    s_nop 0
    v_add_f32 v18, 1.0, v18
    v_rcp_f32 v18, v18
    s_nop 0
    v_mul_f32 v18, v14, v18
    v_cvt_pk_bf16_f32 v18, v18, v18
    v_lshlrev_b32 v14, 16, v18
    v_lshlrev_b32 v15, 16, v15
    v_mul_f32 v18, 0xbfb8aa3b, v15
    v_exp_f32 v18, v18
    s_nop 0
    v_add_f32 v18, 1.0, v18
    v_rcp_f32 v18, v18
    s_nop 0
    v_mul_f32 v18, v15, v18
    v_cvt_pk_bf16_f32 v18, v18, v18
    v_lshlrev_b32 v15, 16, v18
    v_lshlrev_b32 v16, 16, v16
    v_mul_f32 v18, 0xbfb8aa3b, v16
    v_exp_f32 v18, v18
    s_nop 0
    v_add_f32 v18, 1.0, v18
    v_rcp_f32 v18, v18
    s_nop 0
    v_mul_f32 v18, v16, v18
    v_cvt_pk_bf16_f32 v18, v18, v18
    v_lshlrev_b32 v16, 16, v18
    s_waitcnt vmcnt(8)
    v_lshlrev_b32 v18, 16, v20
    v_and_b32 v19, 0xffff0000, v20
    v_mul_f32 v56, v8, v18
    v_mul_f32 v57, v8, v19
    v_lshlrev_b32 v18, 16, v21
    v_and_b32 v19, 0xffff0000, v21
    v_mul_f32 v58, v8, v18
    v_mul_f32 v59, v8, v19
    v_lshlrev_b32 v18, 16, v22
    v_and_b32 v19, 0xffff0000, v22
    v_mul_f32 v60, v8, v18
    v_mul_f32 v61, v8, v19
    v_lshlrev_b32 v18, 16, v23
    v_and_b32 v19, 0xffff0000, v23
    v_mul_f32 v62, v8, v18
    v_mul_f32 v63, v8, v19
    s_waitcnt vmcnt(7)
    v_lshlrev_b32 v18, 16, v24
    v_and_b32 v19, 0xffff0000, v24
    v_fmac_f32 v56, v9, v18
    v_fmac_f32 v57, v9, v19
    v_lshlrev_b32 v18, 16, v25
    v_and_b32 v19, 0xffff0000, v25
    v_fmac_f32 v58, v9, v18
    v_fmac_f32 v59, v9, v19
    v_lshlrev_b32 v18, 16, v26
    v_and_b32 v19, 0xffff0000, v26
    v_fmac_f32 v60, v9, v18
    v_fmac_f32 v61, v9, v19
    v_lshlrev_b32 v18, 16, v27
    v_and_b32 v19, 0xffff0000, v27
    v_fmac_f32 v62, v9, v18
    v_fmac_f32 v63, v9, v19
    s_waitcnt vmcnt(6)
    v_lshlrev_b32 v18, 16, v28
    v_and_b32 v19, 0xffff0000, v28
    v_fmac_f32 v56, v10, v18
    v_fmac_f32 v57, v10, v19
    v_lshlrev_b32 v18, 16, v29
    v_and_b32 v19, 0xffff0000, v29
    v_fmac_f32 v58, v10, v18
    v_fmac_f32 v59, v10, v19
    v_lshlrev_b32 v18, 16, v30
    v_and_b32 v19, 0xffff0000, v30
    v_fmac_f32 v60, v10, v18
    v_fmac_f32 v61, v10, v19
    v_lshlrev_b32 v18, 16, v31
    v_and_b32 v19, 0xffff0000, v31
    v_fmac_f32 v62, v10, v18
    v_fmac_f32 v63, v10, v19
    s_waitcnt vmcnt(5)
    v_lshlrev_b32 v18, 16, v32
    v_and_b32 v19, 0xffff0000, v32
    v_fmac_f32 v56, v11, v18
    v_fmac_f32 v57, v11, v19
    v_lshlrev_b32 v18, 16, v33
    v_and_b32 v19, 0xffff0000, v33
    v_fmac_f32 v58, v11, v18
    v_fmac_f32 v59, v11, v19
    v_lshlrev_b32 v18, 16, v34
    v_and_b32 v19, 0xffff0000, v34
    v_fmac_f32 v60, v11, v18
    v_fmac_f32 v61, v11, v19
    v_lshlrev_b32 v18, 16, v35
    v_and_b32 v19, 0xffff0000, v35
    v_fmac_f32 v62, v11, v18
    v_fmac_f32 v63, v11, v19
    s_waitcnt vmcnt(4)
    v_lshlrev_b32 v18, 16, v36
    v_and_b32 v19, 0xffff0000, v36
    v_fmac_f32 v56, v12, v18
    v_fmac_f32 v57, v12, v19
    v_lshlrev_b32 v18, 16, v37
    v_and_b32 v19, 0xffff0000, v37
    v_fmac_f32 v58, v12, v18
    v_fmac_f32 v59, v12, v19
    v_lshlrev_b32 v18, 16, v38
    v_and_b32 v19, 0xffff0000, v38
    v_fmac_f32 v60, v12, v18
    v_fmac_f32 v61, v12, v19
    v_lshlrev_b32 v18, 16, v39
    v_and_b32 v19, 0xffff0000, v39
    v_fmac_f32 v62, v12, v18
    v_fmac_f32 v63, v12, v19
    s_waitcnt vmcnt(3)
    v_lshlrev_b32 v18, 16, v40
    v_and_b32 v19, 0xffff0000, v40
    v_fmac_f32 v56, v13, v18
    v_fmac_f32 v57, v13, v19
    v_lshlrev_b32 v18, 16, v41
    v_and_b32 v19, 0xffff0000, v41
    v_fmac_f32 v58, v13, v18
    v_fmac_f32 v59, v13, v19
    v_lshlrev_b32 v18, 16, v42
    v_and_b32 v19, 0xffff0000, v42
    v_fmac_f32 v60, v13, v18
    v_fmac_f32 v61, v13, v19
    v_lshlrev_b32 v18, 16, v43
    v_and_b32 v19, 0xffff0000, v43
    v_fmac_f32 v62, v13, v18
    v_fmac_f32 v63, v13, v19
    s_waitcnt vmcnt(2)
    v_lshlrev_b32 v18, 16, v44
    v_and_b32 v19, 0xffff0000, v44
    v_fmac_f32 v56, v14, v18
    v_fmac_f32 v57, v14, v19
    v_lshlrev_b32 v18, 16, v45
    v_and_b32 v19, 0xffff0000, v45
    v_fmac_f32 v58, v14, v18
    v_fmac_f32 v59, v14, v19
    v_lshlrev_b32 v18, 16, v46
    v_and_b32 v19, 0xffff0000, v46
    v_fmac_f32 v60, v14, v18
    v_fmac_f32 v61, v14, v19
    v_lshlrev_b32 v18, 16, v47
    v_and_b32 v19, 0xffff0000, v47
    v_fmac_f32 v62, v14, v18
    v_fmac_f32 v63, v14, v19
    s_waitcnt vmcnt(1)
    v_lshlrev_b32 v18, 16, v48
    v_and_b32 v19, 0xffff0000, v48
    v_fmac_f32 v56, v15, v18
    v_fmac_f32 v57, v15, v19
    v_lshlrev_b32 v18, 16, v49
    v_and_b32 v19, 0xffff0000, v49
    v_fmac_f32 v58, v15, v18
    v_fmac_f32 v59, v15, v19
    v_lshlrev_b32 v18, 16, v50
    v_and_b32 v19, 0xffff0000, v50
    v_fmac_f32 v60, v15, v18
    v_fmac_f32 v61, v15, v19
    v_lshlrev_b32 v18, 16, v51
    v_and_b32 v19, 0xffff0000, v51
    v_fmac_f32 v62, v15, v18
    v_fmac_f32 v63, v15, v19
    s_waitcnt vmcnt(0)
    v_lshlrev_b32 v18, 16, v52
    v_and_b32 v19, 0xffff0000, v52
    v_fmac_f32 v56, v16, v18
    v_fmac_f32 v57, v16, v19
    v_lshlrev_b32 v18, 16, v53
    v_and_b32 v19, 0xffff0000, v53
    v_fmac_f32 v58, v16, v18
    v_fmac_f32 v59, v16, v19
    v_lshlrev_b32 v18, 16, v54
    v_and_b32 v19, 0xffff0000, v54
    v_fmac_f32 v60, v16, v18
    v_fmac_f32 v61, v16, v19
    v_lshlrev_b32 v18, 16, v55
    v_and_b32 v19, 0xffff0000, v55
    v_fmac_f32 v62, v16, v18
    v_fmac_f32 v63, v16, v19
    v_lshlrev_b32 v5, 9, v3
    v_lshlrev_b32 v6, 5, v4
    v_add_u32 v5, v5, v6
    ds_write_b128 v5, v[56:59]
    ds_write_b128 v5, v[60:63] offset:16
    s_waitcnt lgkmcnt(0)
    s_barrier
    v_cmp_gt_u32 vcc, 128, v0
    s_nop 3
    s_and_saveexec_b64 s[28:29], vcc
    s_cbranch_execz K1_END
    v_lshlrev_b32 v5, 2, v0
    ds_read_b32 v20, v5 offset:0
    ds_read_b32 v21, v5 offset:512
    ds_read_b32 v22, v5 offset:1024
    ds_read_b32 v23, v5 offset:1536
    ds_read_b32 v24, v5 offset:2048
    ds_read_b32 v25, v5 offset:2560
    ds_read_b32 v26, v5 offset:3072
    ds_read_b32 v27, v5 offset:3584
    ds_read_b32 v28, v5 offset:4096
    ds_read_b32 v29, v5 offset:4608
    ds_read_b32 v30, v5 offset:5120
    ds_read_b32 v31, v5 offset:5632
    s_waitcnt lgkmcnt(8)
    ds_read_b32 v32, v5 offset:6144
    ds_read_b32 v33, v5 offset:6656
    ds_read_b32 v34, v5 offset:7168
    ds_read_b32 v35, v5 offset:7680
    s_waitcnt lgkmcnt(0)
    v_add_f32 v20, v20, v21
    v_add_f32 v20, v20, v22
    v_add_f32 v20, v20, v23
    v_add_f32 v20, v20, v24
    v_add_f32 v20, v20, v25
    v_add_f32 v20, v20, v26
    v_add_f32 v20, v20, v27
    v_add_f32 v20, v20, v28
    v_add_f32 v20, v20, v29
    v_add_f32 v20, v20, v30
    v_add_f32 v20, v20, v31
    v_add_f32 v20, v20, v32
    v_add_f32 v20, v20, v33
    v_add_f32 v20, v20, v34
    v_add_f32 v20, v20, v35
    s_mul_i32 s16, s22, 13824
    s_lshl_b32 s17, s23, 9
    s_add_u32 s16, s16, s17
    s_add_u32 s16, s16, 0x0
    buffer_store_dword v20, v5, s[8:11], s16 offen sc1
K1_END:
    s_endpgm
.p2align 6
K1_TABLE:
.short 1598, 1598, 1598, 1598, 1534, 1534, 1534, 1534, 1534, 1534, 1534, 1470, 1470, 1470, 1470, 1470
.short 1470, 1470, 1470, 1470, 1532, 1532, 1532, 1532, 1532, 1532, 1532, 1468, 1468, 1468, 1468, 1468
.short 1468, 1468, 1468, 1468, 1530, 1530, 1530, 1530, 1530, 1530, 1530, 1466, 1466, 1466, 1466, 1466
.short 1466, 1466, 1466, 1466, 1528, 1528, 1528, 1528, 1528, 1528, 1528, 1464, 1464, 1464, 1464, 1464
.short 1464, 1464, 1464, 1464, 1526, 1526, 1526, 1526, 1526, 1526, 1526, 1462, 1462, 1462, 1462, 1462
.short 1462, 1462, 1462, 1462, 1524, 1524, 1524, 1524, 1524, 1524, 1524, 1460, 1460, 1460, 1460, 1460
.short 1460, 1460, 1460, 1460, 1522, 1522, 1522, 1522, 1522, 1522, 1522, 1458, 1458, 1458, 1458, 1458
.short 1458, 1458, 1458, 1458, 1520, 1520, 1520, 1520, 1520, 1520, 1520, 1456, 1456, 1456, 1456, 1456
.short 1456, 1456, 1456, 1456, 1518, 1518, 1518, 1518, 1518, 1518, 1518, 1454, 1454, 1454, 1454, 1454
.short 1454, 1454, 1454, 1454, 1516, 1516, 1516, 1516, 1516, 1516, 1516, 1452, 1452, 1452, 1452, 1452
.short 1452, 1452, 1452, 1452, 1514, 1514, 1514, 1514, 1514, 1514, 1514, 1450, 1450, 1450, 1450, 1450
.short 1450, 1450, 1450, 1450, 1512, 1512, 1512, 1512, 1512, 1512, 1512, 1448, 1448, 1448, 1448, 1448
.short 1448, 1448, 1448, 1448, 1510, 1510, 1510, 1510, 1510, 1510, 1510, 1446, 1446, 1446, 1446, 1446
.short 1446, 1446, 1446, 1446, 1508, 1508, 1508, 1508, 1508, 1508, 1508, 1444, 1444, 1444, 1444, 1444
.short 1444, 1444, 1444, 1444, 1506, 1506, 1506, 1506, 1506, 1506, 1506, 1442, 1442, 1442, 1442, 1442
.short 1442, 1442, 1442, 1442, 1504, 1504, 1504, 1504, 1504, 1504, 1504, 1440, 1440, 1440, 1440, 1440
.short 1440, 1440, 1440, 1440, 1502, 1502, 1502, 1502, 1502, 1502, 1502, 1438, 1438, 1438, 1438, 1438
.short 1438, 1438, 1438, 1438, 1500, 1500, 1500, 1500, 1500, 1500, 1500, 1436, 1436, 1436, 1436, 1436
.short 1436, 1436, 1436, 1436, 1498, 1498, 1498, 1498, 1498, 1498, 1498, 1434, 1434, 1434, 1434, 1434
.short 1434, 1434, 1434, 1434, 1496, 1496, 1496, 1496, 1496, 1496, 1496, 1432, 1432, 1432, 1432, 1432
.short 1432, 1432, 1432, 1432, 1494, 1494, 1494, 1494, 1494, 1494, 1494, 1430, 1430, 1430, 1430, 1430
.short 1430, 1430, 1430, 1430, 1492, 1492, 1492, 1492, 1492, 1492, 1492, 1428, 1428, 1428, 1428, 1428
.short 1428, 1428, 1428, 1428, 1490, 1490, 1490, 1490, 1490, 1490, 1490, 1426, 1426, 1426, 1426, 1426
.short 1426, 1426, 1426, 1426, 1488, 1488, 1488, 1488, 1488, 1488, 1488, 1424, 1424, 1424, 1424, 1424
.short 1424, 1424, 1424, 1424, 1486, 1486, 1486, 1486, 1486, 1486, 1486, 1422, 1422, 1422, 1422, 1422
.short 1422, 1422, 1422, 1422, 1484, 1484, 1484, 1484, 1484, 1484, 1484, 1420, 1420, 1420, 1420, 1420
.short 1420, 1420, 1420, 1420, 1482, 1482, 1482, 1482, 1482, 1482, 1482, 1418, 1418, 1418, 1418, 1418
.short 1418, 1418, 1418, 1418, 1480, 1480, 1480, 1480, 1480, 1480, 1480, 1416, 1416, 1416, 1416, 1416
.short 1416, 1416, 1416, 1416, 1478, 1478, 1478, 1478, 1478, 1478, 1478, 1414, 1414, 1414, 1414, 1414
.short 1414, 1414, 1414, 1414, 1476, 1476, 1476, 1476, 1476, 1476, 1476, 1412, 1412, 1412, 1412, 1412
.short 1412, 1412, 1412, 1412, 1474, 1474, 1474, 1474, 1474, 1474, 1474, 1410, 1410, 1410, 1410, 1410
.short 1410, 1410, 1410, 1410, 1472, 1472, 1472, 1472, 1472, 1472, 1472, 1408, 1408, 1408, 1408, 1408
.short 1408, 1408, 1408, 1408, 1406, 1406, 1406, 1406, 1406, 1406, 1406, 1342, 1342, 1342, 1342, 1342
.short 1342, 1342, 1342, 1342, 1404, 1404, 1404, 1404, 1404, 1404, 1404, 1340, 1340, 1340, 1340, 1340
.short 1340, 1340, 1340, 1340, 1402, 1402, 1402, 1402, 1402, 1402, 1402, 1338, 1338, 1338, 1338, 1338
.short 1338, 1338, 1338, 1338, 1400, 1400, 1400, 1400, 1400, 1400, 1400, 1336, 1336, 1336, 1336, 1336
.short 1336, 1336, 1336, 1336, 1398, 1398, 1398, 1398, 1398, 1398, 1398, 1334, 1334, 1334, 1334, 1334
.short 1334, 1334, 1334, 1334, 1396, 1396, 1396, 1396, 1396, 1396, 1396, 1332, 1332, 1332, 1332, 1332
.short 1332, 1332, 1332, 1332, 1394, 1394, 1394, 1394, 1394, 1394, 1394, 1330, 1330, 1330, 1330, 1330
.short 1330, 1330, 1330, 1330, 1392, 1392, 1392, 1392, 1392, 1392, 1392, 1328, 1328, 1328, 1328, 1328
.short 1328, 1328, 1328, 1328, 1390, 1390, 1390, 1390, 1390, 1390, 1390, 1326, 1326, 1326, 1326, 1326
.short 1326, 1326, 1326, 1326, 1388, 1388, 1388, 1388, 1388, 1388, 1388, 1324, 1324, 1324, 1324, 1324
.short 1324, 1324, 1324, 1324, 1386, 1386, 1386, 1386, 1386, 1386, 1386, 1322, 1322, 1322, 1322, 1322
.short 1322, 1322, 1322, 1322, 1384, 1384, 1384, 1384, 1384, 1384, 1384, 1320, 1320, 1320, 1320, 1320
.short 1320, 1320, 1320, 1320, 1382, 1382, 1382, 1382, 1382, 1382, 1382, 1318, 1318, 1318, 1318, 1318
.short 1318, 1318, 1318, 1318, 1380, 1380, 1380, 1380, 1380, 1380, 1380, 1316, 1316, 1316, 1316, 1316
.short 1316, 1316, 1316, 1316, 1378, 1378, 1378, 1378, 1378, 1378, 1378, 1314, 1314, 1314, 1314, 1314
.short 1314, 1314, 1314, 1314, 1376, 1376, 1376, 1376, 1376, 1376, 1376, 1312, 1312, 1312, 1312, 1312
.short 1312, 1312, 1312, 1312, 1374, 1374, 1374, 1374, 1374, 1374, 1374, 1310, 1310, 1310, 1310, 1310
.short 1310, 1310, 1310, 1310, 1372, 1372, 1372, 1372, 1372, 1372, 1372, 1308, 1308, 1308, 1308, 1308
.short 1308, 1308, 1308, 1308, 1370, 1370, 1370, 1370, 1370, 1370, 1370, 1306, 1306, 1306, 1306, 1306
.short 1306, 1306, 1306, 1306, 1368, 1368, 1368, 1368, 1368, 1368, 1368, 1304, 1304, 1304, 1304, 1304
.short 1304, 1304, 1304, 1304, 1366, 1366, 1366, 1366, 1366, 1366, 1366, 1302, 1302, 1302, 1302, 1302
.short 1302, 1302, 1302, 1302, 1364, 1364, 1364, 1364, 1364, 1364, 1364, 1300, 1300, 1300, 1300, 1300
.short 1300, 1300, 1300, 1300, 1362, 1362, 1362, 1362, 1362, 1362, 1362, 1298, 1298, 1298, 1298, 1298
.short 1298, 1298, 1298, 1298, 1360, 1360, 1360, 1360, 1360, 1360, 1360, 1296, 1296, 1296, 1296, 1296
.short 1296, 1296, 1296, 1296, 1358, 1358, 1358, 1358, 1358, 1358, 1358, 1294, 1294, 1294, 1294, 1294
.short 1294, 1294, 1294, 1294, 1356, 1356, 1356, 1356, 1356, 1356, 1356, 1292, 1292, 1292, 1292, 1292
.short 1292, 1292, 1292, 1292, 1354, 1354, 1354, 1354, 1354, 1354, 1354, 1290, 1290, 1290, 1290, 1290
.short 1290, 1290, 1290, 1290, 1352, 1352, 1352, 1352, 1352, 1352, 1352, 1288, 1288, 1288, 1288, 1288
.short 1288, 1288, 1288, 1288, 1350, 1350, 1350, 1350, 1350, 1350, 1350, 1286, 1286, 1286, 1286, 1286
.short 1286, 1286, 1286, 1286, 1348, 1348, 1348, 1348, 1348, 1348, 1348, 1284, 1284, 1284, 1284, 1284
.short 1284, 1284, 1284, 1284, 1346, 1346, 1346, 1346, 1346, 1346, 1346, 1282, 1282, 1282, 1282, 1282
.short 1282, 1282, 1282, 1282, 1344, 1344, 1344, 1344, 1344, 1344, 1344, 1280, 1280, 1280, 1280, 1280
.short 1280, 1280, 1278, 1278, 1278, 1214, 1214, 1214, 1214, 1214, 1150, 1150, 1150, 1086, 1086, 1086
.short 1086, 1086, 1276, 1276, 1276, 1212, 1212, 1212, 1212, 1212, 1148, 1148, 1148, 1084, 1084, 1084
.short 1084, 1084, 1274, 1274, 1274, 1210, 1210, 1210, 1210, 1210, 1146, 1146, 1146, 1082, 1082, 1082
.short 1082, 1082, 1272, 1272, 1272, 1208, 1208, 1208, 1208, 1208, 1144, 1144, 1144, 1080, 1080, 1080
.short 1080, 1080, 1270, 1270, 1270, 1206, 1206, 1206, 1206, 1206, 1142, 1142, 1142, 1078, 1078, 1078
.short 1078, 1078, 1268, 1268, 1268, 1204, 1204, 1204, 1204, 1204, 1140, 1140, 1140, 1076, 1076, 1076
.short 1076, 1076, 1266, 1266, 1266, 1202, 1202, 1202, 1202, 1202, 1138, 1138, 1138, 1074, 1074, 1074
.short 1074, 1074, 1264, 1264, 1264, 1200, 1200, 1200, 1200, 1200, 1136, 1136, 1136, 1072, 1072, 1072
.short 1072, 1072, 1262, 1262, 1262, 1198, 1198, 1198, 1198, 1198, 1134, 1134, 1134, 1070, 1070, 1070
.short 1070, 1070, 1260, 1260, 1260, 1196, 1196, 1196, 1196, 1196, 1132, 1132, 1132, 1068, 1068, 1068
.short 1068, 1068, 1258, 1258, 1258, 1194, 1194, 1194, 1194, 1194, 1130, 1130, 1130, 1066, 1066, 1066
.short 1066, 1066, 1256, 1256, 1256, 1192, 1192, 1192, 1192, 1192, 1128, 1128, 1128, 1064, 1064, 1064
.short 1064, 1064, 1254, 1254, 1254, 1190, 1190, 1190, 1190, 1190, 1126, 1126, 1126, 1062, 1062, 1062
.short 1062, 1062, 1252, 1252, 1252, 1188, 1188, 1188, 1188, 1188, 1124, 1124, 1124, 1060, 1060, 1060
.short 1060, 1060, 1250, 1250, 1250, 1186, 1186, 1186, 1186, 1186, 1122, 1122, 1122, 1058, 1058, 1058
.short 1058, 1058, 1248, 1248, 1248, 1184, 1184, 1184, 1184, 1184, 1120, 1120, 1120, 1056, 1056, 1056
.short 1056, 1056, 1246, 1246, 1246, 1182, 1182, 1182, 1182, 1182, 1118, 1118, 1118, 1054, 1054, 1054
.short 1054, 1054, 1244, 1244, 1244, 1180, 1180, 1180, 1180, 1180, 1116, 1116, 1116, 1052, 1052, 1052
.short 1052, 1052, 1242, 1242, 1242, 1178, 1178, 1178, 1178, 1178, 1114, 1114, 1114, 1050, 1050, 1050
.short 1050, 1050, 1240, 1240, 1240, 1176, 1176, 1176, 1176, 1176, 1112, 1112, 1112, 1048, 1048, 1048
.short 1048, 1048, 1238, 1238, 1238, 1174, 1174, 1174, 1174, 1174, 1110, 1110, 1110, 1046, 1046, 1046
.short 1046, 1046, 1236, 1236, 1236, 1172, 1172, 1172, 1172, 1172, 1108, 1108, 1108, 1044, 1044, 1044
.short 1044, 1044, 1234, 1234, 1234, 1170, 1170, 1170, 1170, 1170, 1106, 1106, 1106, 1042, 1042, 1042
.short 1042, 1042, 1232, 1232, 1232, 1168, 1168, 1168, 1168, 1168, 1104, 1104, 1104, 1040, 1040, 1040
.short 1040, 1040, 1230, 1230, 1230, 1166, 1166, 1166, 1166, 1166, 1102, 1102, 1102, 1038, 1038, 1038
.short 1038, 1038, 1228, 1228, 1228, 1164, 1164, 1164, 1164, 1164, 1100, 1100, 1100, 1036, 1036, 1036
.short 1036, 1036, 1226, 1226, 1226, 1162, 1162, 1162, 1162, 1162, 1098, 1098, 1098, 1034, 1034, 1034
.short 1034, 1034, 1224, 1224, 1224, 1160, 1160, 1160, 1160, 1160, 1096, 1096, 1096, 1032, 1032, 1032
.short 1032, 1032, 1222, 1222, 1222, 1158, 1158, 1158, 1158, 1158, 1094, 1094, 1094, 1030, 1030, 1030
.short 1030, 1030, 1220, 1220, 1220, 1156, 1156, 1156, 1156, 1156, 1092, 1092, 1092, 1028, 1028, 1028
.short 1028, 1028, 1218, 1218, 1218, 1154, 1154, 1154, 1154, 1154, 1090, 1090, 1090, 1026, 1026, 1026
.short 1026, 1026, 1216, 1216, 1216, 1152, 1152, 1152, 1152, 1152, 1088, 1088, 1088, 1024, 1024, 1024
.short 1024, 958, 830, 830, 830, 702, 574, 574, 574, 446, 318, 318, 318, 190, 62, 62
.short 62, 956, 828, 828, 828, 700, 572, 572, 572, 444, 316, 316, 316, 188, 60, 60
.short 60, 954, 826, 826, 826, 698, 570, 570, 570, 442, 314, 314, 314, 186, 58, 58
.short 58, 952, 824, 824, 824, 696, 568, 568, 568, 440, 312, 312, 312, 184, 56, 56
.short 56, 950, 822, 822, 822, 694, 566, 566, 566, 438, 310, 310, 310, 182, 54, 54
.short 54, 948, 820, 820, 820, 692, 564, 564, 564, 436, 308, 308, 308, 180, 52, 52
.short 52, 946, 818, 818, 818, 690, 562, 562, 562, 434, 306, 306, 306, 178, 50, 50
.short 50, 944, 816, 816, 816, 688, 560, 560, 560, 432, 304, 304, 304, 176, 48, 48
.short 48, 942, 814, 814, 814, 686, 558, 558, 558, 430, 302, 302, 302, 174, 46, 46
.short 46, 940, 812, 812, 812, 684, 556, 556, 556, 428, 300, 300, 300, 172, 44, 44
.short 44, 938, 810, 810, 810, 682, 554, 554, 554, 426, 298, 298, 298, 170, 42, 42
.short 42, 936, 808, 808, 808, 680, 552, 552, 552, 424, 296, 296, 296, 168, 40, 40
.short 40, 934, 806, 806, 806, 678, 550, 550, 550, 422, 294, 294, 294, 166, 38, 38
.short 38, 932, 804, 804, 804, 676, 548, 548, 548, 420, 292, 292, 292, 164, 36, 36
.short 36, 930, 802, 802, 802, 674, 546, 546, 546, 418, 290, 290, 290, 162, 34, 34
.short 34, 928, 800, 800, 800, 672, 544, 544, 544, 416, 288, 288, 288, 160, 32, 32
.short 990, 926, 862, 798, 734, 670, 606, 542, 478, 414, 350, 286, 222, 158, 94, 30
.short 988, 924, 860, 796, 732, 668, 604, 540, 476, 412, 348, 284, 220, 156, 92, 28
.short 986, 922, 858, 794, 730, 666, 602, 538, 474, 410, 346, 282, 218, 154, 90, 26
.short 984, 920, 856, 792, 728, 664, 600, 536, 472, 408, 344, 280, 216, 152, 88, 24
.short 982, 918, 854, 790, 726, 662, 598, 534, 470, 406, 342, 278, 214, 150, 86, 22
.short 980, 916, 852, 788, 724, 660, 596, 532, 468, 404, 340, 276, 212, 148, 84, 20
.short 978, 914, 850, 786, 722, 658, 594, 530, 466, 402, 338, 274, 210, 146, 82, 18
.short 976, 912, 848, 784, 720, 656, 592, 528, 464, 400, 336, 272, 208, 144, 80, 16
.short 974, 910, 846, 782, 718, 654, 590, 526, 462, 398, 334, 270, 206, 142, 78, 14
.short 972, 908, 844, 780, 716, 652, 588, 524, 460, 396, 332, 268, 204, 140, 76, 12
.short 970, 906, 842, 778, 714, 650, 586, 522, 458, 394, 330, 266, 202, 138, 74, 10
.short 968, 904, 840, 776, 712, 648, 584, 520, 456, 392, 328, 264, 200, 136, 72, 8
.short 966, 902, 838, 774, 710, 646, 582, 518, 454, 390, 326, 262, 198, 134, 70, 6
.short 964, 900, 836, 772, 708, 644, 580, 516, 452, 388, 324, 260, 196, 132, 68, 4
.short 962, 898, 834, 770, 706, 642, 578, 514, 450, 386, 322, 258, 194, 130, 66, 2
.short 960, 896, 832, 768, 704, 640, 576, 512, 448, 384, 320, 256, 192, 128, 64, 0
.globl k2_conv_kernel
.p2align 8
.type k2_conv_kernel,@function
k2_conv_kernel:
    s_cmp_ge_u32 s2, 144
    s_cbranch_scc1 K2_END
    s_load_dwordx2 s[4:5], s[0:1], 128
    v_lshrrev_b32 v1, 6, v0
    v_and_b32 v2, 63, v0
    v_readfirstlane_b32 s20, v1
    s_nop 3
    s_cmp_ge_u32 s20, 4
    s_cbranch_scc1 K2_REL
    s_load_dwordx2 s[6:7], s[0:1], 48
    s_lshl_b32 s21, s2, 2
    s_add_u32 s21, s21, s20
    s_mul_i32 s22, s20, 13120
    s_waitcnt lgkmcnt(0)
    s_mov_b32 s8, s4
    s_and_b32 s9, s5, 0xffff
    s_mov_b32 s10, 0x29ba000
    s_mov_b32 s11, 0x20000
    s_mov_b32 s12, s6
    s_and_b32 s13, s7, 0xffff
    s_mov_b32 s14, 0x480
    s_mov_b32 s15, 0x20000
    s_lshl_b32 s16, s21, 1
    v_mov_b32 v15, 0
    buffer_load_ushort v68, v15, s[12:15], s16 offen
    v_and_b32 v3, 3, v2
    v_mul_u32_u24 v3, 13824, v3
    v_lshrrev_b32 v4, 2, v2
    v_mul_u32_u24 v5, 2304, v4
    v_add_u32 v3, v3, v5
    s_lshl_b32 s16, s21, 2
    s_add_u32 s16, s16, 0x0
    buffer_load_dword v6, v3, s[8:11], s16 offen
    v_lshrrev_b32 v3, 3, v2
    v_mul_u32_u24 v3, 18432, v3
    v_and_b32 v5, 7, v2
    v_lshlrev_b32 v5, 4, v5
    v_add_u32 v3, v3, v5
    s_mul_i32 s16, s20, 589824
    s_lshl_b32 s17, s2, 7
    s_add_u32 s16, s16, s17
    s_add_u32 s17, s16, 0x492000
    s_add_u32 s16, s16, 0x252000
    s_add_u32 s27, s22, 4608
    s_lshl_b32 s28, s20, 12
    s_add_u32 s28, s28, 52480
    s_mov_b32 m0, s27
    s_nop 0
    buffer_load_dwordx4 v3, s[8:11], s16 offen lds
    s_add_u32 s16, s16, 147456
    s_add_u32 s27, s27, 1024
    s_mov_b32 m0, s27
    s_nop 0
    buffer_load_dwordx4 v3, s[8:11], s16 offen lds
    s_add_u32 s16, s16, 147456
    s_add_u32 s27, s27, 1024
    s_mov_b32 m0, s27
    s_nop 0
    buffer_load_dwordx4 v3, s[8:11], s16 offen lds
    s_add_u32 s16, s16, 147456
    s_add_u32 s27, s27, 1024
    s_mov_b32 m0, s27
    s_nop 0
    buffer_load_dwordx4 v3, s[8:11], s16 offen lds
    v_lshlrev_b32 v7, 4, v2
    s_lshl_b32 s16, s21, 12
    s_add_u32 s16, s16, 0x12000
    buffer_load_dwordx4 v[32:35], v7, s[8:11], s16 offen offset:0
    buffer_load_dwordx4 v[48:51], v7, s[8:11], s16 offen offset:4
    buffer_load_dwordx4 v[36:39], v7, s[8:11], s16 offen offset:1024
    buffer_load_dwordx4 v[52:55], v7, s[8:11], s16 offen offset:1028
    buffer_load_dwordx4 v[40:43], v7, s[8:11], s16 offen offset:2048
    buffer_load_dwordx4 v[56:59], v7, s[8:11], s16 offen offset:2052
    buffer_load_dwordx4 v[44:47], v7, s[8:11], s16 offen offset:3072
    buffer_load_dwordx4 v[60:63], v7, s[8:11], s16 offen offset:3076
    s_mov_b32 m0, s28
    s_nop 0
    buffer_load_dwordx4 v3, s[8:11], s17 offen lds
    s_add_u32 s17, s17, 147456
    s_add_u32 s28, s28, 1024
    s_mov_b32 m0, s28
    s_nop 0
    buffer_load_dwordx4 v3, s[8:11], s17 offen lds
    s_add_u32 s17, s17, 147456
    s_add_u32 s28, s28, 1024
    s_mov_b32 m0, s28
    s_nop 0
    buffer_load_dwordx4 v3, s[8:11], s17 offen lds
    s_add_u32 s17, s17, 147456
    s_add_u32 s28, s28, 1024
    s_mov_b32 m0, s28
    s_nop 0
    buffer_load_dwordx4 v3, s[8:11], s17 offen lds
    v_and_b32 v69, 15, v2
    v_lshrrev_b32 v70, 4, v2
    v_lshlrev_b32 v204, 5, v69
    v_lshlrev_b32 v71, 4, v70
    v_add_u32 v204, v204, v71
    s_add_u32 s29, s22, 480
    v_add_u32 v204, s29, v204
    v_lshlrev_b32 v209, 5, v69
    v_lshlrev_b32 v210, 3, v70
    v_add_u32 v209, v209, v210
    v_add_u32 v209, s22, v209
    v_sub_u32 v210, 2031, v69
    v_lshrrev_b32 v210, 1, v210
    v_lshlrev_b32 v210, 2, v210
    v_add_u32 v210, v210, v71
    v_and_b32 v211, 1, v69
    v_mul_u32_u24 v211, 4160, v211
    v_sub_u32 v211, 8768, v211
    v_add_u32 v210, v210, v211
    v_add_u32 v210, s22, v210
    v_subrev_u32 v205, 512, v210
    v_subrev_u32 v206, 1536, v210
    v_subrev_u32 v207, 2560, v210
    v_subrev_u32 v208, 3584, v210
    v_mov_b32 v212, 142592
    v_mov_b32 v214, 0
    v_mov_b32 v215, 0
    ds_write_b64 v212, v[214:215]
    ds_write_b64 v212, v[214:215] offset:8
    v_mov_b32 v64, 0
    v_mov_b32 v65, 0
    v_mov_b32 v66, 0
    v_mov_b32 v67, 0
    v_add_u32 v8, s22, v7
    s_mov_b32 exec_hi, 0
    ds_write_b128 v8, v[64:67] offset:0
    s_mov_b64 exec, -1
    s_waitcnt vmcnt(16)
    v_add_f32_dpp v6, v6, v6 quad_perm:[1,0,3,2] row_mask:0xf bank_mask:0xf
    s_nop 1
    v_add_f32_dpp v6, v6, v6 quad_perm:[2,3,0,1] row_mask:0xf bank_mask:0xf
    v_cvt_pk_bf16_f32 v6, v6, v6
    v_lshlrev_b32 v9, 16, v6
    v_add_f32 v10, 1.0, v9
    v_cvt_pk_bf16_f32 v10, v10, v10
    v_lshlrev_b32 v11, 16, v10
    v_readlane_b32 s24, v9, 0
    v_readlane_b32 s25, v11, 4
    v_readfirstlane_b32 s23, v68
    s_nop 3
    s_lshl_b32 s23, s23, 16
    v_readlane_b32 s26, v9, 8
    v_mul_u32_u24 v5, 1152, v4
    s_lshl_b32 s16, s21, 1
    s_add_u32 s16, s16, 0xe000
    s_mov_b64 exec, 0x111111
    buffer_store_short v6, v5, s[8:11], s16 offen
    s_mov_b64 exec, -1
    s_lshl_b32 s16, s2, 8
    s_add_u32 s16, s16, 0x29b2000
    v_lshlrev_b32 v12, 7, v2
    v_mov_b32 v15, 0
    s_cmp_lg_u32 s20, 0
    s_cbranch_scc1 K2_NOCLR
    s_cmp_ge_u32 s2, 128
    s_cbranch_scc1 K2_NOCLR
    s_mov_b64 exec, 3
    v_mov_b32 v14, 0
    buffer_store_dwordx2 v[14:15], v12, s[8:11], s16 offen sc1
    s_mov_b64 exec, -1
K2_NOCLR:
    v_mov_b32 v14, s24
    v_lshrrev_b32 v10, 1, v2
    v_lshlrev_b32 v10, 7, v10
    v_and_b32 v11, 1, v2
    v_lshlrev_b32 v11, 4, v11
    v_add_u32 v10, v10, v11
    s_lshl_b32 s16, s20, 5
    v_add_u32 v15, s16, v10
    s_waitcnt vmcnt(13)
    s_waitcnt lgkmcnt(0)
    s_barrier
    ds_read_b128 v[16:19], v15 offset:4608
    ds_read_b128 v[20:23], v15 offset:17728
    ds_read_b128 v[24:27], v15 offset:30848
    ds_read_b128 v[28:31], v15 offset:43968
    s_waitcnt lgkmcnt(3)
    v_lshlrev_b32 v10, 16, v16
    v_and_b32 v11, 0xffff0000, v16
    v_fma_f32 v10, v10, s25, v14
    v_fma_f32 v11, v11, s25, v14
    v_cvt_pk_bf16_f32 v16, v10, v11
    v_lshlrev_b32 v10, 16, v17
    v_and_b32 v11, 0xffff0000, v17
    v_fma_f32 v10, v10, s25, v14
    v_fma_f32 v11, v11, s25, v14
    v_cvt_pk_bf16_f32 v17, v10, v11
    v_lshlrev_b32 v10, 16, v18
    v_and_b32 v11, 0xffff0000, v18
    v_fma_f32 v10, v10, s25, v14
    v_fma_f32 v11, v11, s25, v14
    v_cvt_pk_bf16_f32 v18, v10, v11
    v_lshlrev_b32 v10, 16, v19
    v_and_b32 v11, 0xffff0000, v19
    v_fma_f32 v10, v10, s25, v14
    v_fma_f32 v11, v11, s25, v14
    v_cvt_pk_bf16_f32 v19, v10, v11
    ds_write_b128 v8, v[16:19] offset:512
    s_waitcnt lgkmcnt(3)
    v_lshlrev_b32 v10, 16, v20
    v_and_b32 v11, 0xffff0000, v20
    v_fma_f32 v10, v10, s25, v14
    v_fma_f32 v11, v11, s25, v14
    v_cvt_pk_bf16_f32 v20, v10, v11
    v_lshlrev_b32 v10, 16, v21
    v_and_b32 v11, 0xffff0000, v21
    v_fma_f32 v10, v10, s25, v14
    v_fma_f32 v11, v11, s25, v14
    v_cvt_pk_bf16_f32 v21, v10, v11
    v_lshlrev_b32 v10, 16, v22
    v_and_b32 v11, 0xffff0000, v22
    v_fma_f32 v10, v10, s25, v14
    v_fma_f32 v11, v11, s25, v14
    v_cvt_pk_bf16_f32 v22, v10, v11
    v_lshlrev_b32 v10, 16, v23
    v_and_b32 v11, 0xffff0000, v23
    v_fma_f32 v10, v10, s25, v14
    v_fma_f32 v11, v11, s25, v14
    v_cvt_pk_bf16_f32 v23, v10, v11
    ds_write_b128 v8, v[20:23] offset:1536
    s_waitcnt lgkmcnt(3)
    v_lshlrev_b32 v10, 16, v24
    v_and_b32 v11, 0xffff0000, v24
    v_fma_f32 v10, v10, s25, v14
    v_fma_f32 v11, v11, s25, v14
    v_cvt_pk_bf16_f32 v24, v10, v11
    v_lshlrev_b32 v10, 16, v25
    v_and_b32 v11, 0xffff0000, v25
    v_fma_f32 v10, v10, s25, v14
    v_fma_f32 v11, v11, s25, v14
    v_cvt_pk_bf16_f32 v25, v10, v11
    v_lshlrev_b32 v10, 16, v26
    v_and_b32 v11, 0xffff0000, v26
    v_fma_f32 v10, v10, s25, v14
    v_fma_f32 v11, v11, s25, v14
    v_cvt_pk_bf16_f32 v26, v10, v11
    v_lshlrev_b32 v10, 16, v27
    v_and_b32 v11, 0xffff0000, v27
    v_fma_f32 v10, v10, s25, v14
    v_fma_f32 v11, v11, s25, v14
    v_cvt_pk_bf16_f32 v27, v10, v11
    ds_write_b128 v8, v[24:27] offset:2560
    s_waitcnt lgkmcnt(3)
    v_lshlrev_b32 v10, 16, v28
    v_and_b32 v11, 0xffff0000, v28
    v_fma_f32 v10, v10, s25, v14
    v_fma_f32 v11, v11, s25, v14
    v_cvt_pk_bf16_f32 v28, v10, v11
    v_lshlrev_b32 v10, 16, v29
    v_and_b32 v11, 0xffff0000, v29
    v_fma_f32 v10, v10, s25, v14
    v_fma_f32 v11, v11, s25, v14
    v_cvt_pk_bf16_f32 v29, v10, v11
    v_lshlrev_b32 v10, 16, v30
    v_and_b32 v11, 0xffff0000, v30
    v_fma_f32 v10, v10, s25, v14
    v_fma_f32 v11, v11, s25, v14
    v_cvt_pk_bf16_f32 v30, v10, v11
    v_lshlrev_b32 v10, 16, v31
    v_and_b32 v11, 0xffff0000, v31
    v_fma_f32 v10, v10, s25, v14
    v_fma_f32 v11, v11, s25, v14
    v_cvt_pk_bf16_f32 v31, v10, v11
    ds_write_b128 v8, v[28:31] offset:3584
    s_waitcnt lgkmcnt(0)
    v_mov_b32 v213, 1
    s_mov_b64 exec, 1
    ds_add_u32 v212, v213 offset:0
    s_mov_b64 exec, -1
    s_mov_b32 s57, 1048576
K2_RV0:
    ds_read_b32 v213, v212 offset:0
    s_waitcnt lgkmcnt(0)
    v_cmp_gt_u32 vcc, 4, v213
    s_sub_u32 s57, s57, 1
    s_cmp_eq_u32 s57, 0
    s_cbranch_scc1 K2_RV0_X
    s_nop 0
    s_cbranch_vccnz K2_RV0
K2_RV0_X:
    s_mov_b64 exec, 3
    ds_write_b128 v8, v[64:67] offset:8704
    ds_write_b128 v8, v[64:67] offset:12864
    s_mov_b64 exec, -1
    s_waitcnt lgkmcnt(2)
    s_waitcnt vmcnt(5)
    v_cmp_eq_u32 vcc, 63, v2
    v_mov_b32 v10, -1
    v_mov_b32 v11, 0xffff
    v_cndmask_b32 v10, v10, v11, vcc
    ds_write_b128 v8, v[32:35] offset:4608
    v_alignbit_b32 v48, v48, v32, 16
    v_alignbit_b32 v49, v49, v33, 16
    v_alignbit_b32 v50, v50, v34, 16
    v_alignbit_b32 v51, v51, v35, 16
    ds_write_b128 v8, v[48:51] offset:8768
    ds_write_b128 v8, v[36:39] offset:5632
    v_alignbit_b32 v52, v52, v36, 16
    v_alignbit_b32 v53, v53, v37, 16
    v_alignbit_b32 v54, v54, v38, 16
    v_alignbit_b32 v55, v55, v39, 16
    ds_write_b128 v8, v[52:55] offset:9792
    ds_write_b128 v8, v[40:43] offset:6656
    v_alignbit_b32 v56, v56, v40, 16
    v_alignbit_b32 v57, v57, v41, 16
    v_alignbit_b32 v58, v58, v42, 16
    v_alignbit_b32 v59, v59, v43, 16
    ds_write_b128 v8, v[56:59] offset:10816
    ds_write_b128 v8, v[44:47] offset:7680
    v_alignbit_b32 v60, v60, v44, 16
    v_alignbit_b32 v61, v61, v45, 16
    v_alignbit_b32 v62, v62, v46, 16
    v_alignbit_b32 v63, v63, v47, 16
    v_and_b32 v63, v63, v10
    ds_write_b128 v8, v[60:63] offset:11840
    s_cmp_ge_u32 s2, 64
    s_cbranch_scc1 K2_NOPF
    s_getpc_b64 s[34:35]
K2_PC:
    s_add_u32 s34, s34, k4_mlp_kernel-K2_PC
    s_addc_u32 s35, s35, 0
    s_lshr_b32 s16, s2, 3
    s_lshl_b32 s16, s16, 12
    s_add_u32 s34, s34, s16
    s_addc_u32 s35, s35, 0
    v_lshlrev_b32 v70, 4, v0
    v_mov_b32 v71, s35
    v_add_co_u32 v70, vcc, s34, v70
    s_nop 1
    v_addc_co_u32 v71, vcc, 0, v71, vcc
    global_load_dwordx4 v[176:179], v[70:71], off
K2_NOPF:
    s_waitcnt lgkmcnt(0)
    ds_read_b128 v[80:83], v204 offset:0
    ds_read2_b32 v[48:49], v205 offset0:128 offset1:129
    ds_read2_b32 v[50:51], v205 offset0:130 offset1:131
    ds_read_b128 v[84:87], v204 offset:512
    ds_read2_b32 v[52:53], v205 offset0:0 offset1:1
    ds_read2_b32 v[54:55], v205 offset0:2 offset1:3
    ds_read_b128 v[88:91], v204 offset:1024
    ds_read2_b32 v[56:57], v206 offset0:128 offset1:129
    ds_read2_b32 v[58:59], v206 offset0:130 offset1:131
    ds_read_b128 v[92:95], v204 offset:1536
    ds_read2_b32 v[60:61], v206 offset0:0 offset1:1
    ds_read2_b32 v[62:63], v206 offset0:2 offset1:3
    ds_read_b128 v[96:99], v204 offset:2048
    ds_read2_b32 v[64:65], v207 offset0:128 offset1:129
    ds_read2_b32 v[66:67], v207 offset0:130 offset1:131
    ds_read_b128 v[100:103], v204 offset:2560
    ds_read2_b32 v[68:69], v207 offset0:0 offset1:1
    ds_read2_b32 v[70:71], v207 offset0:2 offset1:3
    ds_read_b128 v[104:107], v204 offset:3072
    ds_read2_b32 v[72:73], v208 offset0:128 offset1:129
    ds_read2_b32 v[74:75], v208 offset0:130 offset1:131
    ds_read_b128 v[108:111], v204 offset:3584
    ds_read2_b32 v[76:77], v208 offset0:0 offset1:1
    ds_read2_b32 v[78:79], v208 offset0:2 offset1:3
    v_subrev_u32 v204, 64, v204
    v_subrev_u32 v205, 64, v205
    v_subrev_u32 v206, 64, v206
    v_subrev_u32 v207, 64, v207
    v_subrev_u32 v208, 64, v208
    s_waitcnt lgkmcnt(0)
    v_mfma_f32_16x16x32_bf16 v[16:19], v[48:51], v[80:83], 0
    v_mfma_f32_16x16x32_bf16 v[20:23], v[48:51], v[84:87], 0
    ds_read_b128 v[144:147], v204 offset:0
    v_mfma_f32_16x16x32_bf16 v[24:27], v[48:51], v[88:91], 0
    ds_read2_b32 v[112:113], v205 offset0:128 offset1:129
    v_mfma_f32_16x16x32_bf16 v[28:31], v[48:51], v[92:95], 0
    ds_read2_b32 v[114:115], v205 offset0:130 offset1:131
    v_mfma_f32_16x16x32_bf16 v[32:35], v[48:51], v[96:99], 0
    ds_read_b128 v[148:151], v204 offset:512
    v_mfma_f32_16x16x32_bf16 v[36:39], v[48:51], v[100:103], 0
    ds_read2_b32 v[116:117], v205 offset0:0 offset1:1
    v_mfma_f32_16x16x32_bf16 v[40:43], v[48:51], v[104:107], 0
    ds_read2_b32 v[118:119], v205 offset0:2 offset1:3
    v_mfma_f32_16x16x32_bf16 v[44:47], v[48:51], v[108:111], 0
    ds_read_b128 v[152:155], v204 offset:1024
    v_mfma_f32_16x16x32_bf16 v[20:23], v[52:55], v[80:83], v[20:23]
    ds_read2_b32 v[120:121], v206 offset0:128 offset1:129
    v_mfma_f32_16x16x32_bf16 v[24:27], v[52:55], v[84:87], v[24:27]
    ds_read2_b32 v[122:123], v206 offset0:130 offset1:131
    v_mfma_f32_16x16x32_bf16 v[28:31], v[52:55], v[88:91], v[28:31]
    ds_read_b128 v[156:159], v204 offset:1536
    v_mfma_f32_16x16x32_bf16 v[32:35], v[52:55], v[92:95], v[32:35]
    ds_read2_b32 v[124:125], v206 offset0:0 offset1:1
    v_mfma_f32_16x16x32_bf16 v[36:39], v[52:55], v[96:99], v[36:39]
    ds_read2_b32 v[126:127], v206 offset0:2 offset1:3
    v_mfma_f32_16x16x32_bf16 v[40:43], v[52:55], v[100:103], v[40:43]
    ds_read_b128 v[160:163], v204 offset:2048
    v_mfma_f32_16x16x32_bf16 v[44:47], v[52:55], v[104:107], v[44:47]
    ds_read2_b32 v[128:129], v207 offset0:128 offset1:129
    v_mfma_f32_16x16x32_bf16 v[24:27], v[56:59], v[80:83], v[24:27]
    ds_read2_b32 v[130:131], v207 offset0:130 offset1:131
    v_mfma_f32_16x16x32_bf16 v[28:31], v[56:59], v[84:87], v[28:31]
    ds_read_b128 v[164:167], v204 offset:2560
    v_mfma_f32_16x16x32_bf16 v[32:35], v[56:59], v[88:91], v[32:35]
    ds_read2_b32 v[132:133], v207 offset0:0 offset1:1
    v_mfma_f32_16x16x32_bf16 v[36:39], v[56:59], v[92:95], v[36:39]
    ds_read2_b32 v[134:135], v207 offset0:2 offset1:3
    v_mfma_f32_16x16x32_bf16 v[40:43], v[56:59], v[96:99], v[40:43]
    ds_read_b128 v[168:171], v204 offset:3072
    v_mfma_f32_16x16x32_bf16 v[44:47], v[56:59], v[100:103], v[44:47]
    ds_read2_b32 v[136:137], v208 offset0:128 offset1:129
    v_mfma_f32_16x16x32_bf16 v[28:31], v[60:63], v[80:83], v[28:31]
    ds_read2_b32 v[138:139], v208 offset0:130 offset1:131
    v_mfma_f32_16x16x32_bf16 v[32:35], v[60:63], v[84:87], v[32:35]
    ds_read_b128 v[172:175], v204 offset:3584
    v_mfma_f32_16x16x32_bf16 v[36:39], v[60:63], v[88:91], v[36:39]
    ds_read2_b32 v[140:141], v208 offset0:0 offset1:1
    v_mfma_f32_16x16x32_bf16 v[40:43], v[60:63], v[92:95], v[40:43]
    ds_read2_b32 v[142:143], v208 offset0:2 offset1:3
    v_mfma_f32_16x16x32_bf16 v[44:47], v[60:63], v[96:99], v[44:47]
    v_mfma_f32_16x16x32_bf16 v[32:35], v[64:67], v[80:83], v[32:35]
    v_mfma_f32_16x16x32_bf16 v[36:39], v[64:67], v[84:87], v[36:39]
    v_mfma_f32_16x16x32_bf16 v[40:43], v[64:67], v[88:91], v[40:43]
    v_mfma_f32_16x16x32_bf16 v[44:47], v[64:67], v[92:95], v[44:47]
    v_mfma_f32_16x16x32_bf16 v[36:39], v[68:71], v[80:83], v[36:39]
    v_mfma_f32_16x16x32_bf16 v[40:43], v[68:71], v[84:87], v[40:43]
    v_mfma_f32_16x16x32_bf16 v[44:47], v[68:71], v[88:91], v[44:47]
    v_mfma_f32_16x16x32_bf16 v[40:43], v[72:75], v[80:83], v[40:43]
    v_mfma_f32_16x16x32_bf16 v[44:47], v[72:75], v[84:87], v[44:47]
    v_mfma_f32_16x16x32_bf16 v[44:47], v[76:79], v[80:83], v[44:47]
    v_subrev_u32 v204, 64, v204
    v_subrev_u32 v205, 64, v205
    v_subrev_u32 v206, 64, v206
    v_subrev_u32 v207, 64, v207
    v_subrev_u32 v208, 64, v208
    s_waitcnt lgkmcnt(0)
    v_mfma_f32_16x16x32_bf16 v[16:19], v[112:115], v[144:147], v[16:19]
    v_mfma_f32_16x16x32_bf16 v[20:23], v[112:115], v[148:151], v[20:23]
    ds_read_b128 v[80:83], v204 offset:0
    v_mfma_f32_16x16x32_bf16 v[24:27], v[112:115], v[152:155], v[24:27]
    ds_read2_b32 v[48:49], v205 offset0:128 offset1:129
    v_mfma_f32_16x16x32_bf16 v[28:31], v[112:115], v[156:159], v[28:31]
    ds_read2_b32 v[50:51], v205 offset0:130 offset1:131
    v_mfma_f32_16x16x32_bf16 v[32:35], v[112:115], v[160:163], v[32:35]
    ds_read_b128 v[84:87], v204 offset:512
    v_mfma_f32_16x16x32_bf16 v[36:39], v[112:115], v[164:167], v[36:39]
    ds_read2_b32 v[52:53], v205 offset0:0 offset1:1
    v_mfma_f32_16x16x32_bf16 v[40:43], v[112:115], v[168:171], v[40:43]
    ds_read2_b32 v[54:55], v205 offset0:2 offset1:3
    v_mfma_f32_16x16x32_bf16 v[44:47], v[112:115], v[172:175], v[44:47]
    ds_read_b128 v[88:91], v204 offset:1024
    v_mfma_f32_16x16x32_bf16 v[20:23], v[116:119], v[144:147], v[20:23]
    ds_read2_b32 v[56:57], v206 offset0:128 offset1:129
    v_mfma_f32_16x16x32_bf16 v[24:27], v[116:119], v[148:151], v[24:27]
    ds_read2_b32 v[58:59], v206 offset0:130 offset1:131
    v_mfma_f32_16x16x32_bf16 v[28:31], v[116:119], v[152:155], v[28:31]
    ds_read_b128 v[92:95], v204 offset:1536
    v_mfma_f32_16x16x32_bf16 v[32:35], v[116:119], v[156:159], v[32:35]
    ds_read2_b32 v[60:61], v206 offset0:0 offset1:1
    v_mfma_f32_16x16x32_bf16 v[36:39], v[116:119], v[160:163], v[36:39]
    ds_read2_b32 v[62:63], v206 offset0:2 offset1:3
    v_mfma_f32_16x16x32_bf16 v[40:43], v[116:119], v[164:167], v[40:43]
    ds_read_b128 v[96:99], v204 offset:2048
    v_mfma_f32_16x16x32_bf16 v[44:47], v[116:119], v[168:171], v[44:47]
    ds_read2_b32 v[64:65], v207 offset0:128 offset1:129
    v_mfma_f32_16x16x32_bf16 v[24:27], v[120:123], v[144:147], v[24:27]
    ds_read2_b32 v[66:67], v207 offset0:130 offset1:131
    v_mfma_f32_16x16x32_bf16 v[28:31], v[120:123], v[148:151], v[28:31]
    ds_read_b128 v[100:103], v204 offset:2560
    v_mfma_f32_16x16x32_bf16 v[32:35], v[120:123], v[152:155], v[32:35]
    ds_read2_b32 v[68:69], v207 offset0:0 offset1:1
    v_mfma_f32_16x16x32_bf16 v[36:39], v[120:123], v[156:159], v[36:39]
    ds_read2_b32 v[70:71], v207 offset0:2 offset1:3
    v_mfma_f32_16x16x32_bf16 v[40:43], v[120:123], v[160:163], v[40:43]
    ds_read_b128 v[104:107], v204 offset:3072
    v_mfma_f32_16x16x32_bf16 v[44:47], v[120:123], v[164:167], v[44:47]
    ds_read2_b32 v[72:73], v208 offset0:128 offset1:129
    v_mfma_f32_16x16x32_bf16 v[28:31], v[124:127], v[144:147], v[28:31]
    ds_read2_b32 v[74:75], v208 offset0:130 offset1:131
    v_mfma_f32_16x16x32_bf16 v[32:35], v[124:127], v[148:151], v[32:35]
    ds_read_b128 v[108:111], v204 offset:3584
    v_mfma_f32_16x16x32_bf16 v[36:39], v[124:127], v[152:155], v[36:39]
    ds_read2_b32 v[76:77], v208 offset0:0 offset1:1
    v_mfma_f32_16x16x32_bf16 v[40:43], v[124:127], v[156:159], v[40:43]
    ds_read2_b32 v[78:79], v208 offset0:2 offset1:3
    v_mfma_f32_16x16x32_bf16 v[44:47], v[124:127], v[160:163], v[44:47]
    v_mfma_f32_16x16x32_bf16 v[32:35], v[128:131], v[144:147], v[32:35]
    v_mfma_f32_16x16x32_bf16 v[36:39], v[128:131], v[148:151], v[36:39]
    v_mfma_f32_16x16x32_bf16 v[40:43], v[128:131], v[152:155], v[40:43]
    v_mfma_f32_16x16x32_bf16 v[44:47], v[128:131], v[156:159], v[44:47]
    v_mfma_f32_16x16x32_bf16 v[36:39], v[132:135], v[144:147], v[36:39]
    v_mfma_f32_16x16x32_bf16 v[40:43], v[132:135], v[148:151], v[40:43]
    v_mfma_f32_16x16x32_bf16 v[44:47], v[132:135], v[152:155], v[44:47]
    v_mfma_f32_16x16x32_bf16 v[40:43], v[136:139], v[144:147], v[40:43]
    v_mfma_f32_16x16x32_bf16 v[44:47], v[136:139], v[148:151], v[44:47]
    v_mfma_f32_16x16x32_bf16 v[44:47], v[140:143], v[144:147], v[44:47]
    v_subrev_u32 v204, 64, v204
    v_subrev_u32 v205, 64, v205
    v_subrev_u32 v206, 64, v206
    v_subrev_u32 v207, 64, v207
    v_subrev_u32 v208, 64, v208
    s_waitcnt lgkmcnt(0)
    v_mfma_f32_16x16x32_bf16 v[16:19], v[48:51], v[80:83], v[16:19]
    v_mfma_f32_16x16x32_bf16 v[20:23], v[48:51], v[84:87], v[20:23]
    ds_read_b128 v[144:147], v204 offset:0
    v_mfma_f32_16x16x32_bf16 v[24:27], v[48:51], v[88:91], v[24:27]
    ds_read2_b32 v[112:113], v205 offset0:128 offset1:129
    v_mfma_f32_16x16x32_bf16 v[28:31], v[48:51], v[92:95], v[28:31]
    ds_read2_b32 v[114:115], v205 offset0:130 offset1:131
    v_mfma_f32_16x16x32_bf16 v[32:35], v[48:51], v[96:99], v[32:35]
    ds_read_b128 v[148:151], v204 offset:512
    v_mfma_f32_16x16x32_bf16 v[36:39], v[48:51], v[100:103], v[36:39]
    ds_read2_b32 v[116:117], v205 offset0:0 offset1:1
    v_mfma_f32_16x16x32_bf16 v[40:43], v[48:51], v[104:107], v[40:43]
    ds_read2_b32 v[118:119], v205 offset0:2 offset1:3
    v_mfma_f32_16x16x32_bf16 v[44:47], v[48:51], v[108:111], v[44:47]
    ds_read_b128 v[152:155], v204 offset:1024
    v_mfma_f32_16x16x32_bf16 v[20:23], v[52:55], v[80:83], v[20:23]
    ds_read2_b32 v[120:121], v206 offset0:128 offset1:129
    v_mfma_f32_16x16x32_bf16 v[24:27], v[52:55], v[84:87], v[24:27]
    ds_read2_b32 v[122:123], v206 offset0:130 offset1:131
    v_mfma_f32_16x16x32_bf16 v[28:31], v[52:55], v[88:91], v[28:31]
    ds_read_b128 v[156:159], v204 offset:1536
    v_mfma_f32_16x16x32_bf16 v[32:35], v[52:55], v[92:95], v[32:35]
    ds_read2_b32 v[124:125], v206 offset0:0 offset1:1
    v_mfma_f32_16x16x32_bf16 v[36:39], v[52:55], v[96:99], v[36:39]
    ds_read2_b32 v[126:127], v206 offset0:2 offset1:3
    v_mfma_f32_16x16x32_bf16 v[40:43], v[52:55], v[100:103], v[40:43]
    ds_read_b128 v[160:163], v204 offset:2048
    v_mfma_f32_16x16x32_bf16 v[44:47], v[52:55], v[104:107], v[44:47]
    ds_read2_b32 v[128:129], v207 offset0:128 offset1:129
    v_mfma_f32_16x16x32_bf16 v[24:27], v[56:59], v[80:83], v[24:27]
    ds_read2_b32 v[130:131], v207 offset0:130 offset1:131
    v_mfma_f32_16x16x32_bf16 v[28:31], v[56:59], v[84:87], v[28:31]
    ds_read_b128 v[164:167], v204 offset:2560
    v_mfma_f32_16x16x32_bf16 v[32:35], v[56:59], v[88:91], v[32:35]
    ds_read2_b32 v[132:133], v207 offset0:0 offset1:1
    v_mfma_f32_16x16x32_bf16 v[36:39], v[56:59], v[92:95], v[36:39]
    ds_read2_b32 v[134:135], v207 offset0:2 offset1:3
    v_mfma_f32_16x16x32_bf16 v[40:43], v[56:59], v[96:99], v[40:43]
    ds_read_b128 v[168:171], v204 offset:3072
    v_mfma_f32_16x16x32_bf16 v[44:47], v[56:59], v[100:103], v[44:47]
    ds_read2_b32 v[136:137], v208 offset0:128 offset1:129
    v_mfma_f32_16x16x32_bf16 v[28:31], v[60:63], v[80:83], v[28:31]
    ds_read2_b32 v[138:139], v208 offset0:130 offset1:131
    v_mfma_f32_16x16x32_bf16 v[32:35], v[60:63], v[84:87], v[32:35]
    ds_read_b128 v[172:175], v204 offset:3584
    v_mfma_f32_16x16x32_bf16 v[36:39], v[60:63], v[88:91], v[36:39]
    ds_read2_b32 v[140:141], v208 offset0:0 offset1:1
    v_mfma_f32_16x16x32_bf16 v[40:43], v[60:63], v[92:95], v[40:43]
    ds_read2_b32 v[142:143], v208 offset0:2 offset1:3
    v_mfma_f32_16x16x32_bf16 v[44:47], v[60:63], v[96:99], v[44:47]
    v_mfma_f32_16x16x32_bf16 v[32:35], v[64:67], v[80:83], v[32:35]
    v_mfma_f32_16x16x32_bf16 v[36:39], v[64:67], v[84:87], v[36:39]
    v_mfma_f32_16x16x32_bf16 v[40:43], v[64:67], v[88:91], v[40:43]
    v_mfma_f32_16x16x32_bf16 v[44:47], v[64:67], v[92:95], v[44:47]
    v_mfma_f32_16x16x32_bf16 v[36:39], v[68:71], v[80:83], v[36:39]
    v_mfma_f32_16x16x32_bf16 v[40:43], v[68:71], v[84:87], v[40:43]
    v_mfma_f32_16x16x32_bf16 v[44:47], v[68:71], v[88:91], v[44:47]
    v_mfma_f32_16x16x32_bf16 v[40:43], v[72:75], v[80:83], v[40:43]
    v_mfma_f32_16x16x32_bf16 v[44:47], v[72:75], v[84:87], v[44:47]
    v_mfma_f32_16x16x32_bf16 v[44:47], v[76:79], v[80:83], v[44:47]
    v_subrev_u32 v204, 64, v204
    v_subrev_u32 v205, 64, v205
    v_subrev_u32 v206, 64, v206
    v_subrev_u32 v207, 64, v207
    v_subrev_u32 v208, 64, v208
    s_waitcnt lgkmcnt(0)
    s_waitcnt vmcnt(1)
    s_waitcnt lgkmcnt(0)
    v_mov_b32 v213, 1
    s_mov_b64 exec, 1
    ds_add_u32 v212, v213 offset:8
    s_mov_b64 exec, -1
    v_mfma_f32_16x16x32_bf16 v[16:19], v[112:115], v[144:147], v[16:19]
    v_mfma_f32_16x16x32_bf16 v[20:23], v[112:115], v[148:151], v[20:23]
    ds_read_b128 v[80:83], v204 offset:0
    v_mfma_f32_16x16x32_bf16 v[24:27], v[112:115], v[152:155], v[24:27]
    ds_read2_b32 v[48:49], v205 offset0:128 offset1:129
    v_mfma_f32_16x16x32_bf16 v[28:31], v[112:115], v[156:159], v[28:31]
    ds_read2_b32 v[50:51], v205 offset0:130 offset1:131
    v_mfma_f32_16x16x32_bf16 v[32:35], v[112:115], v[160:163], v[32:35]
    ds_read_b128 v[84:87], v204 offset:512
    v_mfma_f32_16x16x32_bf16 v[36:39], v[112:115], v[164:167], v[36:39]
    ds_read2_b32 v[52:53], v205 offset0:0 offset1:1
    v_mfma_f32_16x16x32_bf16 v[40:43], v[112:115], v[168:171], v[40:43]
    ds_read2_b32 v[54:55], v205 offset0:2 offset1:3
    v_mfma_f32_16x16x32_bf16 v[44:47], v[112:115], v[172:175], v[44:47]
    ds_read_b128 v[88:91], v204 offset:1024
    v_mfma_f32_16x16x32_bf16 v[20:23], v[116:119], v[144:147], v[20:23]
    ds_read2_b32 v[56:57], v206 offset0:128 offset1:129
    v_mfma_f32_16x16x32_bf16 v[24:27], v[116:119], v[148:151], v[24:27]
    ds_read2_b32 v[58:59], v206 offset0:130 offset1:131
    v_mfma_f32_16x16x32_bf16 v[28:31], v[116:119], v[152:155], v[28:31]
    ds_read_b128 v[92:95], v204 offset:1536
    v_mfma_f32_16x16x32_bf16 v[32:35], v[116:119], v[156:159], v[32:35]
    ds_read2_b32 v[60:61], v206 offset0:0 offset1:1
    v_mfma_f32_16x16x32_bf16 v[36:39], v[116:119], v[160:163], v[36:39]
    ds_read2_b32 v[62:63], v206 offset0:2 offset1:3
    v_mfma_f32_16x16x32_bf16 v[40:43], v[116:119], v[164:167], v[40:43]
    ds_read_b128 v[96:99], v204 offset:2048
    v_mfma_f32_16x16x32_bf16 v[44:47], v[116:119], v[168:171], v[44:47]
    ds_read2_b32 v[64:65], v207 offset0:128 offset1:129
    v_mfma_f32_16x16x32_bf16 v[24:27], v[120:123], v[144:147], v[24:27]
    ds_read2_b32 v[66:67], v207 offset0:130 offset1:131
    v_mfma_f32_16x16x32_bf16 v[28:31], v[120:123], v[148:151], v[28:31]
    ds_read_b128 v[100:103], v204 offset:2560
    v_mfma_f32_16x16x32_bf16 v[32:35], v[120:123], v[152:155], v[32:35]
    ds_read2_b32 v[68:69], v207 offset0:0 offset1:1
    v_mfma_f32_16x16x32_bf16 v[36:39], v[120:123], v[156:159], v[36:39]
    ds_read2_b32 v[70:71], v207 offset0:2 offset1:3
    v_mfma_f32_16x16x32_bf16 v[40:43], v[120:123], v[160:163], v[40:43]
    ds_read_b128 v[104:107], v204 offset:3072
    v_mfma_f32_16x16x32_bf16 v[44:47], v[120:123], v[164:167], v[44:47]
    ds_read2_b32 v[72:73], v208 offset0:128 offset1:129
    v_mfma_f32_16x16x32_bf16 v[28:31], v[124:127], v[144:147], v[28:31]
    ds_read2_b32 v[74:75], v208 offset0:130 offset1:131
    v_mfma_f32_16x16x32_bf16 v[32:35], v[124:127], v[148:151], v[32:35]
    ds_read_b128 v[108:111], v204 offset:3584
    v_mfma_f32_16x16x32_bf16 v[36:39], v[124:127], v[152:155], v[36:39]
    ds_read2_b32 v[76:77], v208 offset0:0 offset1:1
    v_mfma_f32_16x16x32_bf16 v[40:43], v[124:127], v[156:159], v[40:43]
    ds_read2_b32 v[78:79], v208 offset0:2 offset1:3
    v_mfma_f32_16x16x32_bf16 v[44:47], v[124:127], v[160:163], v[44:47]
    v_mfma_f32_16x16x32_bf16 v[32:35], v[128:131], v[144:147], v[32:35]
    v_mfma_f32_16x16x32_bf16 v[36:39], v[128:131], v[148:151], v[36:39]
    v_mfma_f32_16x16x32_bf16 v[40:43], v[128:131], v[152:155], v[40:43]
    v_mfma_f32_16x16x32_bf16 v[44:47], v[128:131], v[156:159], v[44:47]
    v_mfma_f32_16x16x32_bf16 v[36:39], v[132:135], v[144:147], v[36:39]
    v_mfma_f32_16x16x32_bf16 v[40:43], v[132:135], v[148:151], v[40:43]
    v_mfma_f32_16x16x32_bf16 v[44:47], v[132:135], v[152:155], v[44:47]
    v_mfma_f32_16x16x32_bf16 v[40:43], v[136:139], v[144:147], v[40:43]
    v_mfma_f32_16x16x32_bf16 v[44:47], v[136:139], v[148:151], v[44:47]
    v_mfma_f32_16x16x32_bf16 v[44:47], v[140:143], v[144:147], v[44:47]
    v_subrev_u32 v204, 64, v204
    v_subrev_u32 v205, 64, v205
    v_subrev_u32 v206, 64, v206
    v_subrev_u32 v207, 64, v207
    v_subrev_u32 v208, 64, v208
    s_waitcnt lgkmcnt(0)
    v_mfma_f32_16x16x32_bf16 v[16:19], v[48:51], v[80:83], v[16:19]
    v_mfma_f32_16x16x32_bf16 v[20:23], v[48:51], v[84:87], v[20:23]
    ds_read_b128 v[144:147], v204 offset:0
    v_mfma_f32_16x16x32_bf16 v[24:27], v[48:51], v[88:91], v[24:27]
    ds_read2_b32 v[112:113], v205 offset0:128 offset1:129
    v_mfma_f32_16x16x32_bf16 v[28:31], v[48:51], v[92:95], v[28:31]
    ds_read2_b32 v[114:115], v205 offset0:130 offset1:131
    v_mfma_f32_16x16x32_bf16 v[32:35], v[48:51], v[96:99], v[32:35]
    ds_read_b128 v[148:151], v204 offset:512
    v_mfma_f32_16x16x32_bf16 v[36:39], v[48:51], v[100:103], v[36:39]
    ds_read2_b32 v[116:117], v205 offset0:0 offset1:1
    v_mfma_f32_16x16x32_bf16 v[40:43], v[48:51], v[104:107], v[40:43]
    ds_read2_b32 v[118:119], v205 offset0:2 offset1:3
    v_mfma_f32_16x16x32_bf16 v[44:47], v[48:51], v[108:111], v[44:47]
    ds_read_b128 v[152:155], v204 offset:1024
    v_mfma_f32_16x16x32_bf16 v[20:23], v[52:55], v[80:83], v[20:23]
    ds_read2_b32 v[120:121], v206 offset0:128 offset1:129
    v_mfma_f32_16x16x32_bf16 v[24:27], v[52:55], v[84:87], v[24:27]
    ds_read2_b32 v[122:123], v206 offset0:130 offset1:131
    v_mfma_f32_16x16x32_bf16 v[28:31], v[52:55], v[88:91], v[28:31]
    ds_read_b128 v[156:159], v204 offset:1536
    v_mfma_f32_16x16x32_bf16 v[32:35], v[52:55], v[92:95], v[32:35]
    ds_read2_b32 v[124:125], v206 offset0:0 offset1:1
    v_mfma_f32_16x16x32_bf16 v[36:39], v[52:55], v[96:99], v[36:39]
    ds_read2_b32 v[126:127], v206 offset0:2 offset1:3
    v_mfma_f32_16x16x32_bf16 v[40:43], v[52:55], v[100:103], v[40:43]
    ds_read_b128 v[160:163], v204 offset:2048
    v_mfma_f32_16x16x32_bf16 v[44:47], v[52:55], v[104:107], v[44:47]
    ds_read2_b32 v[128:129], v207 offset0:128 offset1:129
    v_mfma_f32_16x16x32_bf16 v[24:27], v[56:59], v[80:83], v[24:27]
    ds_read2_b32 v[130:131], v207 offset0:130 offset1:131
    v_mfma_f32_16x16x32_bf16 v[28:31], v[56:59], v[84:87], v[28:31]
    ds_read_b128 v[164:167], v204 offset:2560
    v_mfma_f32_16x16x32_bf16 v[32:35], v[56:59], v[88:91], v[32:35]
    ds_read2_b32 v[132:133], v207 offset0:0 offset1:1
    v_mfma_f32_16x16x32_bf16 v[36:39], v[56:59], v[92:95], v[36:39]
    ds_read2_b32 v[134:135], v207 offset0:2 offset1:3
    v_mfma_f32_16x16x32_bf16 v[40:43], v[56:59], v[96:99], v[40:43]
    ds_read_b128 v[168:171], v204 offset:3072
    v_mfma_f32_16x16x32_bf16 v[44:47], v[56:59], v[100:103], v[44:47]
    ds_read2_b32 v[136:137], v208 offset0:128 offset1:129
    v_mfma_f32_16x16x32_bf16 v[28:31], v[60:63], v[80:83], v[28:31]
    ds_read2_b32 v[138:139], v208 offset0:130 offset1:131
    v_mfma_f32_16x16x32_bf16 v[32:35], v[60:63], v[84:87], v[32:35]
    ds_read_b128 v[172:175], v204 offset:3584
    v_mfma_f32_16x16x32_bf16 v[36:39], v[60:63], v[88:91], v[36:39]
    ds_read2_b32 v[140:141], v208 offset0:0 offset1:1
    v_mfma_f32_16x16x32_bf16 v[40:43], v[60:63], v[92:95], v[40:43]
    ds_read2_b32 v[142:143], v208 offset0:2 offset1:3
    v_mfma_f32_16x16x32_bf16 v[44:47], v[60:63], v[96:99], v[44:47]
    v_mfma_f32_16x16x32_bf16 v[32:35], v[64:67], v[80:83], v[32:35]
    v_mfma_f32_16x16x32_bf16 v[36:39], v[64:67], v[84:87], v[36:39]
    v_mfma_f32_16x16x32_bf16 v[40:43], v[64:67], v[88:91], v[40:43]
    v_mfma_f32_16x16x32_bf16 v[44:47], v[64:67], v[92:95], v[44:47]
    v_mfma_f32_16x16x32_bf16 v[36:39], v[68:71], v[80:83], v[36:39]
    v_mfma_f32_16x16x32_bf16 v[40:43], v[68:71], v[84:87], v[40:43]
    v_mfma_f32_16x16x32_bf16 v[44:47], v[68:71], v[88:91], v[44:47]
    v_mfma_f32_16x16x32_bf16 v[40:43], v[72:75], v[80:83], v[40:43]
    v_mfma_f32_16x16x32_bf16 v[44:47], v[72:75], v[84:87], v[44:47]
    v_mfma_f32_16x16x32_bf16 v[44:47], v[76:79], v[80:83], v[44:47]
    v_subrev_u32 v204, 64, v204
    v_subrev_u32 v205, 64, v205
    v_subrev_u32 v206, 64, v206
    v_subrev_u32 v207, 64, v207
    v_subrev_u32 v208, 64, v208
    s_waitcnt lgkmcnt(0)
    v_mfma_f32_16x16x32_bf16 v[16:19], v[112:115], v[144:147], v[16:19]
    v_mfma_f32_16x16x32_bf16 v[20:23], v[112:115], v[148:151], v[20:23]
    ds_read_b128 v[80:83], v204 offset:0
    v_mfma_f32_16x16x32_bf16 v[24:27], v[112:115], v[152:155], v[24:27]
    ds_read2_b32 v[48:49], v205 offset0:128 offset1:129
    v_mfma_f32_16x16x32_bf16 v[28:31], v[112:115], v[156:159], v[28:31]
    ds_read2_b32 v[50:51], v205 offset0:130 offset1:131
    v_mfma_f32_16x16x32_bf16 v[32:35], v[112:115], v[160:163], v[32:35]
    ds_read_b128 v[84:87], v204 offset:512
    v_mfma_f32_16x16x32_bf16 v[36:39], v[112:115], v[164:167], v[36:39]
    ds_read2_b32 v[52:53], v205 offset0:0 offset1:1
    v_mfma_f32_16x16x32_bf16 v[40:43], v[112:115], v[168:171], v[40:43]
    ds_read2_b32 v[54:55], v205 offset0:2 offset1:3
    v_mfma_f32_16x16x32_bf16 v[44:47], v[112:115], v[172:175], v[44:47]
    ds_read_b128 v[88:91], v204 offset:1024
    v_mfma_f32_16x16x32_bf16 v[20:23], v[116:119], v[144:147], v[20:23]
    ds_read2_b32 v[56:57], v206 offset0:128 offset1:129
    v_mfma_f32_16x16x32_bf16 v[24:27], v[116:119], v[148:151], v[24:27]
    ds_read2_b32 v[58:59], v206 offset0:130 offset1:131
    v_mfma_f32_16x16x32_bf16 v[28:31], v[116:119], v[152:155], v[28:31]
    ds_read_b128 v[92:95], v204 offset:1536
    v_mfma_f32_16x16x32_bf16 v[32:35], v[116:119], v[156:159], v[32:35]
    ds_read2_b32 v[60:61], v206 offset0:0 offset1:1
    v_mfma_f32_16x16x32_bf16 v[36:39], v[116:119], v[160:163], v[36:39]
    ds_read2_b32 v[62:63], v206 offset0:2 offset1:3
    v_mfma_f32_16x16x32_bf16 v[40:43], v[116:119], v[164:167], v[40:43]
    ds_read_b128 v[96:99], v204 offset:2048
    v_mfma_f32_16x16x32_bf16 v[44:47], v[116:119], v[168:171], v[44:47]
    ds_read2_b32 v[64:65], v207 offset0:128 offset1:129
    v_mfma_f32_16x16x32_bf16 v[24:27], v[120:123], v[144:147], v[24:27]
    ds_read2_b32 v[66:67], v207 offset0:130 offset1:131
    v_mfma_f32_16x16x32_bf16 v[28:31], v[120:123], v[148:151], v[28:31]
    ds_read_b128 v[100:103], v204 offset:2560
    v_mfma_f32_16x16x32_bf16 v[32:35], v[120:123], v[152:155], v[32:35]
    ds_read2_b32 v[68:69], v207 offset0:0 offset1:1
    v_mfma_f32_16x16x32_bf16 v[36:39], v[120:123], v[156:159], v[36:39]
    ds_read2_b32 v[70:71], v207 offset0:2 offset1:3
    v_mfma_f32_16x16x32_bf16 v[40:43], v[120:123], v[160:163], v[40:43]
    ds_read_b128 v[104:107], v204 offset:3072
    v_mfma_f32_16x16x32_bf16 v[44:47], v[120:123], v[164:167], v[44:47]
    ds_read2_b32 v[72:73], v208 offset0:128 offset1:129
    v_mfma_f32_16x16x32_bf16 v[28:31], v[124:127], v[144:147], v[28:31]
    ds_read2_b32 v[74:75], v208 offset0:130 offset1:131
    v_mfma_f32_16x16x32_bf16 v[32:35], v[124:127], v[148:151], v[32:35]
    ds_read_b128 v[108:111], v204 offset:3584
    v_mfma_f32_16x16x32_bf16 v[36:39], v[124:127], v[152:155], v[36:39]
    ds_read2_b32 v[76:77], v208 offset0:0 offset1:1
    v_mfma_f32_16x16x32_bf16 v[40:43], v[124:127], v[156:159], v[40:43]
    ds_read2_b32 v[78:79], v208 offset0:2 offset1:3
    v_mfma_f32_16x16x32_bf16 v[44:47], v[124:127], v[160:163], v[44:47]
    v_mfma_f32_16x16x32_bf16 v[32:35], v[128:131], v[144:147], v[32:35]
    v_mfma_f32_16x16x32_bf16 v[36:39], v[128:131], v[148:151], v[36:39]
    v_mfma_f32_16x16x32_bf16 v[40:43], v[128:131], v[152:155], v[40:43]
    v_mfma_f32_16x16x32_bf16 v[44:47], v[128:131], v[156:159], v[44:47]
    v_mfma_f32_16x16x32_bf16 v[36:39], v[132:135], v[144:147], v[36:39]
    v_mfma_f32_16x16x32_bf16 v[40:43], v[132:135], v[148:151], v[40:43]
    v_mfma_f32_16x16x32_bf16 v[44:47], v[132:135], v[152:155], v[44:47]
    v_mfma_f32_16x16x32_bf16 v[40:43], v[136:139], v[144:147], v[40:43]
    v_mfma_f32_16x16x32_bf16 v[44:47], v[136:139], v[148:151], v[44:47]
    v_mfma_f32_16x16x32_bf16 v[44:47], v[140:143], v[144:147], v[44:47]
    v_subrev_u32 v204, 64, v204
    v_subrev_u32 v205, 64, v205
    v_subrev_u32 v206, 64, v206
    v_subrev_u32 v207, 64, v207
    v_subrev_u32 v208, 64, v208
    s_waitcnt lgkmcnt(0)
    v_mfma_f32_16x16x32_bf16 v[16:19], v[48:51], v[80:83], v[16:19]
    v_mfma_f32_16x16x32_bf16 v[20:23], v[48:51], v[84:87], v[20:23]
    ds_read_b128 v[144:147], v204 offset:0
    v_mfma_f32_16x16x32_bf16 v[24:27], v[48:51], v[88:91], v[24:27]
    ds_read2_b32 v[112:113], v205 offset0:128 offset1:129
    v_mfma_f32_16x16x32_bf16 v[28:31], v[48:51], v[92:95], v[28:31]
    ds_read2_b32 v[114:115], v205 offset0:130 offset1:131
    v_mfma_f32_16x16x32_bf16 v[32:35], v[48:51], v[96:99], v[32:35]
    ds_read_b128 v[148:151], v204 offset:512
    v_mfma_f32_16x16x32_bf16 v[36:39], v[48:51], v[100:103], v[36:39]
    ds_read2_b32 v[116:117], v205 offset0:0 offset1:1
    v_mfma_f32_16x16x32_bf16 v[40:43], v[48:51], v[104:107], v[40:43]
    ds_read2_b32 v[118:119], v205 offset0:2 offset1:3
    v_mfma_f32_16x16x32_bf16 v[44:47], v[48:51], v[108:111], v[44:47]
    ds_read_b128 v[152:155], v204 offset:1024
    v_mfma_f32_16x16x32_bf16 v[20:23], v[52:55], v[80:83], v[20:23]
    ds_read2_b32 v[120:121], v206 offset0:128 offset1:129
    v_mfma_f32_16x16x32_bf16 v[24:27], v[52:55], v[84:87], v[24:27]
    ds_read2_b32 v[122:123], v206 offset0:130 offset1:131
    v_mfma_f32_16x16x32_bf16 v[28:31], v[52:55], v[88:91], v[28:31]
    ds_read_b128 v[156:159], v204 offset:1536
    v_mfma_f32_16x16x32_bf16 v[32:35], v[52:55], v[92:95], v[32:35]
    ds_read2_b32 v[124:125], v206 offset0:0 offset1:1
    v_mfma_f32_16x16x32_bf16 v[36:39], v[52:55], v[96:99], v[36:39]
    ds_read2_b32 v[126:127], v206 offset0:2 offset1:3
    v_mfma_f32_16x16x32_bf16 v[40:43], v[52:55], v[100:103], v[40:43]
    ds_read_b128 v[160:163], v204 offset:2048
    v_mfma_f32_16x16x32_bf16 v[44:47], v[52:55], v[104:107], v[44:47]
    ds_read2_b32 v[128:129], v207 offset0:128 offset1:129
    v_mfma_f32_16x16x32_bf16 v[24:27], v[56:59], v[80:83], v[24:27]
    ds_read2_b32 v[130:131], v207 offset0:130 offset1:131
    v_mfma_f32_16x16x32_bf16 v[28:31], v[56:59], v[84:87], v[28:31]
    ds_read_b128 v[164:167], v204 offset:2560
    v_mfma_f32_16x16x32_bf16 v[32:35], v[56:59], v[88:91], v[32:35]
    ds_read2_b32 v[132:133], v207 offset0:0 offset1:1
    v_mfma_f32_16x16x32_bf16 v[36:39], v[56:59], v[92:95], v[36:39]
    ds_read2_b32 v[134:135], v207 offset0:2 offset1:3
    v_mfma_f32_16x16x32_bf16 v[40:43], v[56:59], v[96:99], v[40:43]
    ds_read_b128 v[168:171], v204 offset:3072
    v_mfma_f32_16x16x32_bf16 v[44:47], v[56:59], v[100:103], v[44:47]
    ds_read2_b32 v[136:137], v208 offset0:128 offset1:129
    v_mfma_f32_16x16x32_bf16 v[28:31], v[60:63], v[80:83], v[28:31]
    ds_read2_b32 v[138:139], v208 offset0:130 offset1:131
    v_mfma_f32_16x16x32_bf16 v[32:35], v[60:63], v[84:87], v[32:35]
    ds_read_b128 v[172:175], v204 offset:3584
    v_mfma_f32_16x16x32_bf16 v[36:39], v[60:63], v[88:91], v[36:39]
    ds_read2_b32 v[140:141], v208 offset0:0 offset1:1
    v_mfma_f32_16x16x32_bf16 v[40:43], v[60:63], v[92:95], v[40:43]
    ds_read2_b32 v[142:143], v208 offset0:2 offset1:3
    v_mfma_f32_16x16x32_bf16 v[44:47], v[60:63], v[96:99], v[44:47]
    v_mfma_f32_16x16x32_bf16 v[32:35], v[64:67], v[80:83], v[32:35]
    v_mfma_f32_16x16x32_bf16 v[36:39], v[64:67], v[84:87], v[36:39]
    v_mfma_f32_16x16x32_bf16 v[40:43], v[64:67], v[88:91], v[40:43]
    v_mfma_f32_16x16x32_bf16 v[44:47], v[64:67], v[92:95], v[44:47]
    v_mfma_f32_16x16x32_bf16 v[36:39], v[68:71], v[80:83], v[36:39]
    v_mfma_f32_16x16x32_bf16 v[40:43], v[68:71], v[84:87], v[40:43]
    v_mfma_f32_16x16x32_bf16 v[44:47], v[68:71], v[88:91], v[44:47]
    v_mfma_f32_16x16x32_bf16 v[40:43], v[72:75], v[80:83], v[40:43]
    v_mfma_f32_16x16x32_bf16 v[44:47], v[72:75], v[84:87], v[44:47]
    v_mfma_f32_16x16x32_bf16 v[44:47], v[76:79], v[80:83], v[44:47]
    v_subrev_u32 v204, 64, v204
    v_subrev_u32 v205, 64, v205
    v_subrev_u32 v206, 64, v206
    v_subrev_u32 v207, 64, v207
    v_subrev_u32 v208, 64, v208
    s_waitcnt lgkmcnt(0)
    v_mfma_f32_16x16x32_bf16 v[16:19], v[112:115], v[144:147], v[16:19]
    v_mfma_f32_16x16x32_bf16 v[20:23], v[112:115], v[148:151], v[20:23]
    v_mfma_f32_16x16x32_bf16 v[24:27], v[112:115], v[152:155], v[24:27]
    v_mfma_f32_16x16x32_bf16 v[28:31], v[112:115], v[156:159], v[28:31]
    v_mfma_f32_16x16x32_bf16 v[32:35], v[112:115], v[160:163], v[32:35]
    v_mfma_f32_16x16x32_bf16 v[36:39], v[112:115], v[164:167], v[36:39]
    v_mfma_f32_16x16x32_bf16 v[40:43], v[112:115], v[168:171], v[40:43]
    v_mfma_f32_16x16x32_bf16 v[44:47], v[112:115], v[172:175], v[44:47]
    v_mfma_f32_16x16x32_bf16 v[20:23], v[116:119], v[144:147], v[20:23]
    v_mfma_f32_16x16x32_bf16 v[24:27], v[116:119], v[148:151], v[24:27]
    v_mfma_f32_16x16x32_bf16 v[28:31], v[116:119], v[152:155], v[28:31]
    v_mfma_f32_16x16x32_bf16 v[32:35], v[116:119], v[156:159], v[32:35]
    v_mfma_f32_16x16x32_bf16 v[36:39], v[116:119], v[160:163], v[36:39]
    v_mfma_f32_16x16x32_bf16 v[40:43], v[116:119], v[164:167], v[40:43]
    v_mfma_f32_16x16x32_bf16 v[44:47], v[116:119], v[168:171], v[44:47]
    v_mfma_f32_16x16x32_bf16 v[24:27], v[120:123], v[144:147], v[24:27]
    v_mfma_f32_16x16x32_bf16 v[28:31], v[120:123], v[148:151], v[28:31]
    v_mfma_f32_16x16x32_bf16 v[32:35], v[120:123], v[152:155], v[32:35]
    v_mfma_f32_16x16x32_bf16 v[36:39], v[120:123], v[156:159], v[36:39]
    v_mfma_f32_16x16x32_bf16 v[40:43], v[120:123], v[160:163], v[40:43]
    v_mfma_f32_16x16x32_bf16 v[44:47], v[120:123], v[164:167], v[44:47]
    v_mfma_f32_16x16x32_bf16 v[28:31], v[124:127], v[144:147], v[28:31]
    v_mfma_f32_16x16x32_bf16 v[32:35], v[124:127], v[148:151], v[32:35]
    v_mfma_f32_16x16x32_bf16 v[36:39], v[124:127], v[152:155], v[36:39]
    v_mfma_f32_16x16x32_bf16 v[40:43], v[124:127], v[156:159], v[40:43]
    v_mfma_f32_16x16x32_bf16 v[44:47], v[124:127], v[160:163], v[44:47]
    v_mfma_f32_16x16x32_bf16 v[32:35], v[128:131], v[144:147], v[32:35]
    v_mfma_f32_16x16x32_bf16 v[36:39], v[128:131], v[148:151], v[36:39]
    v_mfma_f32_16x16x32_bf16 v[40:43], v[128:131], v[152:155], v[40:43]
    v_mfma_f32_16x16x32_bf16 v[44:47], v[128:131], v[156:159], v[44:47]
    v_mfma_f32_16x16x32_bf16 v[36:39], v[132:135], v[144:147], v[36:39]
    v_mfma_f32_16x16x32_bf16 v[40:43], v[132:135], v[148:151], v[40:43]
    v_mfma_f32_16x16x32_bf16 v[44:47], v[132:135], v[152:155], v[44:47]
    v_mfma_f32_16x16x32_bf16 v[40:43], v[136:139], v[144:147], v[40:43]
    v_mfma_f32_16x16x32_bf16 v[44:47], v[136:139], v[148:151], v[44:47]
    v_mfma_f32_16x16x32_bf16 v[44:47], v[140:143], v[144:147], v[44:47]
    s_waitcnt lgkmcnt(0)
    s_mov_b32 s57, 1048576
K2_RV2:
    ds_read_b32 v213, v212 offset:8
    s_waitcnt lgkmcnt(0)
    v_cmp_gt_u32 vcc, 4, v213
    s_sub_u32 s57, s57, 1
    s_cmp_eq_u32 s57, 0
    s_cbranch_scc1 K2_RV2_X
    s_nop 0
    s_cbranch_vccnz K2_RV2
K2_RV2_X:
    v_and_b32 v14, 15, v2
    v_lshlrev_b32 v14, 7, v14
    v_lshrrev_b32 v15, 4, v2
    v_lshlrev_b32 v15, 3, v15
    v_add_u32 v14, v14, v15
    s_lshl_b32 s16, s20, 5
    s_add_u32 s16, s16, 52480
    v_add_u32 v14, s16, v14
    ds_read_b64 v[48:49], v209 offset:512
    ds_read_b64 v[50:51], v14 offset:0
    ds_read_b64 v[52:53], v209 offset:1024
    ds_read_b64 v[54:55], v14 offset:2048
    ds_read_b64 v[56:57], v209 offset:1536
    ds_read_b64 v[58:59], v14 offset:4096
    ds_read_b64 v[60:61], v209 offset:2048
    ds_read_b64 v[62:63], v14 offset:6144
    s_waitcnt lgkmcnt(6)
    v_lshlrev_b32 v10, 16, v48
    v_and_b32 v11, 0xffff0000, v48
    v_lshlrev_b32 v12, 16, v49
    v_and_b32 v13, 0xffff0000, v49
    v_fma_f32 v10, v10, s23, v16
    v_fma_f32 v11, v11, s23, v17
    v_fma_f32 v12, v12, s23, v18
    v_fma_f32 v13, v13, s23, v19
    v_lshlrev_b32 v4, 16, v50
    v_and_b32 v5, 0xffff0000, v50
    v_lshlrev_b32 v6, 16, v51
    v_and_b32 v7, 0xffff0000, v51
    v_fma_f32 v10, v10, s26, v4
    v_fma_f32 v11, v11, s26, v5
    v_fma_f32 v12, v12, s26, v6
    v_fma_f32 v13, v13, s26, v7
    v_cvt_pk_bf16_f32 v48, v10, v11
    v_cvt_pk_bf16_f32 v49, v12, v13
    ds_write_b64 v209, v[48:49] offset:4608
    ds_read_b64 v[64:65], v209 offset:2560
    ds_read_b64 v[66:67], v14 offset:8192
    s_waitcnt lgkmcnt(7)
    v_lshlrev_b32 v10, 16, v52
    v_and_b32 v11, 0xffff0000, v52
    v_lshlrev_b32 v12, 16, v53
    v_and_b32 v13, 0xffff0000, v53
    v_fma_f32 v10, v10, s23, v20
    v_fma_f32 v11, v11, s23, v21
    v_fma_f32 v12, v12, s23, v22
    v_fma_f32 v13, v13, s23, v23
    v_lshlrev_b32 v4, 16, v54
    v_and_b32 v5, 0xffff0000, v54
    v_lshlrev_b32 v6, 16, v55
    v_and_b32 v7, 0xffff0000, v55
    v_fma_f32 v10, v10, s26, v4
    v_fma_f32 v11, v11, s26, v5
    v_fma_f32 v12, v12, s26, v6
    v_fma_f32 v13, v13, s26, v7
    v_cvt_pk_bf16_f32 v52, v10, v11
    v_cvt_pk_bf16_f32 v53, v12, v13
    ds_write_b64 v209, v[52:53] offset:5120
    ds_read_b64 v[68:69], v209 offset:3072
    ds_read_b64 v[70:71], v14 offset:10240
    s_waitcnt lgkmcnt(8)
    v_lshlrev_b32 v10, 16, v56
    v_and_b32 v11, 0xffff0000, v56
    v_lshlrev_b32 v12, 16, v57
    v_and_b32 v13, 0xffff0000, v57
    v_fma_f32 v10, v10, s23, v24
    v_fma_f32 v11, v11, s23, v25
    v_fma_f32 v12, v12, s23, v26
    v_fma_f32 v13, v13, s23, v27
    v_lshlrev_b32 v4, 16, v58
    v_and_b32 v5, 0xffff0000, v58
    v_lshlrev_b32 v6, 16, v59
    v_and_b32 v7, 0xffff0000, v59
    v_fma_f32 v10, v10, s26, v4
    v_fma_f32 v11, v11, s26, v5
    v_fma_f32 v12, v12, s26, v6
    v_fma_f32 v13, v13, s26, v7
    v_cvt_pk_bf16_f32 v56, v10, v11
    v_cvt_pk_bf16_f32 v57, v12, v13
    ds_write_b64 v209, v[56:57] offset:5632
    ds_read_b64 v[72:73], v209 offset:3584
    ds_read_b64 v[74:75], v14 offset:12288
    s_waitcnt lgkmcnt(9)
    v_lshlrev_b32 v10, 16, v60
    v_and_b32 v11, 0xffff0000, v60
    v_lshlrev_b32 v12, 16, v61
    v_and_b32 v13, 0xffff0000, v61
    v_fma_f32 v10, v10, s23, v28
    v_fma_f32 v11, v11, s23, v29
    v_fma_f32 v12, v12, s23, v30
    v_fma_f32 v13, v13, s23, v31
    v_lshlrev_b32 v4, 16, v62
    v_and_b32 v5, 0xffff0000, v62
    v_lshlrev_b32 v6, 16, v63
    v_and_b32 v7, 0xffff0000, v63
    v_fma_f32 v10, v10, s26, v4
    v_fma_f32 v11, v11, s26, v5
    v_fma_f32 v12, v12, s26, v6
    v_fma_f32 v13, v13, s26, v7
    v_cvt_pk_bf16_f32 v60, v10, v11
    v_cvt_pk_bf16_f32 v61, v12, v13
    ds_write_b64 v209, v[60:61] offset:6144
    ds_read_b64 v[76:77], v209 offset:4096
    ds_read_b64 v[78:79], v14 offset:14336
    s_waitcnt lgkmcnt(9)
    v_lshlrev_b32 v10, 16, v64
    v_and_b32 v11, 0xffff0000, v64
    v_lshlrev_b32 v12, 16, v65
    v_and_b32 v13, 0xffff0000, v65
    v_fma_f32 v10, v10, s23, v32
    v_fma_f32 v11, v11, s23, v33
    v_fma_f32 v12, v12, s23, v34
    v_fma_f32 v13, v13, s23, v35
    v_lshlrev_b32 v4, 16, v66
    v_and_b32 v5, 0xffff0000, v66
    v_lshlrev_b32 v6, 16, v67
    v_and_b32 v7, 0xffff0000, v67
    v_fma_f32 v10, v10, s26, v4
    v_fma_f32 v11, v11, s26, v5
    v_fma_f32 v12, v12, s26, v6
    v_fma_f32 v13, v13, s26, v7
    v_cvt_pk_bf16_f32 v64, v10, v11
    v_cvt_pk_bf16_f32 v65, v12, v13
    ds_write_b64 v209, v[64:65] offset:6656
    s_waitcnt lgkmcnt(7)
    v_lshlrev_b32 v10, 16, v68
    v_and_b32 v11, 0xffff0000, v68
    v_lshlrev_b32 v12, 16, v69
    v_and_b32 v13, 0xffff0000, v69
    v_fma_f32 v10, v10, s23, v36
    v_fma_f32 v11, v11, s23, v37
    v_fma_f32 v12, v12, s23, v38
    v_fma_f32 v13, v13, s23, v39
    v_lshlrev_b32 v4, 16, v70
    v_and_b32 v5, 0xffff0000, v70
    v_lshlrev_b32 v6, 16, v71
    v_and_b32 v7, 0xffff0000, v71
    v_fma_f32 v10, v10, s26, v4
    v_fma_f32 v11, v11, s26, v5
    v_fma_f32 v12, v12, s26, v6
    v_fma_f32 v13, v13, s26, v7
    v_cvt_pk_bf16_f32 v68, v10, v11
    v_cvt_pk_bf16_f32 v69, v12, v13
    ds_write_b64 v209, v[68:69] offset:7168
    s_waitcnt lgkmcnt(5)
    v_lshlrev_b32 v10, 16, v72
    v_and_b32 v11, 0xffff0000, v72
    v_lshlrev_b32 v12, 16, v73
    v_and_b32 v13, 0xffff0000, v73
    v_fma_f32 v10, v10, s23, v40
    v_fma_f32 v11, v11, s23, v41
    v_fma_f32 v12, v12, s23, v42
    v_fma_f32 v13, v13, s23, v43
    v_lshlrev_b32 v4, 16, v74
    v_and_b32 v5, 0xffff0000, v74
    v_lshlrev_b32 v6, 16, v75
    v_and_b32 v7, 0xffff0000, v75
    v_fma_f32 v10, v10, s26, v4
    v_fma_f32 v11, v11, s26, v5
    v_fma_f32 v12, v12, s26, v6
    v_fma_f32 v13, v13, s26, v7
    v_cvt_pk_bf16_f32 v72, v10, v11
    v_cvt_pk_bf16_f32 v73, v12, v13
    ds_write_b64 v209, v[72:73] offset:7680
    s_waitcnt lgkmcnt(3)
    v_lshlrev_b32 v10, 16, v76
    v_and_b32 v11, 0xffff0000, v76
    v_lshlrev_b32 v12, 16, v77
    v_and_b32 v13, 0xffff0000, v77
    v_fma_f32 v10, v10, s23, v44
    v_fma_f32 v11, v11, s23, v45
    v_fma_f32 v12, v12, s23, v46
    v_fma_f32 v13, v13, s23, v47
    v_lshlrev_b32 v4, 16, v78
    v_and_b32 v5, 0xffff0000, v78
    v_lshlrev_b32 v6, 16, v79
    v_and_b32 v7, 0xffff0000, v79
    v_fma_f32 v10, v10, s26, v4
    v_fma_f32 v11, v11, s26, v5
    v_fma_f32 v12, v12, s26, v6
    v_fma_f32 v13, v13, s26, v7
    v_cvt_pk_bf16_f32 v76, v10, v11
    v_cvt_pk_bf16_f32 v77, v12, v13
    ds_write_b64 v209, v[76:77] offset:8192
    s_waitcnt lgkmcnt(0)
    v_mov_b32 v213, 1
    s_mov_b64 exec, 1
    ds_add_u32 v212, v213 offset:4
    s_mov_b64 exec, -1
    s_mov_b32 s57, 1048576
K2_RV1:
    ds_read_b32 v213, v212 offset:4
    s_waitcnt lgkmcnt(0)
    v_cmp_gt_u32 vcc, 4, v213
    s_sub_u32 s57, s57, 1
    s_cmp_eq_u32 s57, 0
    s_cbranch_scc1 K2_RV1_X
    s_nop 0
    s_cbranch_vccnz K2_RV1
K2_RV1_X:
    v_bfe_u32 v10, v2, 2, 2
    v_mul_u32_u24 v10, 13120, v10
    v_lshrrev_b32 v11, 4, v2
    v_lshlrev_b32 v11, 5, v11
    v_add_u32 v10, v10, v11
    v_and_b32 v11, 3, v2
    v_lshlrev_b32 v11, 3, v11
    v_add_u32 v10, v10, v11
    s_lshl_b32 s16, s20, 10
    v_add_u32 v10, s16, v10
    v_lshlrev_b32 v11, 3, v2
    s_lshl_b32 s16, s2, 14
    s_lshl_b32 s17, s20, 12
    s_add_u32 s16, s16, s17
    s_add_u32 s16, s16, 0x6d2000
    ds_read_b64_tr_b16 v[16:17], v10 offset:4608
    ds_read_b64_tr_b16 v[18:19], v10 offset:4736
    ds_read_b64_tr_b16 v[20:21], v10 offset:4864
    ds_read_b64_tr_b16 v[22:23], v10 offset:4992
    ds_read_b64_tr_b16 v[24:25], v10 offset:5120
    ds_read_b64_tr_b16 v[26:27], v10 offset:5248
    ds_read_b64_tr_b16 v[28:29], v10 offset:5376
    ds_read_b64_tr_b16 v[30:31], v10 offset:5504
    s_waitcnt lgkmcnt(7)
    buffer_store_dwordx2 v[16:17], v11, s[8:11], s16 offen offset:0 sc1
    s_waitcnt lgkmcnt(6)
    buffer_store_dwordx2 v[18:19], v11, s[8:11], s16 offen offset:512 sc1
    s_waitcnt lgkmcnt(5)
    buffer_store_dwordx2 v[20:21], v11, s[8:11], s16 offen offset:1024 sc1
    s_waitcnt lgkmcnt(4)
    buffer_store_dwordx2 v[22:23], v11, s[8:11], s16 offen offset:1536 sc1
    s_waitcnt lgkmcnt(3)
    buffer_store_dwordx2 v[24:25], v11, s[8:11], s16 offen offset:2048 sc1
    s_waitcnt lgkmcnt(2)
    buffer_store_dwordx2 v[26:27], v11, s[8:11], s16 offen offset:2560 sc1
    s_waitcnt lgkmcnt(1)
    buffer_store_dwordx2 v[28:29], v11, s[8:11], s16 offen offset:3072 sc1
    s_waitcnt lgkmcnt(0)
    buffer_store_dwordx2 v[30:31], v11, s[8:11], s16 offen offset:3584 sc1
    s_endpgm
K2_REL:
    s_load_dwordx2 s[40:41], s[0:1], 64
    s_load_dwordx2 s[42:43], s[0:1], 80
    s_sub_u32 s21, s20, 4
    s_lshl_b32 s22, s2, 2
    s_add_u32 s22, s22, s21
    s_mul_i32 s23, s21, 18432
    s_add_u32 s23, s23, 68864
    s_and_b32 s38, s2, 3
    s_lshl_b32 s38, s38, 1
    s_bfe_u32 s39, s2, 0x10002
    s_add_u32 s38, s38, s39
    s_lshr_b32 s39, s2, 3
    s_lshl_b32 s39, s39, 2
    s_add_u32 s39, s39, s21
    s_lshr_b32 s24, s39, 1
    s_and_b32 s25, s39, 1
    s_lshl_b32 s16, s38, 1
    s_add_u32 s25, s25, s16
    s_mul_i32 s26, s24, 147456
    s_mul_i32 s27, s25, 576
    s_add_u32 s26, s26, s27
    s_mul_i32 s27, s25, 9
    s_mul_i32 s27, s27, 36
    s_add_u32 s27, s27, s24
    s_lshl_b32 s27, s27, 10
    s_add_u32 s27, s27, 0xd92000
    s_lshr_b32 s28, s39, 1
    s_mul_i32 s16, s38, 36
    s_add_u32 s28, s28, s16
    s_and_b32 s29, s39, 1
    s_mul_i32 s30, s28, 18432
    s_mul_i32 s31, s29, 576
    s_add_u32 s30, s30, s31
    s_lshr_b32 s31, s28, 1
    s_and_b32 s32, s28, 1
    s_mul_hi_u32 s33, s31, 0x0e38e38f
    s_mul_i32 s34, s33, 18
    s_sub_u32 s34, s31, s34
    s_lshr_b32 s16, s34, 2
    s_and_b32 s17, s34, 3
    s_mul_i32 s35, s16, 3
    s_add_u32 s35, s35, s17
    s_add_u32 s16, s16, 14
    s_cmp_eq_u32 s17, 3
    s_cselect_b32 s35, s16, s35
    s_sub_u32 s16, s34, 4
    s_cmp_ge_u32 s34, 16
    s_cselect_b32 s35, s16, s35
    s_mul_i32 s16, s33, 18
    s_mul_i32 s17, s29, 9
    s_add_u32 s16, s16, s17
    s_mul_i32 s16, s16, 36
    s_lshl_b32 s17, s35, 1
    s_add_u32 s16, s16, s17
    s_add_u32 s16, s16, s32
    s_lshl_b32 s16, s16, 10
    s_add_u32 s36, s16, 0x12a2000
    v_add_u32 v3, 0, v2
    v_mul_u32_u24 v4, 1821, v3
    v_lshrrev_b32 v4, 16, v4
    v_mul_u32_u24 v5, 36, v4
    v_sub_u32 v5, v3, v5
    v_lshlrev_b32 v5, 4, v5
    v_mul_u32_u24 v16, 9216, v4
    v_add_u32 v16, v16, v5
    v_mul_u32_u24 v26, 1152, v4
    v_add_u32 v26, v26, v5
    v_add_u32 v3, 64, v2
    v_mul_u32_u24 v4, 1821, v3
    v_lshrrev_b32 v4, 16, v4
    v_mul_u32_u24 v5, 36, v4
    v_sub_u32 v5, v3, v5
    v_lshlrev_b32 v5, 4, v5
    v_mul_u32_u24 v17, 9216, v4
    v_add_u32 v17, v17, v5
    v_mul_u32_u24 v27, 1152, v4
    v_add_u32 v27, v27, v5
    v_add_u32 v3, 128, v2
    v_mul_u32_u24 v4, 1821, v3
    v_lshrrev_b32 v4, 16, v4
    v_mul_u32_u24 v5, 36, v4
    v_sub_u32 v5, v3, v5
    v_lshlrev_b32 v5, 4, v5
    v_mul_u32_u24 v18, 9216, v4
    v_add_u32 v18, v18, v5
    v_mul_u32_u24 v28, 1152, v4
    v_add_u32 v28, v28, v5
    v_add_u32 v3, 192, v2
    v_mul_u32_u24 v4, 1821, v3
    v_lshrrev_b32 v4, 16, v4
    v_mul_u32_u24 v5, 36, v4
    v_sub_u32 v5, v3, v5
    v_lshlrev_b32 v5, 4, v5
    v_mul_u32_u24 v19, 9216, v4
    v_add_u32 v19, v19, v5
    v_mul_u32_u24 v29, 1152, v4
    v_add_u32 v29, v29, v5
    v_add_u32 v3, 256, v2
    v_mul_u32_u24 v4, 1821, v3
    v_lshrrev_b32 v4, 16, v4
    v_mul_u32_u24 v5, 36, v4
    v_sub_u32 v5, v3, v5
    v_lshlrev_b32 v5, 4, v5
    v_mul_u32_u24 v20, 9216, v4
    v_add_u32 v20, v20, v5
    v_mul_u32_u24 v30, 1152, v4
    v_add_u32 v30, v30, v5
    v_add_u32 v3, 320, v2
    v_mul_u32_u24 v4, 1821, v3
    v_lshrrev_b32 v4, 16, v4
    v_mul_u32_u24 v5, 36, v4
    v_sub_u32 v5, v3, v5
    v_lshlrev_b32 v5, 4, v5
    v_mul_u32_u24 v21, 9216, v4
    v_add_u32 v21, v21, v5
    v_mul_u32_u24 v31, 1152, v4
    v_add_u32 v31, v31, v5
    v_add_u32 v3, 384, v2
    v_mul_u32_u24 v4, 1821, v3
    v_lshrrev_b32 v4, 16, v4
    v_mul_u32_u24 v5, 36, v4
    v_sub_u32 v5, v3, v5
    v_lshlrev_b32 v5, 4, v5
    v_mul_u32_u24 v22, 9216, v4
    v_add_u32 v22, v22, v5
    v_mul_u32_u24 v32, 1152, v4
    v_add_u32 v32, v32, v5
    v_add_u32 v3, 448, v2
    v_mul_u32_u24 v4, 1821, v3
    v_lshrrev_b32 v4, 16, v4
    v_mul_u32_u24 v5, 36, v4
    v_sub_u32 v5, v3, v5
    v_lshlrev_b32 v5, 4, v5
    v_mul_u32_u24 v23, 9216, v4
    v_add_u32 v23, v23, v5
    v_mul_u32_u24 v33, 1152, v4
    v_add_u32 v33, v33, v5
    v_add_u32 v3, 512, v2
    v_mul_u32_u24 v4, 1821, v3
    v_lshrrev_b32 v4, 16, v4
    v_mul_u32_u24 v5, 36, v4
    v_sub_u32 v5, v3, v5
    v_lshlrev_b32 v5, 4, v5
    v_mul_u32_u24 v24, 9216, v4
    v_add_u32 v24, v24, v5
    v_mul_u32_u24 v34, 1152, v4
    v_add_u32 v34, v34, v5
    v_bfe_u32 v5, v2, 4, 1
    v_lshlrev_b32 v5, 5, v5
    v_and_b32 v6, 3, v2
    v_lshlrev_b32 v6, 3, v6
    v_add_u32 v5, v5, v6
    v_add_u32 v5, s23, v5
    v_lshrrev_b32 v6, 5, v2
    v_bfe_u32 v7, v2, 2, 2
    v_lshlrev_b32 v8, 3, v6
    v_add_u32 v8, v8, v7
    v_mul_u32_u24 v8, 576, v8
    v_add_u32 v8, v8, v5
    v_lshlrev_b32 v9, 2, v6
    v_add_u32 v9, v9, v7
    v_mul_u32_u24 v9, 576, v9
    v_add_u32 v9, v9, v5
    v_add_u32 v9, 9216, v9
    v_lshlrev_b32 v10, 4, v2
    s_waitcnt lgkmcnt(0)
    s_mov_b32 s8, s4
    s_and_b32 s9, s5, 0xffff
    s_mov_b32 s10, 0x29ba000
    s_mov_b32 s11, 0x20000
    s_mov_b32 s44, s40
    s_and_b32 s45, s41, 0xffff
    s_mov_b32 s46, 0x510000
    s_mov_b32 s47, 0x20000
    s_mov_b32 s48, s42
    s_and_b32 s49, s43, 0xffff
    s_mov_b32 s50, 0x510000
    s_mov_b32 s51, 0x20000
    s_barrier
    s_add_u32 s37, s23, 0
    s_mov_b32 m0, s37
    s_nop 0
    buffer_load_dwordx4 v16, s[44:47], s26 offen lds
    s_add_u32 s37, s23, 1024
    s_mov_b32 m0, s37
    s_nop 0
    buffer_load_dwordx4 v17, s[44:47], s26 offen lds
    s_add_u32 s37, s23, 2048
    s_mov_b32 m0, s37
    s_nop 0
    buffer_load_dwordx4 v18, s[44:47], s26 offen lds
    s_add_u32 s37, s23, 3072
    s_mov_b32 m0, s37
    s_nop 0
    buffer_load_dwordx4 v19, s[44:47], s26 offen lds
    s_add_u32 s37, s23, 4096
    s_mov_b32 m0, s37
    s_nop 0
    buffer_load_dwordx4 v20, s[44:47], s26 offen lds
    s_add_u32 s37, s23, 5120
    s_mov_b32 m0, s37
    s_nop 0
    buffer_load_dwordx4 v21, s[44:47], s26 offen lds
    s_add_u32 s37, s23, 6144
    s_mov_b32 m0, s37
    s_nop 0
    buffer_load_dwordx4 v22, s[44:47], s26 offen lds
    s_add_u32 s37, s23, 7168
    s_mov_b32 m0, s37
    s_nop 0
    buffer_load_dwordx4 v23, s[44:47], s26 offen lds
    s_add_u32 s37, s23, 8192
    s_mov_b32 m0, s37
    s_nop 0
    buffer_load_dwordx4 v24, s[44:47], s26 offen lds
    s_add_u32 s37, s23, 9216
    s_mov_b32 m0, s37
    s_nop 0
    buffer_load_dwordx4 v26, s[48:51], s30 offen lds
    s_add_u32 s37, s23, 10240
    s_mov_b32 m0, s37
    s_nop 0
    buffer_load_dwordx4 v27, s[48:51], s30 offen lds
    s_add_u32 s37, s23, 11264
    s_mov_b32 m0, s37
    s_nop 0
    buffer_load_dwordx4 v28, s[48:51], s30 offen lds
    s_add_u32 s37, s23, 12288
    s_mov_b32 m0, s37
    s_nop 0
    buffer_load_dwordx4 v29, s[48:51], s30 offen lds
    s_add_u32 s37, s23, 13312
    s_mov_b32 m0, s37
    s_nop 0
    buffer_load_dwordx4 v30, s[48:51], s30 offen lds
    s_add_u32 s37, s23, 14336
    s_mov_b32 m0, s37
    s_nop 0
    buffer_load_dwordx4 v31, s[48:51], s30 offen lds
    s_add_u32 s37, s23, 15360
    s_mov_b32 m0, s37
    s_nop 0
    buffer_load_dwordx4 v32, s[48:51], s30 offen lds
    s_add_u32 s37, s23, 16384
    s_mov_b32 m0, s37
    s_nop 0
    buffer_load_dwordx4 v33, s[48:51], s30 offen lds
    s_add_u32 s37, s23, 17408
    s_mov_b32 m0, s37
    s_nop 0
    buffer_load_dwordx4 v34, s[48:51], s30 offen lds
    s_waitcnt vmcnt(9)
    ds_read_b64_tr_b16 v[36:37], v8 offset:0
    ds_read_b64_tr_b16 v[38:39], v8 offset:2304
    ds_read_b64_tr_b16 v[40:41], v8 offset:64
    ds_read_b64_tr_b16 v[42:43], v8 offset:2368
    ds_read_b64_tr_b16 v[44:45], v8 offset:128
    ds_read_b64_tr_b16 v[46:47], v8 offset:2432
    ds_read_b64_tr_b16 v[48:49], v8 offset:192
    ds_read_b64_tr_b16 v[50:51], v8 offset:2496
    ds_read_b64_tr_b16 v[52:53], v8 offset:256
    ds_read_b64_tr_b16 v[54:55], v8 offset:2560
    s_waitcnt lgkmcnt(8)
    buffer_store_dwordx4 v[36:39], v10, s[8:11], s27 offen sc1
    s_add_u32 s27, s27, 36864
    ds_read_b64_tr_b16 v[36:37], v8 offset:320
    ds_read_b64_tr_b16 v[38:39], v8 offset:2624
    s_waitcnt lgkmcnt(8)
    buffer_store_dwordx4 v[40:43], v10, s[8:11], s27 offen sc1
    s_add_u32 s27, s27, 36864
    ds_read_b64_tr_b16 v[40:41], v8 offset:384
    ds_read_b64_tr_b16 v[42:43], v8 offset:2688
    s_waitcnt lgkmcnt(8)
    buffer_store_dwordx4 v[44:47], v10, s[8:11], s27 offen sc1
    s_add_u32 s27, s27, 36864
    ds_read_b64_tr_b16 v[44:45], v8 offset:448
    ds_read_b64_tr_b16 v[46:47], v8 offset:2752
    s_waitcnt lgkmcnt(8)
    buffer_store_dwordx4 v[48:51], v10, s[8:11], s27 offen sc1
    s_add_u32 s27, s27, 36864
    ds_read_b64_tr_b16 v[48:49], v8 offset:512
    ds_read_b64_tr_b16 v[50:51], v8 offset:2816
    s_waitcnt lgkmcnt(8)
    buffer_store_dwordx4 v[52:55], v10, s[8:11], s27 offen sc1
    s_add_u32 s27, s27, 36864
    s_waitcnt lgkmcnt(6)
    buffer_store_dwordx4 v[36:39], v10, s[8:11], s27 offen sc1
    s_add_u32 s27, s27, 36864
    s_waitcnt lgkmcnt(4)
    buffer_store_dwordx4 v[40:43], v10, s[8:11], s27 offen sc1
    s_add_u32 s27, s27, 36864
    s_waitcnt lgkmcnt(2)
    buffer_store_dwordx4 v[44:47], v10, s[8:11], s27 offen sc1
    s_add_u32 s27, s27, 36864
    s_waitcnt lgkmcnt(0)
    buffer_store_dwordx4 v[48:51], v10, s[8:11], s27 offen sc1
    s_add_u32 s27, s27, 36864
    s_waitcnt vmcnt(9)
    ds_read_b64_tr_b16 v[36:37], v9 offset:0
    ds_read_b64_tr_b16 v[38:39], v9 offset:4608
    ds_read_b64_tr_b16 v[40:41], v9 offset:64
    ds_read_b64_tr_b16 v[42:43], v9 offset:4672
    ds_read_b64_tr_b16 v[44:45], v9 offset:128
    ds_read_b64_tr_b16 v[46:47], v9 offset:4736
    ds_read_b64_tr_b16 v[48:49], v9 offset:192
    ds_read_b64_tr_b16 v[50:51], v9 offset:4800
    ds_read_b64_tr_b16 v[52:53], v9 offset:256
    ds_read_b64_tr_b16 v[54:55], v9 offset:4864
    s_waitcnt lgkmcnt(8)
    buffer_store_dwordx4 v[36:39], v10, s[8:11], s36 offen sc1
    s_add_u32 s36, s36, 36864
    ds_read_b64_tr_b16 v[36:37], v9 offset:320
    ds_read_b64_tr_b16 v[38:39], v9 offset:4928
    s_waitcnt lgkmcnt(8)
    buffer_store_dwordx4 v[40:43], v10, s[8:11], s36 offen sc1
    s_add_u32 s36, s36, 36864
    ds_read_b64_tr_b16 v[40:41], v9 offset:384
    ds_read_b64_tr_b16 v[42:43], v9 offset:4992
    s_waitcnt lgkmcnt(8)
    buffer_store_dwordx4 v[44:47], v10, s[8:11], s36 offen sc1
    s_add_u32 s36, s36, 36864
    ds_read_b64_tr_b16 v[44:45], v9 offset:448
    ds_read_b64_tr_b16 v[46:47], v9 offset:5056
    s_waitcnt lgkmcnt(8)
    buffer_store_dwordx4 v[48:51], v10, s[8:11], s36 offen sc1
    s_add_u32 s36, s36, 36864
    ds_read_b64_tr_b16 v[48:49], v9 offset:512
    ds_read_b64_tr_b16 v[50:51], v9 offset:5120
    s_waitcnt lgkmcnt(8)
    buffer_store_dwordx4 v[52:55], v10, s[8:11], s36 offen sc1
    s_add_u32 s36, s36, 36864
    s_waitcnt lgkmcnt(6)
    buffer_store_dwordx4 v[36:39], v10, s[8:11], s36 offen sc1
    s_add_u32 s36, s36, 36864
    s_waitcnt lgkmcnt(4)
    buffer_store_dwordx4 v[40:43], v10, s[8:11], s36 offen sc1
    s_add_u32 s36, s36, 36864
    s_waitcnt lgkmcnt(2)
    buffer_store_dwordx4 v[44:47], v10, s[8:11], s36 offen sc1
    s_add_u32 s36, s36, 36864
    s_waitcnt lgkmcnt(0)
    buffer_store_dwordx4 v[48:51], v10, s[8:11], s36 offen sc1
    s_add_u32 s36, s36, 36864
K2_END:
    s_endpgm
.globl k4_mlp_kernel
.p2align 8
.type k4_mlp_kernel,@function
k4_mlp_kernel:
    s_cmp_ge_u32 s2, 256
    s_cbranch_scc1 K4_END
    s_load_dwordx2 s[4:5], s[0:1], 128
    s_load_dwordx2 s[6:7], s[0:1], 72
    v_lshrrev_b32 v14, 6, v0
    v_and_b32 v15, 63, v0
    v_readfirstlane_b32 s20, v14
    v_lshlrev_b32 v1, 4, v15
    s_and_b32 s16, s2, 3
    s_lshl_b32 s16, s16, 1
    s_bfe_u32 s17, s2, 0x10003
    s_add_u32 s16, s16, s17
    s_bfe_u32 s17, s2, 0x10002
    s_lshl_b32 s17, s17, 4
    s_lshr_b32 s49, s2, 4
    s_add_u32 s17, s17, s49
    s_and_b32 s18, s20, 1
    s_lshr_b32 s19, s20, 1
    s_mul_i32 s28, s18, -36864
    s_mul_i32 s29, s18, -28672
    s_mul_i32 s30, s18, 18432
    s_mul_i32 s31, s18, -8192
    s_mul_i32 s32, s18, -10240
    s_add_u32 s32, s32, 14336
    s_mul_i32 s42, s18, 18432
    s_sub_u32 s43, 18432, s42
    s_mul_i32 s44, s18, 14336
    s_sub_u32 s45, 14336, s44
    s_lshl_b32 s46, s18, 12
    s_sub_u32 s47, 32768, s46
    s_add_u32 s46, s46, 28672
    s_mul_i32 s33, s16, 18
    s_lshl_b32 s34, s20, 2
    s_add_u32 s34, s34, s33
    s_mul_i32 s34, s34, 36864
    s_add_u32 s35, s33, s19
    s_add_u32 s35, s35, 16
    s_mul_i32 s35, s35, 36864
    s_add_u32 s21, s35, s42
    s_add_u32 s21, s21, 0xd92000
    s_add_u32 s22, s34, s42
    s_add_u32 s22, s22, 0xd92000
    s_add_u32 s23, s34, s44
    s_add_u32 s23, s23, 0x12a2000
    s_add_u32 s24, s35, s44
    s_add_u32 s24, s24, 0x12a2000
    s_lshl_b32 s34, s17, 3
    s_add_u32 s34, s34, s16
    s_mul_i32 s34, s34, 73728
    s_add_u32 s34, s34, 0x17b2000
    s_lshl_b32 s35, s20, 14
    s_add_u32 s35, s35, s34
    s_lshl_b32 s36, s18, 11
    s_add_u32 s25, s35, s36
    s_xor_b32 s36, s36, 2048
    s_add_u32 s26, s35, s36
    s_add_u32 s35, s19, 16
    s_lshl_b32 s35, s35, 12
    s_add_u32 s35, s35, s34
    s_lshl_b32 s36, s18, 11
    s_add_u32 s27, s35, s36
    s_mul_i32 s35, s18, 36864
    s_mul_i32 s36, s19, 18432
    s_add_u32 s36, s36, s35
    s_mul_i32 s37, s17, 73728
    s_add_u32 s37, s37, s36
    s_add_u32 s40, s37, 0xb52000
    s_add_u32 s41, s36, 0
    s_xor_b32 s36, s18, 1
    s_mul_i32 s36, s36, 36864
    v_add_u32 v4, s35, v1
    v_add_u32 v5, s36, v1
    v_add_u32 v2, s42, v4
    v_add_u32 v3, s42, v5
    s_mul_i32 s37, s20, 6144
    s_add_u32 s37, s37, 73728
    v_add_u32 v6, s37, v4
    v_add_u32 v7, s37, v5
    s_lshl_b32 s48, s20, 12
    s_sub_u32 s48, 28672, s48
    s_lshl_b32 s37, s19, 11
    s_add_u32 s37, s37, 98304
    v_add_u32 v8, s37, v4
    s_lshl_b32 s37, s20, 11
    s_add_u32 s37, s37, 102400
    v_add_u32 v12, s37, v1
    s_xor_b32 s37, s20, 1
    s_lshl_b32 s37, s37, 11
    s_add_u32 s37, s37, 102400
    v_add_u32 v13, s37, v1
    v_lshrrev_b32 v14, 5, v15
    v_lshlrev_b32 v14, 6, v14
    s_lshl_b32 s37, s20, 9
    s_add_u32 s37, s37, 147456
    v_add_u32 v9, s37, v14
    s_lshl_b32 s37, s19, 7
    s_add_u32 s37, s37, 149504
    s_cmp_eq_u32 s18, 0
    s_cselect_b32 s37, s37, 149760
    v_add_u32 v10, s37, v14
    v_mov_b32 v11, 0xc0135761
    s_waitcnt lgkmcnt(0)
    s_mov_b32 s8, s4
    s_and_b32 s9, s5, 0xffff
    s_mov_b32 s10, 0x29ba000
    s_mov_b32 s11, 0x20000
    s_mov_b32 s12, s6
    s_and_b32 s13, s7, 0xffff
    s_mov_b32 s14, 0x2400
    s_mov_b32 s15, 0x20000
    s_mul_i32 s37, s16, 1152
    v_lshlrev_b32 v14, 3, v0
    v_add_u32 v14, s37, v14
    buffer_load_dwordx2 v[14:15], v14, s[12:15], 0 offen
    v_lshrrev_b32 v18, 4, v1
    v_and_b32 v16, 15, v18
    v_lshrrev_b32 v17, 4, v18
    s_lshl_b32 s33, s17, 6
    s_lshl_b32 s34, s20, 4
    s_add_u32 s33, s33, s34
    v_add_u32 v18, s33, v16
    v_lshlrev_b32 v18, 3, v18
    v_lshlrev_b32 v19, 15, v17
    v_add_u32 v18, v18, v19
    v_add_u32 v19, 16384, v18
    v_lshlrev_b32 v20, 4, v0
    s_mov_b32 s33, 0xf200
    s_mov_b32 s34, 0xed80
    buffer_load_dwordx4 v[24:27], v20, s[8:11], s33 offen
    buffer_load_dwordx4 v[28:31], v20, s[8:11], s34 offen
    s_mov_b32 s40, 0x6d2000
    buffer_load_dwordx2 v[100:101], v18, s[8:11], s40 offen
    buffer_load_dwordx2 v[102:103], v19, s[8:11], s40 offen
    s_add_u32 s40, s40, 131072
    buffer_load_dwordx2 v[108:109], v18, s[8:11], s40 offen
    buffer_load_dwordx2 v[110:111], v19, s[8:11], s40 offen
    s_add_u32 s40, s40, 131072
    buffer_load_dwordx2 v[116:117], v18, s[8:11], s40 offen
    buffer_load_dwordx2 v[118:119], v19, s[8:11], s40 offen
    s_add_u32 s40, s40, 131072
    buffer_load_dwordx2 v[124:125], v18, s[8:11], s40 offen
    buffer_load_dwordx2 v[126:127], v19, s[8:11], s40 offen
    s_add_u32 s40, s40, 131072
    buffer_load_dwordx2 v[132:133], v18, s[8:11], s40 offen
    buffer_load_dwordx2 v[134:135], v19, s[8:11], s40 offen
    s_add_u32 s40, s40, 131072
    buffer_load_dwordx2 v[140:141], v18, s[8:11], s40 offen
    buffer_load_dwordx2 v[142:143], v19, s[8:11], s40 offen
    s_add_u32 s40, s40, 131072
    buffer_load_dwordx2 v[148:149], v18, s[8:11], s40 offen
    buffer_load_dwordx2 v[150:151], v19, s[8:11], s40 offen
    s_add_u32 s40, s40, 131072
    buffer_load_dwordx2 v[156:157], v18, s[8:11], s40 offen
    buffer_load_dwordx2 v[158:159], v19, s[8:11], s40 offen
    s_add_u32 s40, s40, 131072
    buffer_load_dwordx2 v[164:165], v18, s[8:11], s40 offen
    buffer_load_dwordx2 v[166:167], v19, s[8:11], s40 offen
    s_add_u32 s40, s40, 131072
    buffer_load_dwordx2 v[172:173], v18, s[8:11], s40 offen
    buffer_load_dwordx2 v[174:175], v19, s[8:11], s40 offen
    s_add_u32 s40, s40, 131072
    v_lshrrev_b32 v46, 3, v0
    v_lshlrev_b32 v46, 7, v46
    v_and_b32 v47, 1, v0
    v_lshlrev_b32 v47, 6, v47
    v_add_u32 v46, v46, v47
    v_bfe_u32 v47, v0, 1, 2
    v_lshlrev_b32 v47, 4, v47
    v_add_u32 v46, v46, v47
    v_add_u32 v46, 147456, v46
    s_waitcnt vmcnt(22)
    v_lshlrev_b32 v40, 16, v14
    v_and_b32 v41, 0xffff0000, v14
    v_lshlrev_b32 v42, 16, v15
    v_and_b32 v43, 0xffff0000, v15
    v_cmp_gt_u32 vcc, 144, v0
    s_nop 1
    v_cndmask_b32 v40, 0, v40, vcc
    v_cndmask_b32 v41, 0, v41, vcc
    v_cndmask_b32 v42, 0, v42, vcc
    v_cndmask_b32 v43, 0, v43, vcc
    v_cmp_gt_u32 vcc, 152, v0
    s_nop 3
    s_and_saveexec_b64 s[38:39], vcc
    ds_write_b128 v46, v[40:43]
    s_mov_b64 exec, s[38:39]
    s_waitcnt vmcnt(20)
    v_lshlrev_b32 v32, 16, v24
    v_and_b32 v33, 0xffff0000, v24
    v_lshlrev_b32 v48, 16, v28
    v_and_b32 v49, 0xffff0000, v28
    v_lshlrev_b32 v34, 16, v25
    v_and_b32 v35, 0xffff0000, v25
    v_lshlrev_b32 v50, 16, v29
    v_and_b32 v51, 0xffff0000, v29
    v_lshlrev_b32 v36, 16, v26
    v_and_b32 v37, 0xffff0000, v26
    v_lshlrev_b32 v52, 16, v30
    v_and_b32 v53, 0xffff0000, v30
    v_lshlrev_b32 v38, 16, v27
    v_and_b32 v39, 0xffff0000, v27
    v_lshlrev_b32 v54, 16, v31
    v_and_b32 v55, 0xffff0000, v31
    v_add_f32 v32, 1.0, v32
    v_add_f32 v33, 1.0, v33
    v_cvt_pk_bf16_f32 v24, v32, v33
    v_lshlrev_b32 v32, 16, v24
    v_and_b32 v33, 0xffff0000, v24
    v_add_f32 v34, 1.0, v34
    v_add_f32 v35, 1.0, v35
    v_cvt_pk_bf16_f32 v24, v34, v35
    v_lshlrev_b32 v34, 16, v24
    v_and_b32 v35, 0xffff0000, v24
    v_add_f32 v36, 1.0, v36
    v_add_f32 v37, 1.0, v37
    v_cvt_pk_bf16_f32 v24, v36, v37
    v_lshlrev_b32 v36, 16, v24
    v_and_b32 v37, 0xffff0000, v24
    v_add_f32 v38, 1.0, v38
    v_add_f32 v39, 1.0, v39
    v_cvt_pk_bf16_f32 v24, v38, v39
    v_lshlrev_b32 v38, 16, v24
    v_and_b32 v39, 0xffff0000, v24
    v_lshlrev_b32 v20, 5, v0
    v_add_u32 v20, 73728, v20
    v_cmp_gt_u32 vcc, 72, v0
    s_nop 3
    s_and_saveexec_b64 s[38:39], vcc
    ds_write_b128 v20, v[32:35] offset:0
    ds_write_b128 v20, v[36:39] offset:16
    ds_write_b128 v20, v[48:51] offset:2304
    ds_write_b128 v20, v[52:55] offset:2320
    s_mov_b64 exec, s[38:39]
    s_waitcnt vmcnt(18)
    buffer_load_dwordx2 v[180:181], v18, s[8:11], s40 offen
    buffer_load_dwordx2 v[182:183], v19, s[8:11], s40 offen
    s_add_u32 s40, s40, 131072
    v_lshlrev_b32 v96, 16, v100
    v_and_b32 v97, 0xffff0000, v100
    v_lshlrev_b32 v98, 16, v101
    v_and_b32 v99, 0xffff0000, v101
    v_lshlrev_b32 v100, 16, v102
    v_and_b32 v101, 0xffff0000, v102
    v_lshlrev_b32 v102, 16, v103
    v_and_b32 v103, 0xffff0000, v103
    v_pk_add_f32 v[20:21], v[96:97], v[98:99]
    v_pk_add_f32 v[24:25], v[100:101], v[102:103]
    v_pk_mul_f32 v[22:23], v[96:97], v[96:97]
    v_pk_mul_f32 v[28:29], v[98:99], v[98:99]
    v_pk_fma_f32 v[22:23], v[100:101], v[100:101], v[22:23]
    v_pk_fma_f32 v[28:29], v[102:103], v[102:103], v[28:29]
    s_waitcnt vmcnt(18)
    buffer_load_dwordx2 v[188:189], v18, s[8:11], s40 offen
    buffer_load_dwordx2 v[190:191], v19, s[8:11], s40 offen
    s_add_u32 s40, s40, 131072
    v_lshlrev_b32 v104, 16, v108
    v_and_b32 v105, 0xffff0000, v108
    v_lshlrev_b32 v106, 16, v109
    v_and_b32 v107, 0xffff0000, v109
    v_lshlrev_b32 v108, 16, v110
    v_and_b32 v109, 0xffff0000, v110
    v_lshlrev_b32 v110, 16, v111
    v_and_b32 v111, 0xffff0000, v111
    v_pk_add_f32 v[20:21], v[20:21], v[104:105]
    v_pk_add_f32 v[24:25], v[24:25], v[108:109]
    v_pk_fma_f32 v[22:23], v[104:105], v[104:105], v[22:23]
    v_pk_fma_f32 v[28:29], v[106:107], v[106:107], v[28:29]
    v_pk_add_f32 v[20:21], v[20:21], v[106:107]
    v_pk_add_f32 v[24:25], v[24:25], v[110:111]
    v_pk_fma_f32 v[22:23], v[108:109], v[108:109], v[22:23]
    v_pk_fma_f32 v[28:29], v[110:111], v[110:111], v[28:29]
    s_waitcnt vmcnt(18)
    buffer_load_dwordx2 v[196:197], v18, s[8:11], s40 offen
    buffer_load_dwordx2 v[198:199], v19, s[8:11], s40 offen
    s_add_u32 s40, s40, 131072
    v_lshlrev_b32 v112, 16, v116
    v_and_b32 v113, 0xffff0000, v116
    v_lshlrev_b32 v114, 16, v117
    v_and_b32 v115, 0xffff0000, v117
    v_lshlrev_b32 v116, 16, v118
    v_and_b32 v117, 0xffff0000, v118
    v_lshlrev_b32 v118, 16, v119
    v_and_b32 v119, 0xffff0000, v119
    v_pk_add_f32 v[20:21], v[20:21], v[112:113]
    v_pk_add_f32 v[24:25], v[24:25], v[116:117]
    v_pk_fma_f32 v[22:23], v[112:113], v[112:113], v[22:23]
    v_pk_fma_f32 v[28:29], v[114:115], v[114:115], v[28:29]
    v_pk_add_f32 v[20:21], v[20:21], v[114:115]
    v_pk_add_f32 v[24:25], v[24:25], v[118:119]
    v_pk_fma_f32 v[22:23], v[116:117], v[116:117], v[22:23]
    v_pk_fma_f32 v[28:29], v[118:119], v[118:119], v[28:29]
    s_waitcnt vmcnt(18)
    buffer_load_dwordx2 v[204:205], v18, s[8:11], s40 offen
    buffer_load_dwordx2 v[206:207], v19, s[8:11], s40 offen
    s_add_u32 s40, s40, 131072
    v_lshlrev_b32 v120, 16, v124
    v_and_b32 v121, 0xffff0000, v124
    v_lshlrev_b32 v122, 16, v125
    v_and_b32 v123, 0xffff0000, v125
    v_lshlrev_b32 v124, 16, v126
    v_and_b32 v125, 0xffff0000, v126
    v_lshlrev_b32 v126, 16, v127
    v_and_b32 v127, 0xffff0000, v127
    v_pk_add_f32 v[20:21], v[20:21], v[120:121]
    v_pk_add_f32 v[24:25], v[24:25], v[124:125]
    v_pk_fma_f32 v[22:23], v[120:121], v[120:121], v[22:23]
    v_pk_fma_f32 v[28:29], v[122:123], v[122:123], v[28:29]
    v_pk_add_f32 v[20:21], v[20:21], v[122:123]
    v_pk_add_f32 v[24:25], v[24:25], v[126:127]
    v_pk_fma_f32 v[22:23], v[124:125], v[124:125], v[22:23]
    v_pk_fma_f32 v[28:29], v[126:127], v[126:127], v[28:29]
    s_waitcnt vmcnt(18)
    buffer_load_dwordx2 v[212:213], v18, s[8:11], s40 offen
    buffer_load_dwordx2 v[214:215], v19, s[8:11], s40 offen
    s_add_u32 s40, s40, 131072
    v_lshlrev_b32 v128, 16, v132
    v_and_b32 v129, 0xffff0000, v132
    v_lshlrev_b32 v130, 16, v133
    v_and_b32 v131, 0xffff0000, v133
    v_lshlrev_b32 v132, 16, v134
    v_and_b32 v133, 0xffff0000, v134
    v_lshlrev_b32 v134, 16, v135
    v_and_b32 v135, 0xffff0000, v135
    v_pk_add_f32 v[20:21], v[20:21], v[128:129]
    v_pk_add_f32 v[24:25], v[24:25], v[132:133]
    v_pk_fma_f32 v[22:23], v[128:129], v[128:129], v[22:23]
    v_pk_fma_f32 v[28:29], v[130:131], v[130:131], v[28:29]
    v_pk_add_f32 v[20:21], v[20:21], v[130:131]
    v_pk_add_f32 v[24:25], v[24:25], v[134:135]
    v_pk_fma_f32 v[22:23], v[132:133], v[132:133], v[22:23]
    v_pk_fma_f32 v[28:29], v[134:135], v[134:135], v[28:29]
    s_waitcnt vmcnt(18)
    buffer_load_dwordx2 v[220:221], v18, s[8:11], s40 offen
    buffer_load_dwordx2 v[222:223], v19, s[8:11], s40 offen
    s_add_u32 s40, s40, 131072
    v_lshlrev_b32 v136, 16, v140
    v_and_b32 v137, 0xffff0000, v140
    v_lshlrev_b32 v138, 16, v141
    v_and_b32 v139, 0xffff0000, v141
    v_lshlrev_b32 v140, 16, v142
    v_and_b32 v141, 0xffff0000, v142
    v_lshlrev_b32 v142, 16, v143
    v_and_b32 v143, 0xffff0000, v143
    v_pk_add_f32 v[20:21], v[20:21], v[136:137]
    v_pk_add_f32 v[24:25], v[24:25], v[140:141]
    v_pk_fma_f32 v[22:23], v[136:137], v[136:137], v[22:23]
    v_pk_fma_f32 v[28:29], v[138:139], v[138:139], v[28:29]
    v_pk_add_f32 v[20:21], v[20:21], v[138:139]
    v_pk_add_f32 v[24:25], v[24:25], v[142:143]
    v_pk_fma_f32 v[22:23], v[140:141], v[140:141], v[22:23]
    v_pk_fma_f32 v[28:29], v[142:143], v[142:143], v[28:29]
    s_waitcnt vmcnt(18)
    buffer_load_dwordx2 v[228:229], v18, s[8:11], s40 offen
    buffer_load_dwordx2 v[230:231], v19, s[8:11], s40 offen
    s_add_u32 s40, s40, 131072
    v_lshlrev_b32 v144, 16, v148
    v_and_b32 v145, 0xffff0000, v148
    v_lshlrev_b32 v146, 16, v149
    v_and_b32 v147, 0xffff0000, v149
    v_lshlrev_b32 v148, 16, v150
    v_and_b32 v149, 0xffff0000, v150
    v_lshlrev_b32 v150, 16, v151
    v_and_b32 v151, 0xffff0000, v151
    v_pk_add_f32 v[20:21], v[20:21], v[144:145]
    v_pk_add_f32 v[24:25], v[24:25], v[148:149]
    v_pk_fma_f32 v[22:23], v[144:145], v[144:145], v[22:23]
    v_pk_fma_f32 v[28:29], v[146:147], v[146:147], v[28:29]
    v_pk_add_f32 v[20:21], v[20:21], v[146:147]
    v_pk_add_f32 v[24:25], v[24:25], v[150:151]
    v_pk_fma_f32 v[22:23], v[148:149], v[148:149], v[22:23]
    v_pk_fma_f32 v[28:29], v[150:151], v[150:151], v[28:29]
    s_waitcnt vmcnt(18)
    buffer_load_dwordx2 v[236:237], v18, s[8:11], s40 offen
    buffer_load_dwordx2 v[238:239], v19, s[8:11], s40 offen
    v_lshlrev_b32 v152, 16, v156
    v_and_b32 v153, 0xffff0000, v156
    v_lshlrev_b32 v154, 16, v157
    v_and_b32 v155, 0xffff0000, v157
    v_lshlrev_b32 v156, 16, v158
    v_and_b32 v157, 0xffff0000, v158
    v_lshlrev_b32 v158, 16, v159
    v_and_b32 v159, 0xffff0000, v159
    v_pk_add_f32 v[20:21], v[20:21], v[152:153]
    v_pk_add_f32 v[24:25], v[24:25], v[156:157]
    v_pk_fma_f32 v[22:23], v[152:153], v[152:153], v[22:23]
    v_pk_fma_f32 v[28:29], v[154:155], v[154:155], v[28:29]
    v_pk_add_f32 v[20:21], v[20:21], v[154:155]
    v_pk_add_f32 v[24:25], v[24:25], v[158:159]
    v_pk_fma_f32 v[22:23], v[156:157], v[156:157], v[22:23]
    v_pk_fma_f32 v[28:29], v[158:159], v[158:159], v[28:29]
    s_waitcnt vmcnt(18)
    v_lshlrev_b32 v160, 16, v164
    v_and_b32 v161, 0xffff0000, v164
    v_lshlrev_b32 v162, 16, v165
    v_and_b32 v163, 0xffff0000, v165
    v_lshlrev_b32 v164, 16, v166
    v_and_b32 v165, 0xffff0000, v166
    v_lshlrev_b32 v166, 16, v167
    v_and_b32 v167, 0xffff0000, v167
    v_pk_add_f32 v[20:21], v[20:21], v[160:161]
    v_pk_add_f32 v[24:25], v[24:25], v[164:165]
    v_pk_fma_f32 v[22:23], v[160:161], v[160:161], v[22:23]
    v_pk_fma_f32 v[28:29], v[162:163], v[162:163], v[28:29]
    v_pk_add_f32 v[20:21], v[20:21], v[162:163]
    v_pk_add_f32 v[24:25], v[24:25], v[166:167]
    v_pk_fma_f32 v[22:23], v[164:165], v[164:165], v[22:23]
    v_pk_fma_f32 v[28:29], v[166:167], v[166:167], v[28:29]
    s_waitcnt vmcnt(16)
    v_lshlrev_b32 v168, 16, v172
    v_and_b32 v169, 0xffff0000, v172
    v_lshlrev_b32 v170, 16, v173
    v_and_b32 v171, 0xffff0000, v173
    v_lshlrev_b32 v172, 16, v174
    v_and_b32 v173, 0xffff0000, v174
    v_lshlrev_b32 v174, 16, v175
    v_and_b32 v175, 0xffff0000, v175
    v_pk_add_f32 v[20:21], v[20:21], v[168:169]
    v_pk_add_f32 v[24:25], v[24:25], v[172:173]
    v_pk_fma_f32 v[22:23], v[168:169], v[168:169], v[22:23]
    v_pk_fma_f32 v[28:29], v[170:171], v[170:171], v[28:29]
    v_pk_add_f32 v[20:21], v[20:21], v[170:171]
    v_pk_add_f32 v[24:25], v[24:25], v[174:175]
    v_pk_fma_f32 v[22:23], v[172:173], v[172:173], v[22:23]
    v_pk_fma_f32 v[28:29], v[174:175], v[174:175], v[28:29]
    s_waitcnt vmcnt(14)
    v_lshlrev_b32 v176, 16, v180
    v_and_b32 v177, 0xffff0000, v180
    v_lshlrev_b32 v178, 16, v181
    v_and_b32 v179, 0xffff0000, v181
    v_lshlrev_b32 v180, 16, v182
    v_and_b32 v181, 0xffff0000, v182
    v_lshlrev_b32 v182, 16, v183
    v_and_b32 v183, 0xffff0000, v183
    v_pk_add_f32 v[20:21], v[20:21], v[176:177]
    v_pk_add_f32 v[24:25], v[24:25], v[180:181]
    v_pk_fma_f32 v[22:23], v[176:177], v[176:177], v[22:23]
    v_pk_fma_f32 v[28:29], v[178:179], v[178:179], v[28:29]
    v_pk_add_f32 v[20:21], v[20:21], v[178:179]
    v_pk_add_f32 v[24:25], v[24:25], v[182:183]
    v_pk_fma_f32 v[22:23], v[180:181], v[180:181], v[22:23]
    v_pk_fma_f32 v[28:29], v[182:183], v[182:183], v[28:29]
    s_waitcnt vmcnt(12)
    v_lshlrev_b32 v184, 16, v188
    v_and_b32 v185, 0xffff0000, v188
    v_lshlrev_b32 v186, 16, v189
    v_and_b32 v187, 0xffff0000, v189
    v_lshlrev_b32 v188, 16, v190
    v_and_b32 v189, 0xffff0000, v190
    v_lshlrev_b32 v190, 16, v191
    v_and_b32 v191, 0xffff0000, v191
    v_pk_add_f32 v[20:21], v[20:21], v[184:185]
    v_pk_add_f32 v[24:25], v[24:25], v[188:189]
    v_pk_fma_f32 v[22:23], v[184:185], v[184:185], v[22:23]
    v_pk_fma_f32 v[28:29], v[186:187], v[186:187], v[28:29]
    v_pk_add_f32 v[20:21], v[20:21], v[186:187]
    v_pk_add_f32 v[24:25], v[24:25], v[190:191]
    v_pk_fma_f32 v[22:23], v[188:189], v[188:189], v[22:23]
    v_pk_fma_f32 v[28:29], v[190:191], v[190:191], v[28:29]
    s_waitcnt vmcnt(10)
    v_lshlrev_b32 v192, 16, v196
    v_and_b32 v193, 0xffff0000, v196
    v_lshlrev_b32 v194, 16, v197
    v_and_b32 v195, 0xffff0000, v197
    v_lshlrev_b32 v196, 16, v198
    v_and_b32 v197, 0xffff0000, v198
    v_lshlrev_b32 v198, 16, v199
    v_and_b32 v199, 0xffff0000, v199
    v_pk_add_f32 v[20:21], v[20:21], v[192:193]
    v_pk_add_f32 v[24:25], v[24:25], v[196:197]
    v_pk_fma_f32 v[22:23], v[192:193], v[192:193], v[22:23]
    v_pk_fma_f32 v[28:29], v[194:195], v[194:195], v[28:29]
    v_pk_add_f32 v[20:21], v[20:21], v[194:195]
    v_pk_add_f32 v[24:25], v[24:25], v[198:199]
    v_pk_fma_f32 v[22:23], v[196:197], v[196:197], v[22:23]
    v_pk_fma_f32 v[28:29], v[198:199], v[198:199], v[28:29]
    s_waitcnt vmcnt(8)
    v_lshlrev_b32 v200, 16, v204
    v_and_b32 v201, 0xffff0000, v204
    v_lshlrev_b32 v202, 16, v205
    v_and_b32 v203, 0xffff0000, v205
    v_lshlrev_b32 v204, 16, v206
    v_and_b32 v205, 0xffff0000, v206
    v_lshlrev_b32 v206, 16, v207
    v_and_b32 v207, 0xffff0000, v207
    v_pk_add_f32 v[20:21], v[20:21], v[200:201]
    v_pk_add_f32 v[24:25], v[24:25], v[204:205]
    v_pk_fma_f32 v[22:23], v[200:201], v[200:201], v[22:23]
    v_pk_fma_f32 v[28:29], v[202:203], v[202:203], v[28:29]
    v_pk_add_f32 v[20:21], v[20:21], v[202:203]
    v_pk_add_f32 v[24:25], v[24:25], v[206:207]
    v_pk_fma_f32 v[22:23], v[204:205], v[204:205], v[22:23]
    v_pk_fma_f32 v[28:29], v[206:207], v[206:207], v[28:29]
    s_waitcnt vmcnt(6)
    v_lshlrev_b32 v208, 16, v212
    v_and_b32 v209, 0xffff0000, v212
    v_lshlrev_b32 v210, 16, v213
    v_and_b32 v211, 0xffff0000, v213
    v_lshlrev_b32 v212, 16, v214
    v_and_b32 v213, 0xffff0000, v214
    v_lshlrev_b32 v214, 16, v215
    v_and_b32 v215, 0xffff0000, v215
    v_pk_add_f32 v[20:21], v[20:21], v[208:209]
    v_pk_add_f32 v[24:25], v[24:25], v[212:213]
    v_pk_fma_f32 v[22:23], v[208:209], v[208:209], v[22:23]
    v_pk_fma_f32 v[28:29], v[210:211], v[210:211], v[28:29]
    v_pk_add_f32 v[20:21], v[20:21], v[210:211]
    v_pk_add_f32 v[24:25], v[24:25], v[214:215]
    v_pk_fma_f32 v[22:23], v[212:213], v[212:213], v[22:23]
    v_pk_fma_f32 v[28:29], v[214:215], v[214:215], v[28:29]
    s_waitcnt vmcnt(4)
    v_lshlrev_b32 v216, 16, v220
    v_and_b32 v217, 0xffff0000, v220
    v_lshlrev_b32 v218, 16, v221
    v_and_b32 v219, 0xffff0000, v221
    v_lshlrev_b32 v220, 16, v222
    v_and_b32 v221, 0xffff0000, v222
    v_lshlrev_b32 v222, 16, v223
    v_and_b32 v223, 0xffff0000, v223
    v_pk_add_f32 v[20:21], v[20:21], v[216:217]
    v_pk_add_f32 v[24:25], v[24:25], v[220:221]
    v_pk_fma_f32 v[22:23], v[216:217], v[216:217], v[22:23]
    v_pk_fma_f32 v[28:29], v[218:219], v[218:219], v[28:29]
    v_pk_add_f32 v[20:21], v[20:21], v[218:219]
    v_pk_add_f32 v[24:25], v[24:25], v[222:223]
    v_pk_fma_f32 v[22:23], v[220:221], v[220:221], v[22:23]
    v_pk_fma_f32 v[28:29], v[222:223], v[222:223], v[28:29]
    s_waitcnt vmcnt(2)
    v_lshlrev_b32 v224, 16, v228
    v_and_b32 v225, 0xffff0000, v228
    v_lshlrev_b32 v226, 16, v229
    v_and_b32 v227, 0xffff0000, v229
    v_lshlrev_b32 v228, 16, v230
    v_and_b32 v229, 0xffff0000, v230
    v_lshlrev_b32 v230, 16, v231
    v_and_b32 v231, 0xffff0000, v231
    v_pk_add_f32 v[20:21], v[20:21], v[224:225]
    v_pk_add_f32 v[24:25], v[24:25], v[228:229]
    v_pk_fma_f32 v[22:23], v[224:225], v[224:225], v[22:23]
    v_pk_fma_f32 v[28:29], v[226:227], v[226:227], v[28:29]
    v_pk_add_f32 v[20:21], v[20:21], v[226:227]
    v_pk_add_f32 v[24:25], v[24:25], v[230:231]
    v_pk_fma_f32 v[22:23], v[228:229], v[228:229], v[22:23]
    v_pk_fma_f32 v[28:29], v[230:231], v[230:231], v[28:29]
    s_waitcnt vmcnt(0)
    v_lshlrev_b32 v232, 16, v236
    v_and_b32 v233, 0xffff0000, v236
    v_lshlrev_b32 v234, 16, v237
    v_and_b32 v235, 0xffff0000, v237
    v_lshlrev_b32 v236, 16, v238
    v_and_b32 v237, 0xffff0000, v238
    v_lshlrev_b32 v238, 16, v239
    v_and_b32 v239, 0xffff0000, v239
    v_pk_add_f32 v[20:21], v[20:21], v[232:233]
    v_pk_add_f32 v[24:25], v[24:25], v[236:237]
    v_pk_fma_f32 v[22:23], v[232:233], v[232:233], v[22:23]
    v_pk_fma_f32 v[28:29], v[234:235], v[234:235], v[28:29]
    v_pk_add_f32 v[20:21], v[20:21], v[234:235]
    v_pk_add_f32 v[24:25], v[24:25], v[238:239]
    v_pk_fma_f32 v[22:23], v[236:237], v[236:237], v[22:23]
    v_pk_fma_f32 v[28:29], v[238:239], v[238:239], v[28:29]
    s_waitcnt lgkmcnt(0)
    s_barrier
    v_lshlrev_b32 v26, 5, v17
    v_add_u32 v26, 73728, v26
    ds_read_b128 v[32:35], v26 offset:0
    ds_read_b128 v[36:39], v26 offset:16
    ds_read_b128 v[40:43], v26 offset:2304
    ds_read_b128 v[44:47], v26 offset:2320
    ds_read_b128 v[48:51], v26 offset:128
    ds_read_b128 v[52:55], v26 offset:144
    ds_read_b128 v[56:59], v26 offset:2432
    ds_read_b128 v[60:63], v26 offset:2448
    v_pk_add_f32 v[20:21], v[20:21], v[24:25]
    v_pk_add_f32 v[22:23], v[22:23], v[28:29]
    v_add_f32 v20, v20, v21
    v_mov_b32 v21, v20
    s_nop 1
    v_permlane16_swap_b32 v20, v21
    v_add_f32 v20, v20, v21
    v_mov_b32 v21, v20
    s_nop 1
    v_permlane32_swap_b32 v20, v21
    v_add_f32 v20, v20, v21
    v_mul_f32 v20, 0x3ae38e39, v20
    v_add_f32 v22, v22, v23
    v_mov_b32 v23, v22
    s_nop 1
    v_permlane16_swap_b32 v22, v23
    v_add_f32 v22, v22, v23
    v_mov_b32 v23, v22
    s_nop 1
    v_permlane32_swap_b32 v22, v23
    v_add_f32 v22, v22, v23
    v_mul_f32 v22, 0x3ae38e39, v22
    v_fma_f32 v22, -v20, v20, v22
    v_max_f32 v22, 0, v22
    v_add_f32 v22, 0x3727c5ac, v22
    v_rsq_f32 v22, v22
    v_mov_b32 v21, v20
    v_mov_b32 v23, v22
    v_mov_b32 v30, v20
    v_mov_b32 v31, v20
    v_mov_b32 v82, v22
    v_mov_b32 v83, v22
    ds_read_b128 v[64:67], v26 offset:256
    ds_read_b128 v[68:71], v26 offset:272
    ds_read_b128 v[72:75], v26 offset:2560
    ds_read_b128 v[76:79], v26 offset:2576
    buffer_load_dwordx4 a[72:75], v1, s[8:11], s21 offen offset:0
    s_waitcnt lgkmcnt(8)
    v_pk_mul_f32 v[32:33], v[32:33], v[82:83]
    v_pk_mul_f32 v[34:35], v[34:35], v[82:83]
    v_pk_mul_f32 v[36:37], v[36:37], v[82:83]
    v_pk_mul_f32 v[38:39], v[38:39], v[82:83]
    v_pk_fma_f32 v[40:41], v[32:33], v[30:31], v[40:41] neg_lo:[1,0,0] neg_hi:[1,0,0]
    v_pk_fma_f32 v[42:43], v[34:35], v[30:31], v[42:43] neg_lo:[1,0,0] neg_hi:[1,0,0]
    v_pk_fma_f32 v[44:45], v[36:37], v[30:31], v[44:45] neg_lo:[1,0,0] neg_hi:[1,0,0]
    v_pk_fma_f32 v[46:47], v[38:39], v[30:31], v[46:47] neg_lo:[1,0,0] neg_hi:[1,0,0]
    v_pk_fma_f32 v[96:97], v[96:97], v[32:33], v[40:41]
    v_pk_fma_f32 v[98:99], v[98:99], v[34:35], v[42:43]
    v_pk_fma_f32 v[100:101], v[100:101], v[36:37], v[44:45]
    v_pk_fma_f32 v[102:103], v[102:103], v[38:39], v[46:47]
    v_pk_add_f32 v[20:21], v[96:97], v[98:99]
    v_pk_add_f32 v[24:25], v[100:101], v[102:103]
    v_pk_mul_f32 v[22:23], v[96:97], v[96:97]
    v_pk_mul_f32 v[28:29], v[98:99], v[98:99]
    v_pk_fma_f32 v[22:23], v[100:101], v[100:101], v[22:23]
    v_pk_fma_f32 v[28:29], v[102:103], v[102:103], v[28:29]
    ds_read_b128 v[32:35], v26 offset:384
    ds_read_b128 v[36:39], v26 offset:400
    ds_read_b128 v[40:43], v26 offset:2688
    ds_read_b128 v[44:47], v26 offset:2704
    buffer_load_dwordx4 a[76:79], v1, s[8:11], s21 offen offset:1024
    s_waitcnt lgkmcnt(8)
    v_pk_mul_f32 v[48:49], v[48:49], v[82:83]
    v_pk_mul_f32 v[50:51], v[50:51], v[82:83]
    v_pk_mul_f32 v[52:53], v[52:53], v[82:83]
    v_pk_mul_f32 v[54:55], v[54:55], v[82:83]
    v_pk_fma_f32 v[56:57], v[48:49], v[30:31], v[56:57] neg_lo:[1,0,0] neg_hi:[1,0,0]
    v_pk_fma_f32 v[58:59], v[50:51], v[30:31], v[58:59] neg_lo:[1,0,0] neg_hi:[1,0,0]
    v_pk_fma_f32 v[60:61], v[52:53], v[30:31], v[60:61] neg_lo:[1,0,0] neg_hi:[1,0,0]
    v_pk_fma_f32 v[62:63], v[54:55], v[30:31], v[62:63] neg_lo:[1,0,0] neg_hi:[1,0,0]
    v_pk_fma_f32 v[104:105], v[104:105], v[48:49], v[56:57]
    v_pk_fma_f32 v[106:107], v[106:107], v[50:51], v[58:59]
    v_pk_fma_f32 v[108:109], v[108:109], v[52:53], v[60:61]
    v_pk_fma_f32 v[110:111], v[110:111], v[54:55], v[62:63]
    v_pk_add_f32 v[20:21], v[20:21], v[104:105]
    v_pk_add_f32 v[24:25], v[24:25], v[108:109]
    v_pk_fma_f32 v[22:23], v[104:105], v[104:105], v[22:23]
    v_pk_fma_f32 v[28:29], v[106:107], v[106:107], v[28:29]
    v_pk_add_f32 v[20:21], v[20:21], v[106:107]
    v_pk_add_f32 v[24:25], v[24:25], v[110:111]
    v_pk_fma_f32 v[22:23], v[108:109], v[108:109], v[22:23]
    v_pk_fma_f32 v[28:29], v[110:111], v[110:111], v[28:29]
    ds_read_b128 v[48:51], v26 offset:512
    ds_read_b128 v[52:55], v26 offset:528
    ds_read_b128 v[56:59], v26 offset:2816
    ds_read_b128 v[60:63], v26 offset:2832
    buffer_load_dwordx4 a[80:83], v1, s[8:11], s21 offen offset:2048
    s_waitcnt lgkmcnt(8)
    v_pk_mul_f32 v[64:65], v[64:65], v[82:83]
    v_pk_mul_f32 v[66:67], v[66:67], v[82:83]
    v_pk_mul_f32 v[68:69], v[68:69], v[82:83]
    v_pk_mul_f32 v[70:71], v[70:71], v[82:83]
    v_pk_fma_f32 v[72:73], v[64:65], v[30:31], v[72:73] neg_lo:[1,0,0] neg_hi:[1,0,0]
    v_pk_fma_f32 v[74:75], v[66:67], v[30:31], v[74:75] neg_lo:[1,0,0] neg_hi:[1,0,0]
    v_pk_fma_f32 v[76:77], v[68:69], v[30:31], v[76:77] neg_lo:[1,0,0] neg_hi:[1,0,0]
    v_pk_fma_f32 v[78:79], v[70:71], v[30:31], v[78:79] neg_lo:[1,0,0] neg_hi:[1,0,0]
    v_pk_fma_f32 v[112:113], v[112:113], v[64:65], v[72:73]
    v_pk_fma_f32 v[114:115], v[114:115], v[66:67], v[74:75]
    v_pk_fma_f32 v[116:117], v[116:117], v[68:69], v[76:77]
    v_pk_fma_f32 v[118:119], v[118:119], v[70:71], v[78:79]
    v_pk_add_f32 v[20:21], v[20:21], v[112:113]
    v_pk_add_f32 v[24:25], v[24:25], v[116:117]
    v_pk_fma_f32 v[22:23], v[112:113], v[112:113], v[22:23]
    v_pk_fma_f32 v[28:29], v[114:115], v[114:115], v[28:29]
    v_pk_add_f32 v[20:21], v[20:21], v[114:115]
    v_pk_add_f32 v[24:25], v[24:25], v[118:119]
    v_pk_fma_f32 v[22:23], v[116:117], v[116:117], v[22:23]
    v_pk_fma_f32 v[28:29], v[118:119], v[118:119], v[28:29]
    ds_read_b128 v[64:67], v26 offset:640
    ds_read_b128 v[68:71], v26 offset:656
    ds_read_b128 v[72:75], v26 offset:2944
    ds_read_b128 v[76:79], v26 offset:2960
    buffer_load_dwordx4 a[84:87], v1, s[8:11], s21 offen offset:3072
    s_add_u32 s21, s21, 4096
    s_waitcnt lgkmcnt(8)
    v_pk_mul_f32 v[32:33], v[32:33], v[82:83]
    v_pk_mul_f32 v[34:35], v[34:35], v[82:83]
    v_pk_mul_f32 v[36:37], v[36:37], v[82:83]
    v_pk_mul_f32 v[38:39], v[38:39], v[82:83]
    v_pk_fma_f32 v[40:41], v[32:33], v[30:31], v[40:41] neg_lo:[1,0,0] neg_hi:[1,0,0]
    v_pk_fma_f32 v[42:43], v[34:35], v[30:31], v[42:43] neg_lo:[1,0,0] neg_hi:[1,0,0]
    v_pk_fma_f32 v[44:45], v[36:37], v[30:31], v[44:45] neg_lo:[1,0,0] neg_hi:[1,0,0]
    v_pk_fma_f32 v[46:47], v[38:39], v[30:31], v[46:47] neg_lo:[1,0,0] neg_hi:[1,0,0]
    v_pk_fma_f32 v[120:121], v[120:121], v[32:33], v[40:41]
    v_pk_fma_f32 v[122:123], v[122:123], v[34:35], v[42:43]
    v_pk_fma_f32 v[124:125], v[124:125], v[36:37], v[44:45]
    v_pk_fma_f32 v[126:127], v[126:127], v[38:39], v[46:47]
    v_pk_add_f32 v[20:21], v[20:21], v[120:121]
    v_pk_add_f32 v[24:25], v[24:25], v[124:125]
    v_pk_fma_f32 v[22:23], v[120:121], v[120:121], v[22:23]
    v_pk_fma_f32 v[28:29], v[122:123], v[122:123], v[28:29]
    v_pk_add_f32 v[20:21], v[20:21], v[122:123]
    v_pk_add_f32 v[24:25], v[24:25], v[126:127]
    v_pk_fma_f32 v[22:23], v[124:125], v[124:125], v[22:23]
    v_pk_fma_f32 v[28:29], v[126:127], v[126:127], v[28:29]
    ds_read_b128 v[32:35], v26 offset:768
    ds_read_b128 v[36:39], v26 offset:784
    ds_read_b128 v[40:43], v26 offset:3072
    ds_read_b128 v[44:47], v26 offset:3088
    buffer_load_dwordx4 a[88:91], v1, s[8:11], s21 offen offset:0
    s_waitcnt lgkmcnt(8)
    v_pk_mul_f32 v[48:49], v[48:49], v[82:83]
    v_pk_mul_f32 v[50:51], v[50:51], v[82:83]
    v_pk_mul_f32 v[52:53], v[52:53], v[82:83]
    v_pk_mul_f32 v[54:55], v[54:55], v[82:83]
    v_pk_fma_f32 v[56:57], v[48:49], v[30:31], v[56:57] neg_lo:[1,0,0] neg_hi:[1,0,0]
    v_pk_fma_f32 v[58:59], v[50:51], v[30:31], v[58:59] neg_lo:[1,0,0] neg_hi:[1,0,0]
    v_pk_fma_f32 v[60:61], v[52:53], v[30:31], v[60:61] neg_lo:[1,0,0] neg_hi:[1,0,0]
    v_pk_fma_f32 v[62:63], v[54:55], v[30:31], v[62:63] neg_lo:[1,0,0] neg_hi:[1,0,0]
    v_pk_fma_f32 v[128:129], v[128:129], v[48:49], v[56:57]
    v_pk_fma_f32 v[130:131], v[130:131], v[50:51], v[58:59]
    v_pk_fma_f32 v[132:133], v[132:133], v[52:53], v[60:61]
    v_pk_fma_f32 v[134:135], v[134:135], v[54:55], v[62:63]
    v_pk_add_f32 v[20:21], v[20:21], v[128:129]
    v_pk_add_f32 v[24:25], v[24:25], v[132:133]
    v_pk_fma_f32 v[22:23], v[128:129], v[128:129], v[22:23]
    v_pk_fma_f32 v[28:29], v[130:131], v[130:131], v[28:29]
    v_pk_add_f32 v[20:21], v[20:21], v[130:131]
    v_pk_add_f32 v[24:25], v[24:25], v[134:135]
    v_pk_fma_f32 v[22:23], v[132:133], v[132:133], v[22:23]
    v_pk_fma_f32 v[28:29], v[134:135], v[134:135], v[28:29]
    ds_read_b128 v[48:51], v26 offset:896
    ds_read_b128 v[52:55], v26 offset:912
    ds_read_b128 v[56:59], v26 offset:3200
    ds_read_b128 v[60:63], v26 offset:3216
    buffer_load_dwordx4 a[92:95], v1, s[8:11], s21 offen offset:1024
    s_waitcnt lgkmcnt(8)
    v_pk_mul_f32 v[64:65], v[64:65], v[82:83]
    v_pk_mul_f32 v[66:67], v[66:67], v[82:83]
    v_pk_mul_f32 v[68:69], v[68:69], v[82:83]
    v_pk_mul_f32 v[70:71], v[70:71], v[82:83]
    v_pk_fma_f32 v[72:73], v[64:65], v[30:31], v[72:73] neg_lo:[1,0,0] neg_hi:[1,0,0]
    v_pk_fma_f32 v[74:75], v[66:67], v[30:31], v[74:75] neg_lo:[1,0,0] neg_hi:[1,0,0]
    v_pk_fma_f32 v[76:77], v[68:69], v[30:31], v[76:77] neg_lo:[1,0,0] neg_hi:[1,0,0]
    v_pk_fma_f32 v[78:79], v[70:71], v[30:31], v[78:79] neg_lo:[1,0,0] neg_hi:[1,0,0]
    v_pk_fma_f32 v[136:137], v[136:137], v[64:65], v[72:73]
    v_pk_fma_f32 v[138:139], v[138:139], v[66:67], v[74:75]
    v_pk_fma_f32 v[140:141], v[140:141], v[68:69], v[76:77]
    v_pk_fma_f32 v[142:143], v[142:143], v[70:71], v[78:79]
    v_pk_add_f32 v[20:21], v[20:21], v[136:137]
    v_pk_add_f32 v[24:25], v[24:25], v[140:141]
    v_pk_fma_f32 v[22:23], v[136:137], v[136:137], v[22:23]
    v_pk_fma_f32 v[28:29], v[138:139], v[138:139], v[28:29]
    v_pk_add_f32 v[20:21], v[20:21], v[138:139]
    v_pk_add_f32 v[24:25], v[24:25], v[142:143]
    v_pk_fma_f32 v[22:23], v[140:141], v[140:141], v[22:23]
    v_pk_fma_f32 v[28:29], v[142:143], v[142:143], v[28:29]
    ds_read_b128 v[64:67], v26 offset:1024
    ds_read_b128 v[68:71], v26 offset:1040
    ds_read_b128 v[72:75], v26 offset:3328
    ds_read_b128 v[76:79], v26 offset:3344
    buffer_load_dwordx4 a[96:99], v1, s[8:11], s21 offen offset:2048
    s_waitcnt lgkmcnt(8)
    v_pk_mul_f32 v[32:33], v[32:33], v[82:83]
    v_pk_mul_f32 v[34:35], v[34:35], v[82:83]
    v_pk_mul_f32 v[36:37], v[36:37], v[82:83]
    v_pk_mul_f32 v[38:39], v[38:39], v[82:83]
    v_pk_fma_f32 v[40:41], v[32:33], v[30:31], v[40:41] neg_lo:[1,0,0] neg_hi:[1,0,0]
    v_pk_fma_f32 v[42:43], v[34:35], v[30:31], v[42:43] neg_lo:[1,0,0] neg_hi:[1,0,0]
    v_pk_fma_f32 v[44:45], v[36:37], v[30:31], v[44:45] neg_lo:[1,0,0] neg_hi:[1,0,0]
    v_pk_fma_f32 v[46:47], v[38:39], v[30:31], v[46:47] neg_lo:[1,0,0] neg_hi:[1,0,0]
    v_pk_fma_f32 v[144:145], v[144:145], v[32:33], v[40:41]
    v_pk_fma_f32 v[146:147], v[146:147], v[34:35], v[42:43]
    v_pk_fma_f32 v[148:149], v[148:149], v[36:37], v[44:45]
    v_pk_fma_f32 v[150:151], v[150:151], v[38:39], v[46:47]
    v_pk_add_f32 v[20:21], v[20:21], v[144:145]
    v_pk_add_f32 v[24:25], v[24:25], v[148:149]
    v_pk_fma_f32 v[22:23], v[144:145], v[144:145], v[22:23]
    v_pk_fma_f32 v[28:29], v[146:147], v[146:147], v[28:29]
    v_pk_add_f32 v[20:21], v[20:21], v[146:147]
    v_pk_add_f32 v[24:25], v[24:25], v[150:151]
    v_pk_fma_f32 v[22:23], v[148:149], v[148:149], v[22:23]
    v_pk_fma_f32 v[28:29], v[150:151], v[150:151], v[28:29]
    ds_read_b128 v[32:35], v26 offset:1152
    ds_read_b128 v[36:39], v26 offset:1168
    ds_read_b128 v[40:43], v26 offset:3456
    ds_read_b128 v[44:47], v26 offset:3472
    buffer_load_dwordx4 a[100:103], v1, s[8:11], s21 offen offset:3072
    s_add_u32 s21, s21, 4096
    s_waitcnt lgkmcnt(8)
    v_pk_mul_f32 v[48:49], v[48:49], v[82:83]
    v_pk_mul_f32 v[50:51], v[50:51], v[82:83]
    v_pk_mul_f32 v[52:53], v[52:53], v[82:83]
    v_pk_mul_f32 v[54:55], v[54:55], v[82:83]
    v_pk_fma_f32 v[56:57], v[48:49], v[30:31], v[56:57] neg_lo:[1,0,0] neg_hi:[1,0,0]
    v_pk_fma_f32 v[58:59], v[50:51], v[30:31], v[58:59] neg_lo:[1,0,0] neg_hi:[1,0,0]
    v_pk_fma_f32 v[60:61], v[52:53], v[30:31], v[60:61] neg_lo:[1,0,0] neg_hi:[1,0,0]
    v_pk_fma_f32 v[62:63], v[54:55], v[30:31], v[62:63] neg_lo:[1,0,0] neg_hi:[1,0,0]
    v_pk_fma_f32 v[152:153], v[152:153], v[48:49], v[56:57]
    v_pk_fma_f32 v[154:155], v[154:155], v[50:51], v[58:59]
    v_pk_fma_f32 v[156:157], v[156:157], v[52:53], v[60:61]
    v_pk_fma_f32 v[158:159], v[158:159], v[54:55], v[62:63]
    v_pk_add_f32 v[20:21], v[20:21], v[152:153]
    v_pk_add_f32 v[24:25], v[24:25], v[156:157]
    v_pk_fma_f32 v[22:23], v[152:153], v[152:153], v[22:23]
    v_pk_fma_f32 v[28:29], v[154:155], v[154:155], v[28:29]
    v_pk_add_f32 v[20:21], v[20:21], v[154:155]
    v_pk_add_f32 v[24:25], v[24:25], v[158:159]
    v_pk_fma_f32 v[22:23], v[156:157], v[156:157], v[22:23]
    v_pk_fma_f32 v[28:29], v[158:159], v[158:159], v[28:29]
    ds_read_b128 v[48:51], v26 offset:1280
    ds_read_b128 v[52:55], v26 offset:1296
    ds_read_b128 v[56:59], v26 offset:3584
    ds_read_b128 v[60:63], v26 offset:3600
    buffer_load_dwordx4 a[104:107], v1, s[8:11], s21 offen offset:0
    s_waitcnt lgkmcnt(8)
    v_pk_mul_f32 v[64:65], v[64:65], v[82:83]
    v_pk_mul_f32 v[66:67], v[66:67], v[82:83]
    v_pk_mul_f32 v[68:69], v[68:69], v[82:83]
    v_pk_mul_f32 v[70:71], v[70:71], v[82:83]
    v_pk_fma_f32 v[72:73], v[64:65], v[30:31], v[72:73] neg_lo:[1,0,0] neg_hi:[1,0,0]
    v_pk_fma_f32 v[74:75], v[66:67], v[30:31], v[74:75] neg_lo:[1,0,0] neg_hi:[1,0,0]
    v_pk_fma_f32 v[76:77], v[68:69], v[30:31], v[76:77] neg_lo:[1,0,0] neg_hi:[1,0,0]
    v_pk_fma_f32 v[78:79], v[70:71], v[30:31], v[78:79] neg_lo:[1,0,0] neg_hi:[1,0,0]
    v_pk_fma_f32 v[160:161], v[160:161], v[64:65], v[72:73]
    v_pk_fma_f32 v[162:163], v[162:163], v[66:67], v[74:75]
    v_pk_fma_f32 v[164:165], v[164:165], v[68:69], v[76:77]
    v_pk_fma_f32 v[166:167], v[166:167], v[70:71], v[78:79]
    v_pk_add_f32 v[20:21], v[20:21], v[160:161]
    v_pk_add_f32 v[24:25], v[24:25], v[164:165]
    v_pk_fma_f32 v[22:23], v[160:161], v[160:161], v[22:23]
    v_pk_fma_f32 v[28:29], v[162:163], v[162:163], v[28:29]
    v_pk_add_f32 v[20:21], v[20:21], v[162:163]
    v_pk_add_f32 v[24:25], v[24:25], v[166:167]
    v_pk_fma_f32 v[22:23], v[164:165], v[164:165], v[22:23]
    v_pk_fma_f32 v[28:29], v[166:167], v[166:167], v[28:29]
    ds_read_b128 v[64:67], v26 offset:1408
    ds_read_b128 v[68:71], v26 offset:1424
    ds_read_b128 v[72:75], v26 offset:3712
    ds_read_b128 v[76:79], v26 offset:3728
    buffer_load_dwordx4 a[108:111], v1, s[8:11], s21 offen offset:1024
    s_waitcnt lgkmcnt(8)
    v_pk_mul_f32 v[32:33], v[32:33], v[82:83]
    v_pk_mul_f32 v[34:35], v[34:35], v[82:83]
    v_pk_mul_f32 v[36:37], v[36:37], v[82:83]
    v_pk_mul_f32 v[38:39], v[38:39], v[82:83]
    v_pk_fma_f32 v[40:41], v[32:33], v[30:31], v[40:41] neg_lo:[1,0,0] neg_hi:[1,0,0]
    v_pk_fma_f32 v[42:43], v[34:35], v[30:31], v[42:43] neg_lo:[1,0,0] neg_hi:[1,0,0]
    v_pk_fma_f32 v[44:45], v[36:37], v[30:31], v[44:45] neg_lo:[1,0,0] neg_hi:[1,0,0]
    v_pk_fma_f32 v[46:47], v[38:39], v[30:31], v[46:47] neg_lo:[1,0,0] neg_hi:[1,0,0]
    v_pk_fma_f32 v[168:169], v[168:169], v[32:33], v[40:41]
    v_pk_fma_f32 v[170:171], v[170:171], v[34:35], v[42:43]
    v_pk_fma_f32 v[172:173], v[172:173], v[36:37], v[44:45]
    v_pk_fma_f32 v[174:175], v[174:175], v[38:39], v[46:47]
    v_pk_add_f32 v[20:21], v[20:21], v[168:169]
    v_pk_add_f32 v[24:25], v[24:25], v[172:173]
    v_pk_fma_f32 v[22:23], v[168:169], v[168:169], v[22:23]
    v_pk_fma_f32 v[28:29], v[170:171], v[170:171], v[28:29]
    v_pk_add_f32 v[20:21], v[20:21], v[170:171]
    v_pk_add_f32 v[24:25], v[24:25], v[174:175]
    v_pk_fma_f32 v[22:23], v[172:173], v[172:173], v[22:23]
    v_pk_fma_f32 v[28:29], v[174:175], v[174:175], v[28:29]
    ds_read_b128 v[32:35], v26 offset:1536
    ds_read_b128 v[36:39], v26 offset:1552
    ds_read_b128 v[40:43], v26 offset:3840
    ds_read_b128 v[44:47], v26 offset:3856
    buffer_load_dwordx4 a[112:115], v1, s[8:11], s21 offen offset:2048
    s_waitcnt lgkmcnt(8)
    v_pk_mul_f32 v[48:49], v[48:49], v[82:83]
    v_pk_mul_f32 v[50:51], v[50:51], v[82:83]
    v_pk_mul_f32 v[52:53], v[52:53], v[82:83]
    v_pk_mul_f32 v[54:55], v[54:55], v[82:83]
    v_pk_fma_f32 v[56:57], v[48:49], v[30:31], v[56:57] neg_lo:[1,0,0] neg_hi:[1,0,0]
    v_pk_fma_f32 v[58:59], v[50:51], v[30:31], v[58:59] neg_lo:[1,0,0] neg_hi:[1,0,0]
    v_pk_fma_f32 v[60:61], v[52:53], v[30:31], v[60:61] neg_lo:[1,0,0] neg_hi:[1,0,0]
    v_pk_fma_f32 v[62:63], v[54:55], v[30:31], v[62:63] neg_lo:[1,0,0] neg_hi:[1,0,0]
    v_pk_fma_f32 v[176:177], v[176:177], v[48:49], v[56:57]
    v_pk_fma_f32 v[178:179], v[178:179], v[50:51], v[58:59]
    v_pk_fma_f32 v[180:181], v[180:181], v[52:53], v[60:61]
    v_pk_fma_f32 v[182:183], v[182:183], v[54:55], v[62:63]
    v_pk_add_f32 v[20:21], v[20:21], v[176:177]
    v_pk_add_f32 v[24:25], v[24:25], v[180:181]
    v_pk_fma_f32 v[22:23], v[176:177], v[176:177], v[22:23]
    v_pk_fma_f32 v[28:29], v[178:179], v[178:179], v[28:29]
    v_pk_add_f32 v[20:21], v[20:21], v[178:179]
    v_pk_add_f32 v[24:25], v[24:25], v[182:183]
    v_pk_fma_f32 v[22:23], v[180:181], v[180:181], v[22:23]
    v_pk_fma_f32 v[28:29], v[182:183], v[182:183], v[28:29]
    ds_read_b128 v[48:51], v26 offset:1664
    ds_read_b128 v[52:55], v26 offset:1680
    ds_read_b128 v[56:59], v26 offset:3968
    ds_read_b128 v[60:63], v26 offset:3984
    buffer_load_dwordx4 a[116:119], v1, s[8:11], s21 offen offset:3072
    s_add_u32 s21, s21, 4096
    s_waitcnt lgkmcnt(8)
    v_pk_mul_f32 v[64:65], v[64:65], v[82:83]
    v_pk_mul_f32 v[66:67], v[66:67], v[82:83]
    v_pk_mul_f32 v[68:69], v[68:69], v[82:83]
    v_pk_mul_f32 v[70:71], v[70:71], v[82:83]
    v_pk_fma_f32 v[72:73], v[64:65], v[30:31], v[72:73] neg_lo:[1,0,0] neg_hi:[1,0,0]
    v_pk_fma_f32 v[74:75], v[66:67], v[30:31], v[74:75] neg_lo:[1,0,0] neg_hi:[1,0,0]
    v_pk_fma_f32 v[76:77], v[68:69], v[30:31], v[76:77] neg_lo:[1,0,0] neg_hi:[1,0,0]
    v_pk_fma_f32 v[78:79], v[70:71], v[30:31], v[78:79] neg_lo:[1,0,0] neg_hi:[1,0,0]
    v_pk_fma_f32 v[184:185], v[184:185], v[64:65], v[72:73]
    v_pk_fma_f32 v[186:187], v[186:187], v[66:67], v[74:75]
    v_pk_fma_f32 v[188:189], v[188:189], v[68:69], v[76:77]
    v_pk_fma_f32 v[190:191], v[190:191], v[70:71], v[78:79]
    v_pk_add_f32 v[20:21], v[20:21], v[184:185]
    v_pk_add_f32 v[24:25], v[24:25], v[188:189]
    v_pk_fma_f32 v[22:23], v[184:185], v[184:185], v[22:23]
    v_pk_fma_f32 v[28:29], v[186:187], v[186:187], v[28:29]
    v_pk_add_f32 v[20:21], v[20:21], v[186:187]
    v_pk_add_f32 v[24:25], v[24:25], v[190:191]
    v_pk_fma_f32 v[22:23], v[188:189], v[188:189], v[22:23]
    v_pk_fma_f32 v[28:29], v[190:191], v[190:191], v[28:29]
    ds_read_b128 v[64:67], v26 offset:1792
    ds_read_b128 v[68:71], v26 offset:1808
    ds_read_b128 v[72:75], v26 offset:4096
    ds_read_b128 v[76:79], v26 offset:4112
    buffer_load_dwordx4 a[120:123], v1, s[8:11], s21 offen offset:0
    s_waitcnt lgkmcnt(8)
    v_pk_mul_f32 v[32:33], v[32:33], v[82:83]
    v_pk_mul_f32 v[34:35], v[34:35], v[82:83]
    v_pk_mul_f32 v[36:37], v[36:37], v[82:83]
    v_pk_mul_f32 v[38:39], v[38:39], v[82:83]
    v_pk_fma_f32 v[40:41], v[32:33], v[30:31], v[40:41] neg_lo:[1,0,0] neg_hi:[1,0,0]
    v_pk_fma_f32 v[42:43], v[34:35], v[30:31], v[42:43] neg_lo:[1,0,0] neg_hi:[1,0,0]
    v_pk_fma_f32 v[44:45], v[36:37], v[30:31], v[44:45] neg_lo:[1,0,0] neg_hi:[1,0,0]
    v_pk_fma_f32 v[46:47], v[38:39], v[30:31], v[46:47] neg_lo:[1,0,0] neg_hi:[1,0,0]
    v_pk_fma_f32 v[192:193], v[192:193], v[32:33], v[40:41]
    v_pk_fma_f32 v[194:195], v[194:195], v[34:35], v[42:43]
    v_pk_fma_f32 v[196:197], v[196:197], v[36:37], v[44:45]
    v_pk_fma_f32 v[198:199], v[198:199], v[38:39], v[46:47]
    v_pk_add_f32 v[20:21], v[20:21], v[192:193]
    v_pk_add_f32 v[24:25], v[24:25], v[196:197]
    v_pk_fma_f32 v[22:23], v[192:193], v[192:193], v[22:23]
    v_pk_fma_f32 v[28:29], v[194:195], v[194:195], v[28:29]
    v_pk_add_f32 v[20:21], v[20:21], v[194:195]
    v_pk_add_f32 v[24:25], v[24:25], v[198:199]
    v_pk_fma_f32 v[22:23], v[196:197], v[196:197], v[22:23]
    v_pk_fma_f32 v[28:29], v[198:199], v[198:199], v[28:29]
    ds_read_b128 v[32:35], v26 offset:1920
    ds_read_b128 v[36:39], v26 offset:1936
    ds_read_b128 v[40:43], v26 offset:4224
    ds_read_b128 v[44:47], v26 offset:4240
    buffer_load_dwordx4 a[124:127], v1, s[8:11], s21 offen offset:1024
    s_waitcnt lgkmcnt(8)
    v_pk_mul_f32 v[48:49], v[48:49], v[82:83]
    v_pk_mul_f32 v[50:51], v[50:51], v[82:83]
    v_pk_mul_f32 v[52:53], v[52:53], v[82:83]
    v_pk_mul_f32 v[54:55], v[54:55], v[82:83]
    v_pk_fma_f32 v[56:57], v[48:49], v[30:31], v[56:57] neg_lo:[1,0,0] neg_hi:[1,0,0]
    v_pk_fma_f32 v[58:59], v[50:51], v[30:31], v[58:59] neg_lo:[1,0,0] neg_hi:[1,0,0]
    v_pk_fma_f32 v[60:61], v[52:53], v[30:31], v[60:61] neg_lo:[1,0,0] neg_hi:[1,0,0]
    v_pk_fma_f32 v[62:63], v[54:55], v[30:31], v[62:63] neg_lo:[1,0,0] neg_hi:[1,0,0]
    v_pk_fma_f32 v[200:201], v[200:201], v[48:49], v[56:57]
    v_pk_fma_f32 v[202:203], v[202:203], v[50:51], v[58:59]
    v_pk_fma_f32 v[204:205], v[204:205], v[52:53], v[60:61]
    v_pk_fma_f32 v[206:207], v[206:207], v[54:55], v[62:63]
    v_pk_add_f32 v[20:21], v[20:21], v[200:201]
    v_pk_add_f32 v[24:25], v[24:25], v[204:205]
    v_pk_fma_f32 v[22:23], v[200:201], v[200:201], v[22:23]
    v_pk_fma_f32 v[28:29], v[202:203], v[202:203], v[28:29]
    v_pk_add_f32 v[20:21], v[20:21], v[202:203]
    v_pk_add_f32 v[24:25], v[24:25], v[206:207]
    v_pk_fma_f32 v[22:23], v[204:205], v[204:205], v[22:23]
    v_pk_fma_f32 v[28:29], v[206:207], v[206:207], v[28:29]
    ds_read_b128 v[48:51], v26 offset:2048
    ds_read_b128 v[52:55], v26 offset:2064
    ds_read_b128 v[56:59], v26 offset:4352
    ds_read_b128 v[60:63], v26 offset:4368
    buffer_load_dwordx4 a[128:131], v1, s[8:11], s21 offen offset:2048
    s_waitcnt lgkmcnt(8)
    v_pk_mul_f32 v[64:65], v[64:65], v[82:83]
    v_pk_mul_f32 v[66:67], v[66:67], v[82:83]
    v_pk_mul_f32 v[68:69], v[68:69], v[82:83]
    v_pk_mul_f32 v[70:71], v[70:71], v[82:83]
    v_pk_fma_f32 v[72:73], v[64:65], v[30:31], v[72:73] neg_lo:[1,0,0] neg_hi:[1,0,0]
    v_pk_fma_f32 v[74:75], v[66:67], v[30:31], v[74:75] neg_lo:[1,0,0] neg_hi:[1,0,0]
    v_pk_fma_f32 v[76:77], v[68:69], v[30:31], v[76:77] neg_lo:[1,0,0] neg_hi:[1,0,0]
    v_pk_fma_f32 v[78:79], v[70:71], v[30:31], v[78:79] neg_lo:[1,0,0] neg_hi:[1,0,0]
    v_pk_fma_f32 v[208:209], v[208:209], v[64:65], v[72:73]
    v_pk_fma_f32 v[210:211], v[210:211], v[66:67], v[74:75]
    v_pk_fma_f32 v[212:213], v[212:213], v[68:69], v[76:77]
    v_pk_fma_f32 v[214:215], v[214:215], v[70:71], v[78:79]
    v_pk_add_f32 v[20:21], v[20:21], v[208:209]
    v_pk_add_f32 v[24:25], v[24:25], v[212:213]
    v_pk_fma_f32 v[22:23], v[208:209], v[208:209], v[22:23]
    v_pk_fma_f32 v[28:29], v[210:211], v[210:211], v[28:29]
    v_pk_add_f32 v[20:21], v[20:21], v[210:211]
    v_pk_add_f32 v[24:25], v[24:25], v[214:215]
    v_pk_fma_f32 v[22:23], v[212:213], v[212:213], v[22:23]
    v_pk_fma_f32 v[28:29], v[214:215], v[214:215], v[28:29]
    ds_read_b128 v[64:67], v26 offset:2176
    ds_read_b128 v[68:71], v26 offset:2192
    ds_read_b128 v[72:75], v26 offset:4480
    ds_read_b128 v[76:79], v26 offset:4496
    buffer_load_dwordx4 a[132:135], v1, s[8:11], s21 offen offset:3072
    s_add_u32 s21, s21, 4096
    s_waitcnt lgkmcnt(8)
    v_pk_mul_f32 v[32:33], v[32:33], v[82:83]
    v_pk_mul_f32 v[34:35], v[34:35], v[82:83]
    v_pk_mul_f32 v[36:37], v[36:37], v[82:83]
    v_pk_mul_f32 v[38:39], v[38:39], v[82:83]
    v_pk_fma_f32 v[40:41], v[32:33], v[30:31], v[40:41] neg_lo:[1,0,0] neg_hi:[1,0,0]
    v_pk_fma_f32 v[42:43], v[34:35], v[30:31], v[42:43] neg_lo:[1,0,0] neg_hi:[1,0,0]
    v_pk_fma_f32 v[44:45], v[36:37], v[30:31], v[44:45] neg_lo:[1,0,0] neg_hi:[1,0,0]
    v_pk_fma_f32 v[46:47], v[38:39], v[30:31], v[46:47] neg_lo:[1,0,0] neg_hi:[1,0,0]
    v_pk_fma_f32 v[216:217], v[216:217], v[32:33], v[40:41]
    v_pk_fma_f32 v[218:219], v[218:219], v[34:35], v[42:43]
    v_pk_fma_f32 v[220:221], v[220:221], v[36:37], v[44:45]
    v_pk_fma_f32 v[222:223], v[222:223], v[38:39], v[46:47]
    v_pk_add_f32 v[20:21], v[20:21], v[216:217]
    v_pk_add_f32 v[24:25], v[24:25], v[220:221]
    v_pk_fma_f32 v[22:23], v[216:217], v[216:217], v[22:23]
    v_pk_fma_f32 v[28:29], v[218:219], v[218:219], v[28:29]
    v_pk_add_f32 v[20:21], v[20:21], v[218:219]
    v_pk_add_f32 v[24:25], v[24:25], v[222:223]
    v_pk_fma_f32 v[22:23], v[220:221], v[220:221], v[22:23]
    v_pk_fma_f32 v[28:29], v[222:223], v[222:223], v[28:29]
    buffer_load_dwordx4 a[136:139], v1, s[8:11], s21 offen offset:0
    s_waitcnt lgkmcnt(4)
    v_pk_mul_f32 v[48:49], v[48:49], v[82:83]
    v_pk_mul_f32 v[50:51], v[50:51], v[82:83]
    v_pk_mul_f32 v[52:53], v[52:53], v[82:83]
    v_pk_mul_f32 v[54:55], v[54:55], v[82:83]
    v_pk_fma_f32 v[56:57], v[48:49], v[30:31], v[56:57] neg_lo:[1,0,0] neg_hi:[1,0,0]
    v_pk_fma_f32 v[58:59], v[50:51], v[30:31], v[58:59] neg_lo:[1,0,0] neg_hi:[1,0,0]
    v_pk_fma_f32 v[60:61], v[52:53], v[30:31], v[60:61] neg_lo:[1,0,0] neg_hi:[1,0,0]
    v_pk_fma_f32 v[62:63], v[54:55], v[30:31], v[62:63] neg_lo:[1,0,0] neg_hi:[1,0,0]
    v_pk_fma_f32 v[224:225], v[224:225], v[48:49], v[56:57]
    v_pk_fma_f32 v[226:227], v[226:227], v[50:51], v[58:59]
    v_pk_fma_f32 v[228:229], v[228:229], v[52:53], v[60:61]
    v_pk_fma_f32 v[230:231], v[230:231], v[54:55], v[62:63]
    v_pk_add_f32 v[20:21], v[20:21], v[224:225]
    v_pk_add_f32 v[24:25], v[24:25], v[228:229]
    v_pk_fma_f32 v[22:23], v[224:225], v[224:225], v[22:23]
    v_pk_fma_f32 v[28:29], v[226:227], v[226:227], v[28:29]
    v_pk_add_f32 v[20:21], v[20:21], v[226:227]
    v_pk_add_f32 v[24:25], v[24:25], v[230:231]
    v_pk_fma_f32 v[22:23], v[228:229], v[228:229], v[22:23]
    v_pk_fma_f32 v[28:29], v[230:231], v[230:231], v[28:29]
    buffer_load_dwordx4 a[140:143], v1, s[8:11], s21 offen offset:1024
    s_waitcnt lgkmcnt(0)
    v_pk_mul_f32 v[64:65], v[64:65], v[82:83]
    v_pk_mul_f32 v[66:67], v[66:67], v[82:83]
    v_pk_mul_f32 v[68:69], v[68:69], v[82:83]
    v_pk_mul_f32 v[70:71], v[70:71], v[82:83]
    v_pk_fma_f32 v[72:73], v[64:65], v[30:31], v[72:73] neg_lo:[1,0,0] neg_hi:[1,0,0]
    v_pk_fma_f32 v[74:75], v[66:67], v[30:31], v[74:75] neg_lo:[1,0,0] neg_hi:[1,0,0]
    v_pk_fma_f32 v[76:77], v[68:69], v[30:31], v[76:77] neg_lo:[1,0,0] neg_hi:[1,0,0]
    v_pk_fma_f32 v[78:79], v[70:71], v[30:31], v[78:79] neg_lo:[1,0,0] neg_hi:[1,0,0]
    v_pk_fma_f32 v[232:233], v[232:233], v[64:65], v[72:73]
    v_pk_fma_f32 v[234:235], v[234:235], v[66:67], v[74:75]
    v_pk_fma_f32 v[236:237], v[236:237], v[68:69], v[76:77]
    v_pk_fma_f32 v[238:239], v[238:239], v[70:71], v[78:79]
    v_pk_add_f32 v[20:21], v[20:21], v[232:233]
    v_pk_add_f32 v[24:25], v[24:25], v[236:237]
    v_pk_fma_f32 v[22:23], v[232:233], v[232:233], v[22:23]
    v_pk_fma_f32 v[28:29], v[234:235], v[234:235], v[28:29]
    v_pk_add_f32 v[20:21], v[20:21], v[234:235]
    v_pk_add_f32 v[24:25], v[24:25], v[238:239]
    v_pk_fma_f32 v[22:23], v[236:237], v[236:237], v[22:23]
    v_pk_fma_f32 v[28:29], v[238:239], v[238:239], v[28:29]
    v_pk_add_f32 v[20:21], v[20:21], v[24:25]
    v_pk_add_f32 v[22:23], v[22:23], v[28:29]
    v_add_f32 v20, v20, v21
    v_mov_b32 v21, v20
    s_nop 1
    v_permlane16_swap_b32 v20, v21
    v_add_f32 v20, v20, v21
    v_mov_b32 v21, v20
    s_nop 1
    v_permlane32_swap_b32 v20, v21
    v_add_f32 v20, v20, v21
    v_mul_f32 v20, 0x3ae38e39, v20
    v_add_f32 v22, v22, v23
    v_mov_b32 v23, v22
    s_nop 1
    v_permlane16_swap_b32 v22, v23
    v_add_f32 v22, v22, v23
    v_mov_b32 v23, v22
    s_nop 1
    v_permlane32_swap_b32 v22, v23
    v_add_f32 v22, v22, v23
    v_mul_f32 v22, 0x3ae38e39, v22
    v_fma_f32 v22, -v20, v20, v22
    v_max_f32 v22, 0, v22
    v_add_f32 v22, 0x3727c5ac, v22
    v_rsq_f32 v22, v22
    v_mov_b32 v21, v20
    v_mov_b32 v23, v22
    v_mul_f32 v20, v20, v22
    v_mov_b32 v21, v20
    v_lshrrev_b32 v26, 1, v17
    v_lshlrev_b32 v26, 10, v26
    v_and_b32 v27, 1, v17
    v_lshlrev_b32 v27, 9, v27
    v_add_u32 v26, v26, v27
    v_lshlrev_b32 v27, 4, v16
    v_add_u32 v26, v26, v27
    s_lshr_b32 s33, s20, 1
    s_mul_i32 s33, s33, 36864
    s_and_b32 s34, s20, 1
    s_lshl_b32 s34, s34, 8
    s_add_u32 s33, s33, s34
    s_add_u32 s33, s33, 0
    v_add_u32 v26, s33, v26
    v_pk_fma_f32 v[144:145], v[144:145], v[22:23], v[20:21] neg_lo:[0,0,1] neg_hi:[0,0,1]
    v_pk_fma_f32 v[146:147], v[146:147], v[22:23], v[20:21] neg_lo:[0,0,1] neg_hi:[0,0,1]
    v_pk_fma_f32 v[148:149], v[148:149], v[22:23], v[20:21] neg_lo:[0,0,1] neg_hi:[0,0,1]
    v_pk_fma_f32 v[150:151], v[150:151], v[22:23], v[20:21] neg_lo:[0,0,1] neg_hi:[0,0,1]
    v_cvt_pk_bf16_f32 v32, v144, v145
    v_cvt_pk_bf16_f32 v33, v146, v147
    v_cvt_pk_bf16_f32 v34, v148, v149
    v_cvt_pk_bf16_f32 v35, v150, v151
    ds_write_b128 v26, v[32:35] offset:12288
    s_mov_b32 s21, s22
    s_add_u32 s22, s22, 36864
    buffer_load_dwordx4 v[144:147], v1, s[8:11], s21 offen offset:0
    v_pk_fma_f32 v[152:153], v[152:153], v[22:23], v[20:21] neg_lo:[0,0,1] neg_hi:[0,0,1]
    v_pk_fma_f32 v[154:155], v[154:155], v[22:23], v[20:21] neg_lo:[0,0,1] neg_hi:[0,0,1]
    v_pk_fma_f32 v[156:157], v[156:157], v[22:23], v[20:21] neg_lo:[0,0,1] neg_hi:[0,0,1]
    v_pk_fma_f32 v[158:159], v[158:159], v[22:23], v[20:21] neg_lo:[0,0,1] neg_hi:[0,0,1]
    v_cvt_pk_bf16_f32 v36, v152, v153
    v_cvt_pk_bf16_f32 v37, v154, v155
    v_cvt_pk_bf16_f32 v38, v156, v157
    v_cvt_pk_bf16_f32 v39, v158, v159
    ds_write_b128 v26, v[36:39] offset:14336
    buffer_load_dwordx4 v[148:151], v1, s[8:11], s21 offen offset:1024
    v_pk_fma_f32 v[160:161], v[160:161], v[22:23], v[20:21] neg_lo:[0,0,1] neg_hi:[0,0,1]
    v_pk_fma_f32 v[162:163], v[162:163], v[22:23], v[20:21] neg_lo:[0,0,1] neg_hi:[0,0,1]
    v_pk_fma_f32 v[164:165], v[164:165], v[22:23], v[20:21] neg_lo:[0,0,1] neg_hi:[0,0,1]
    v_pk_fma_f32 v[166:167], v[166:167], v[22:23], v[20:21] neg_lo:[0,0,1] neg_hi:[0,0,1]
    v_cvt_pk_bf16_f32 v32, v160, v161
    v_cvt_pk_bf16_f32 v33, v162, v163
    v_cvt_pk_bf16_f32 v34, v164, v165
    v_cvt_pk_bf16_f32 v35, v166, v167
    ds_write_b128 v26, v[32:35] offset:16384
    buffer_load_dwordx4 v[152:155], v1, s[8:11], s21 offen offset:2048
    v_pk_fma_f32 v[168:169], v[168:169], v[22:23], v[20:21] neg_lo:[0,0,1] neg_hi:[0,0,1]
    v_pk_fma_f32 v[170:171], v[170:171], v[22:23], v[20:21] neg_lo:[0,0,1] neg_hi:[0,0,1]
    v_pk_fma_f32 v[172:173], v[172:173], v[22:23], v[20:21] neg_lo:[0,0,1] neg_hi:[0,0,1]
    v_pk_fma_f32 v[174:175], v[174:175], v[22:23], v[20:21] neg_lo:[0,0,1] neg_hi:[0,0,1]
    v_cvt_pk_bf16_f32 v36, v168, v169
    v_cvt_pk_bf16_f32 v37, v170, v171
    v_cvt_pk_bf16_f32 v38, v172, v173
    v_cvt_pk_bf16_f32 v39, v174, v175
    ds_write_b128 v26, v[36:39] offset:18432
    buffer_load_dwordx4 v[156:159], v1, s[8:11], s21 offen offset:3072
    s_add_u32 s21, s21, 4096
    v_pk_fma_f32 v[176:177], v[176:177], v[22:23], v[20:21] neg_lo:[0,0,1] neg_hi:[0,0,1]
    v_pk_fma_f32 v[178:179], v[178:179], v[22:23], v[20:21] neg_lo:[0,0,1] neg_hi:[0,0,1]
    v_pk_fma_f32 v[180:181], v[180:181], v[22:23], v[20:21] neg_lo:[0,0,1] neg_hi:[0,0,1]
    v_pk_fma_f32 v[182:183], v[182:183], v[22:23], v[20:21] neg_lo:[0,0,1] neg_hi:[0,0,1]
    v_cvt_pk_bf16_f32 v32, v176, v177
    v_cvt_pk_bf16_f32 v33, v178, v179
    v_cvt_pk_bf16_f32 v34, v180, v181
    v_cvt_pk_bf16_f32 v35, v182, v183
    ds_write_b128 v26, v[32:35] offset:20480
    buffer_load_dwordx4 v[160:163], v1, s[8:11], s21 offen offset:0
    v_pk_fma_f32 v[184:185], v[184:185], v[22:23], v[20:21] neg_lo:[0,0,1] neg_hi:[0,0,1]
    v_pk_fma_f32 v[186:187], v[186:187], v[22:23], v[20:21] neg_lo:[0,0,1] neg_hi:[0,0,1]
    v_pk_fma_f32 v[188:189], v[188:189], v[22:23], v[20:21] neg_lo:[0,0,1] neg_hi:[0,0,1]
    v_pk_fma_f32 v[190:191], v[190:191], v[22:23], v[20:21] neg_lo:[0,0,1] neg_hi:[0,0,1]
    v_cvt_pk_bf16_f32 v36, v184, v185
    v_cvt_pk_bf16_f32 v37, v186, v187
    v_cvt_pk_bf16_f32 v38, v188, v189
    v_cvt_pk_bf16_f32 v39, v190, v191
    ds_write_b128 v26, v[36:39] offset:22528
    buffer_load_dwordx4 v[164:167], v1, s[8:11], s21 offen offset:1024
    s_waitcnt lgkmcnt(2)
    v_pk_fma_f32 v[192:193], v[192:193], v[22:23], v[20:21] neg_lo:[0,0,1] neg_hi:[0,0,1]
    v_pk_fma_f32 v[194:195], v[194:195], v[22:23], v[20:21] neg_lo:[0,0,1] neg_hi:[0,0,1]
    v_pk_fma_f32 v[196:197], v[196:197], v[22:23], v[20:21] neg_lo:[0,0,1] neg_hi:[0,0,1]
    v_pk_fma_f32 v[198:199], v[198:199], v[22:23], v[20:21] neg_lo:[0,0,1] neg_hi:[0,0,1]
    v_cvt_pk_bf16_f32 v32, v192, v193
    v_cvt_pk_bf16_f32 v33, v194, v195
    v_cvt_pk_bf16_f32 v34, v196, v197
    v_cvt_pk_bf16_f32 v35, v198, v199
    ds_write_b128 v26, v[32:35] offset:24576
    buffer_load_dwordx4 v[168:171], v1, s[8:11], s21 offen offset:2048
    v_pk_fma_f32 v[200:201], v[200:201], v[22:23], v[20:21] neg_lo:[0,0,1] neg_hi:[0,0,1]
    v_pk_fma_f32 v[202:203], v[202:203], v[22:23], v[20:21] neg_lo:[0,0,1] neg_hi:[0,0,1]
    v_pk_fma_f32 v[204:205], v[204:205], v[22:23], v[20:21] neg_lo:[0,0,1] neg_hi:[0,0,1]
    v_pk_fma_f32 v[206:207], v[206:207], v[22:23], v[20:21] neg_lo:[0,0,1] neg_hi:[0,0,1]
    v_cvt_pk_bf16_f32 v36, v200, v201
    v_cvt_pk_bf16_f32 v37, v202, v203
    v_cvt_pk_bf16_f32 v38, v204, v205
    v_cvt_pk_bf16_f32 v39, v206, v207
    ds_write_b128 v26, v[36:39] offset:26624
    buffer_load_dwordx4 v[172:175], v1, s[8:11], s21 offen offset:3072
    s_add_u32 s21, s21, 4096
    v_pk_fma_f32 v[208:209], v[208:209], v[22:23], v[20:21] neg_lo:[0,0,1] neg_hi:[0,0,1]
    v_pk_fma_f32 v[210:211], v[210:211], v[22:23], v[20:21] neg_lo:[0,0,1] neg_hi:[0,0,1]
    v_pk_fma_f32 v[212:213], v[212:213], v[22:23], v[20:21] neg_lo:[0,0,1] neg_hi:[0,0,1]
    v_pk_fma_f32 v[214:215], v[214:215], v[22:23], v[20:21] neg_lo:[0,0,1] neg_hi:[0,0,1]
    v_cvt_pk_bf16_f32 v32, v208, v209
    v_cvt_pk_bf16_f32 v33, v210, v211
    v_cvt_pk_bf16_f32 v34, v212, v213
    v_cvt_pk_bf16_f32 v35, v214, v215
    ds_write_b128 v26, v[32:35] offset:28672
    buffer_load_dwordx4 v[176:179], v1, s[8:11], s21 offen offset:0
    v_pk_fma_f32 v[216:217], v[216:217], v[22:23], v[20:21] neg_lo:[0,0,1] neg_hi:[0,0,1]
    v_pk_fma_f32 v[218:219], v[218:219], v[22:23], v[20:21] neg_lo:[0,0,1] neg_hi:[0,0,1]
    v_pk_fma_f32 v[220:221], v[220:221], v[22:23], v[20:21] neg_lo:[0,0,1] neg_hi:[0,0,1]
    v_pk_fma_f32 v[222:223], v[222:223], v[22:23], v[20:21] neg_lo:[0,0,1] neg_hi:[0,0,1]
    v_cvt_pk_bf16_f32 v36, v216, v217
    v_cvt_pk_bf16_f32 v37, v218, v219
    v_cvt_pk_bf16_f32 v38, v220, v221
    v_cvt_pk_bf16_f32 v39, v222, v223
    ds_write_b128 v26, v[36:39] offset:30720
    buffer_load_dwordx4 v[180:183], v1, s[8:11], s21 offen offset:1024
    v_pk_fma_f32 v[224:225], v[224:225], v[22:23], v[20:21] neg_lo:[0,0,1] neg_hi:[0,0,1]
    v_pk_fma_f32 v[226:227], v[226:227], v[22:23], v[20:21] neg_lo:[0,0,1] neg_hi:[0,0,1]
    v_pk_fma_f32 v[228:229], v[228:229], v[22:23], v[20:21] neg_lo:[0,0,1] neg_hi:[0,0,1]
    v_pk_fma_f32 v[230:231], v[230:231], v[22:23], v[20:21] neg_lo:[0,0,1] neg_hi:[0,0,1]
    v_cvt_pk_bf16_f32 v32, v224, v225
    v_cvt_pk_bf16_f32 v33, v226, v227
    v_cvt_pk_bf16_f32 v34, v228, v229
    v_cvt_pk_bf16_f32 v35, v230, v231
    ds_write_b128 v26, v[32:35] offset:32768
    buffer_load_dwordx4 v[184:187], v1, s[8:11], s21 offen offset:2048
    v_pk_fma_f32 v[232:233], v[232:233], v[22:23], v[20:21] neg_lo:[0,0,1] neg_hi:[0,0,1]
    v_pk_fma_f32 v[234:235], v[234:235], v[22:23], v[20:21] neg_lo:[0,0,1] neg_hi:[0,0,1]
    v_pk_fma_f32 v[236:237], v[236:237], v[22:23], v[20:21] neg_lo:[0,0,1] neg_hi:[0,0,1]
    v_pk_fma_f32 v[238:239], v[238:239], v[22:23], v[20:21] neg_lo:[0,0,1] neg_hi:[0,0,1]
    v_cvt_pk_bf16_f32 v36, v232, v233
    v_cvt_pk_bf16_f32 v37, v234, v235
    v_cvt_pk_bf16_f32 v38, v236, v237
    v_cvt_pk_bf16_f32 v39, v238, v239
    ds_write_b128 v26, v[36:39] offset:34816
    buffer_load_dwordx4 v[188:191], v1, s[8:11], s21 offen offset:3072
    s_add_u32 s21, s21, 4096
    s_waitcnt lgkmcnt(2)
    v_pk_fma_f32 v[96:97], v[96:97], v[22:23], v[20:21] neg_lo:[0,0,1] neg_hi:[0,0,1]
    v_pk_fma_f32 v[98:99], v[98:99], v[22:23], v[20:21] neg_lo:[0,0,1] neg_hi:[0,0,1]
    v_pk_fma_f32 v[100:101], v[100:101], v[22:23], v[20:21] neg_lo:[0,0,1] neg_hi:[0,0,1]
    v_pk_fma_f32 v[102:103], v[102:103], v[22:23], v[20:21] neg_lo:[0,0,1] neg_hi:[0,0,1]
    v_cvt_pk_bf16_f32 v32, v96, v97
    v_cvt_pk_bf16_f32 v33, v98, v99
    v_cvt_pk_bf16_f32 v34, v100, v101
    v_cvt_pk_bf16_f32 v35, v102, v103
    ds_write_b128 v26, v[32:35] offset:0
    v_pk_fma_f32 v[104:105], v[104:105], v[22:23], v[20:21] neg_lo:[0,0,1] neg_hi:[0,0,1]
    v_pk_fma_f32 v[106:107], v[106:107], v[22:23], v[20:21] neg_lo:[0,0,1] neg_hi:[0,0,1]
    v_pk_fma_f32 v[108:109], v[108:109], v[22:23], v[20:21] neg_lo:[0,0,1] neg_hi:[0,0,1]
    v_pk_fma_f32 v[110:111], v[110:111], v[22:23], v[20:21] neg_lo:[0,0,1] neg_hi:[0,0,1]
    v_cvt_pk_bf16_f32 v36, v104, v105
    v_cvt_pk_bf16_f32 v37, v106, v107
    v_cvt_pk_bf16_f32 v38, v108, v109
    v_cvt_pk_bf16_f32 v39, v110, v111
    ds_write_b128 v26, v[36:39] offset:2048
    v_pk_fma_f32 v[112:113], v[112:113], v[22:23], v[20:21] neg_lo:[0,0,1] neg_hi:[0,0,1]
    v_pk_fma_f32 v[114:115], v[114:115], v[22:23], v[20:21] neg_lo:[0,0,1] neg_hi:[0,0,1]
    v_pk_fma_f32 v[116:117], v[116:117], v[22:23], v[20:21] neg_lo:[0,0,1] neg_hi:[0,0,1]
    v_pk_fma_f32 v[118:119], v[118:119], v[22:23], v[20:21] neg_lo:[0,0,1] neg_hi:[0,0,1]
    v_cvt_pk_bf16_f32 v32, v112, v113
    v_cvt_pk_bf16_f32 v33, v114, v115
    v_cvt_pk_bf16_f32 v34, v116, v117
    v_cvt_pk_bf16_f32 v35, v118, v119
    ds_write_b128 v26, v[32:35] offset:4096
    v_pk_fma_f32 v[120:121], v[120:121], v[22:23], v[20:21] neg_lo:[0,0,1] neg_hi:[0,0,1]
    v_pk_fma_f32 v[122:123], v[122:123], v[22:23], v[20:21] neg_lo:[0,0,1] neg_hi:[0,0,1]
    v_pk_fma_f32 v[124:125], v[124:125], v[22:23], v[20:21] neg_lo:[0,0,1] neg_hi:[0,0,1]
    v_pk_fma_f32 v[126:127], v[126:127], v[22:23], v[20:21] neg_lo:[0,0,1] neg_hi:[0,0,1]
    v_cvt_pk_bf16_f32 v36, v120, v121
    v_cvt_pk_bf16_f32 v37, v122, v123
    v_cvt_pk_bf16_f32 v38, v124, v125
    v_cvt_pk_bf16_f32 v39, v126, v127
    ds_write_b128 v26, v[36:39] offset:6144
    v_pk_fma_f32 v[128:129], v[128:129], v[22:23], v[20:21] neg_lo:[0,0,1] neg_hi:[0,0,1]
    v_pk_fma_f32 v[130:131], v[130:131], v[22:23], v[20:21] neg_lo:[0,0,1] neg_hi:[0,0,1]
    v_pk_fma_f32 v[132:133], v[132:133], v[22:23], v[20:21] neg_lo:[0,0,1] neg_hi:[0,0,1]
    v_pk_fma_f32 v[134:135], v[134:135], v[22:23], v[20:21] neg_lo:[0,0,1] neg_hi:[0,0,1]
    v_cvt_pk_bf16_f32 v32, v128, v129
    v_cvt_pk_bf16_f32 v33, v130, v131
    v_cvt_pk_bf16_f32 v34, v132, v133
    v_cvt_pk_bf16_f32 v35, v134, v135
    ds_write_b128 v26, v[32:35] offset:8192
    v_pk_fma_f32 v[136:137], v[136:137], v[22:23], v[20:21] neg_lo:[0,0,1] neg_hi:[0,0,1]
    v_pk_fma_f32 v[138:139], v[138:139], v[22:23], v[20:21] neg_lo:[0,0,1] neg_hi:[0,0,1]
    v_pk_fma_f32 v[140:141], v[140:141], v[22:23], v[20:21] neg_lo:[0,0,1] neg_hi:[0,0,1]
    v_pk_fma_f32 v[142:143], v[142:143], v[22:23], v[20:21] neg_lo:[0,0,1] neg_hi:[0,0,1]
    v_cvt_pk_bf16_f32 v36, v136, v137
    v_cvt_pk_bf16_f32 v37, v138, v139
    v_cvt_pk_bf16_f32 v38, v140, v141
    v_cvt_pk_bf16_f32 v39, v142, v143
    ds_write_b128 v26, v[36:39] offset:10240
    s_waitcnt lgkmcnt(2)
    s_waitcnt lgkmcnt(0)
    s_barrier
    ds_read_b128 v[16:19], v10 offset:0
    ds_read_b128 v[20:23], v10 offset:16
    ds_read_b128 v[24:27], v10 offset:32
    ds_read_b128 v[28:31], v10 offset:48
    ds_read_b128 a[0:3], v2 offset:0
    ds_read_b128 a[144:147], v3 offset:0
    ds_read_b128 a[4:7], v2 offset:1024
    ds_read_b128 a[148:151], v3 offset:1024
    ds_read_b128 a[8:11], v2 offset:2048
    ds_read_b128 a[152:155], v3 offset:2048
    ds_read_b128 a[12:15], v2 offset:3072
    ds_read_b128 a[156:159], v3 offset:3072
    s_waitcnt vmcnt(28)
    s_waitcnt lgkmcnt(6)
    v_mfma_f32_32x32x16_bf16 v[240:255], a[72:75], a[0:3], v[16:31]
    v_mfma_f32_32x32x16_bf16 v[128:143], a[72:75], a[144:147], v[16:31]
    buffer_load_dwordx4 v[192:195], v1, s[8:11], s21 offen offset:0
    ds_read_b128 a[16:19], v2 offset:4096
    ds_read_b128 a[160:163], v3 offset:4096
    s_waitcnt lgkmcnt(6)
    v_mfma_f32_32x32x16_bf16 v[240:255], a[76:79], a[4:7], v[240:255]
    v_mfma_f32_32x32x16_bf16 v[128:143], a[76:79], a[148:151], v[128:143]
    buffer_load_dwordx4 v[196:199], v1, s[8:11], s21 offen offset:1024
    ds_read_b128 a[20:23], v2 offset:5120
    ds_read_b128 a[164:167], v3 offset:5120
    s_waitcnt vmcnt(28)
    s_waitcnt lgkmcnt(6)
    v_mfma_f32_32x32x16_bf16 v[240:255], a[80:83], a[8:11], v[240:255]
    v_mfma_f32_32x32x16_bf16 v[128:143], a[80:83], a[152:155], v[128:143]
    buffer_load_dwordx4 v[200:203], v1, s[8:11], s21 offen offset:2048
    ds_read_b128 a[24:27], v2 offset:6144
    ds_read_b128 a[168:171], v3 offset:6144
    s_waitcnt lgkmcnt(6)
    v_mfma_f32_32x32x16_bf16 v[240:255], a[84:87], a[12:15], v[240:255]
    v_mfma_f32_32x32x16_bf16 v[128:143], a[84:87], a[156:159], v[128:143]
    buffer_load_dwordx4 v[204:207], v1, s[8:11], s21 offen offset:3072
    s_add_u32 s21, s21, 4096
    ds_read_b128 a[28:31], v2 offset:7168
    ds_read_b128 a[172:175], v3 offset:7168
    s_waitcnt vmcnt(28)
    s_waitcnt lgkmcnt(6)
    v_mfma_f32_32x32x16_bf16 v[240:255], a[88:91], a[16:19], v[240:255]
    v_mfma_f32_32x32x16_bf16 v[128:143], a[88:91], a[160:163], v[128:143]
    buffer_load_dwordx4 v[208:211], v1, s[8:11], s21 offen offset:0
    ds_read_b128 a[32:35], v2 offset:8192
    ds_read_b128 a[176:179], v3 offset:8192
    s_waitcnt lgkmcnt(6)
    v_mfma_f32_32x32x16_bf16 v[240:255], a[92:95], a[20:23], v[240:255]
    v_mfma_f32_32x32x16_bf16 v[128:143], a[92:95], a[164:167], v[128:143]
    buffer_load_dwordx4 v[212:215], v1, s[8:11], s21 offen offset:1024
    ds_read_b128 a[36:39], v2 offset:9216
    ds_read_b128 a[180:183], v3 offset:9216
    s_waitcnt vmcnt(28)
    s_waitcnt lgkmcnt(6)
    v_mfma_f32_32x32x16_bf16 v[240:255], a[96:99], a[24:27], v[240:255]
    v_mfma_f32_32x32x16_bf16 v[128:143], a[96:99], a[168:171], v[128:143]
    s_add_u32 s21, s21, 2048
    s_add_u32 s21, s21, s28
    buffer_load_dwordx4 v[216:219], v1, s[8:11], s21 offen offset:0
    ds_read_b128 a[40:43], v2 offset:10240
    ds_read_b128 a[184:187], v3 offset:10240
    s_waitcnt lgkmcnt(6)
    v_mfma_f32_32x32x16_bf16 v[240:255], a[100:103], a[28:31], v[240:255]
    v_mfma_f32_32x32x16_bf16 v[128:143], a[100:103], a[172:175], v[128:143]
    buffer_load_dwordx4 v[220:223], v1, s[8:11], s21 offen offset:1024
    ds_read_b128 a[44:47], v2 offset:11264
    ds_read_b128 a[188:191], v3 offset:11264
    s_waitcnt vmcnt(28)
    s_waitcnt lgkmcnt(6)
    v_mfma_f32_32x32x16_bf16 v[240:255], a[104:107], a[32:35], v[240:255]
    v_mfma_f32_32x32x16_bf16 v[128:143], a[104:107], a[176:179], v[128:143]
    buffer_load_dwordx4 v[224:227], v1, s[8:11], s21 offen offset:2048
    ds_read_b128 a[48:51], v2 offset:12288
    ds_read_b128 a[192:195], v3 offset:12288
    s_waitcnt lgkmcnt(6)
    v_mfma_f32_32x32x16_bf16 v[240:255], a[108:111], a[36:39], v[240:255]
    v_mfma_f32_32x32x16_bf16 v[128:143], a[108:111], a[180:183], v[128:143]
    buffer_load_dwordx4 v[228:231], v1, s[8:11], s21 offen offset:3072
    s_add_u32 s21, s21, 4096
    ds_read_b128 a[52:55], v2 offset:13312
    ds_read_b128 a[196:199], v3 offset:13312
    s_waitcnt vmcnt(28)
    s_waitcnt lgkmcnt(6)
    v_mfma_f32_32x32x16_bf16 v[240:255], a[112:115], a[40:43], v[240:255]
    v_mfma_f32_32x32x16_bf16 v[128:143], a[112:115], a[184:187], v[128:143]
    buffer_load_dwordx4 v[232:235], v1, s[8:11], s21 offen offset:0
    ds_read_b128 a[56:59], v2 offset:14336
    ds_read_b128 a[200:203], v3 offset:14336
    s_waitcnt lgkmcnt(6)
    v_mfma_f32_32x32x16_bf16 v[240:255], a[116:119], a[44:47], v[240:255]
    v_mfma_f32_32x32x16_bf16 v[128:143], a[116:119], a[188:191], v[128:143]
    buffer_load_dwordx4 v[236:239], v1, s[8:11], s21 offen offset:1024
    ds_read_b128 a[60:63], v2 offset:15360
    ds_read_b128 a[204:207], v3 offset:15360
    s_waitcnt vmcnt(28)
    s_waitcnt lgkmcnt(6)
    v_mfma_f32_32x32x16_bf16 v[240:255], a[120:123], a[48:51], v[240:255]
    v_mfma_f32_32x32x16_bf16 v[128:143], a[120:123], a[192:195], v[128:143]
    ds_read_b128 a[64:67], v2 offset:16384
    ds_read_b128 a[208:211], v3 offset:16384
    ds_read_b128 v[16:19], v9 offset:0
    ds_read_b128 v[20:23], v9 offset:16
    ds_read_b128 v[24:27], v9 offset:32
    ds_read_b128 v[28:31], v9 offset:48
    s_waitcnt lgkmcnt(10)
    v_mfma_f32_32x32x16_bf16 v[240:255], a[124:127], a[52:55], v[240:255]
    v_mfma_f32_32x32x16_bf16 v[128:143], a[124:127], a[196:199], v[128:143]
    ds_read_b128 a[68:71], v2 offset:17408
    ds_read_b128 a[212:215], v3 offset:17408
    s_waitcnt vmcnt(26)
    s_waitcnt lgkmcnt(10)
    v_mfma_f32_32x32x16_bf16 v[240:255], a[128:131], a[56:59], v[240:255]
    v_mfma_f32_32x32x16_bf16 v[128:143], a[128:131], a[200:203], v[128:143]
    s_waitcnt lgkmcnt(8)
    v_mfma_f32_32x32x16_bf16 v[240:255], a[132:135], a[60:63], v[240:255]
    v_mfma_f32_32x32x16_bf16 v[128:143], a[132:135], a[204:207], v[128:143]
    s_waitcnt vmcnt(24)
    s_waitcnt lgkmcnt(6)
    v_mfma_f32_32x32x16_bf16 v[240:255], a[136:139], a[64:67], v[240:255]
    v_mfma_f32_32x32x16_bf16 v[128:143], a[136:139], a[208:211], v[128:143]
    s_waitcnt lgkmcnt(0)
    v_mfma_f32_32x32x16_bf16 v[240:255], a[140:143], a[68:71], v[240:255]
    v_mfma_f32_32x32x16_bf16 v[128:143], a[140:143], a[212:215], v[128:143]
    s_waitcnt vmcnt(22)
    v_mfma_f32_32x32x16_bf16 v[80:95], v[144:147], a[0:3], v[16:31]
    v_mfma_f32_32x32x16_bf16 v[96:111], v[144:147], a[144:147], v[16:31]
    buffer_load_dwordx4 v[144:147], v1, s[8:11], s21 offen offset:2048
    v_mfma_f32_32x32x16_bf16 v[80:95], v[148:151], a[4:7], v[80:95]
    v_mfma_f32_32x32x16_bf16 v[96:111], v[148:151], a[148:151], v[96:111]
    buffer_load_dwordx4 v[148:151], v1, s[8:11], s21 offen offset:3072
    s_add_u32 s21, s21, 4096
    s_waitcnt vmcnt(22)
    v_mfma_f32_32x32x16_bf16 v[80:95], v[152:155], a[8:11], v[80:95]
    v_mfma_f32_32x32x16_bf16 v[96:111], v[152:155], a[152:155], v[96:111]
    buffer_load_dwordx4 v[152:155], v1, s[8:11], s21 offen offset:0
    v_mfma_f32_32x32x16_bf16 v[80:95], v[156:159], a[12:15], v[80:95]
    v_mfma_f32_32x32x16_bf16 v[96:111], v[156:159], a[156:159], v[96:111]
    buffer_load_dwordx4 v[156:159], v1, s[8:11], s21 offen offset:1024
    ds_write_b128 v12, v[128:131] offset:0
    ds_write_b128 v12, v[132:135] offset:1024
    s_waitcnt vmcnt(22)
    v_mfma_f32_32x32x16_bf16 v[80:95], v[160:163], a[16:19], v[80:95]
    ds_write_b128 v12, v[136:139] offset:36864
    ds_write_b128 v12, v[140:143] offset:37888
    v_mfma_f32_32x32x16_bf16 v[96:111], v[160:163], a[160:163], v[96:111]
    buffer_load_dwordx4 v[160:163], v1, s[8:11], s21 offen offset:2048
    v_mfma_f32_32x32x16_bf16 v[80:95], v[164:167], a[20:23], v[80:95]
    v_mfma_f32_32x32x16_bf16 v[96:111], v[164:167], a[164:167], v[96:111]
    buffer_load_dwordx4 v[164:167], v1, s[8:11], s21 offen offset:3072
    s_add_u32 s21, s21, 4096
    s_waitcnt vmcnt(22)
    v_mfma_f32_32x32x16_bf16 v[80:95], v[168:171], a[24:27], v[80:95]
    v_mfma_f32_32x32x16_bf16 v[96:111], v[168:171], a[168:171], v[96:111]
    buffer_load_dwordx4 v[168:171], v1, s[8:11], s21 offen offset:0
    v_mfma_f32_32x32x16_bf16 v[80:95], v[172:175], a[28:31], v[80:95]
    v_mfma_f32_32x32x16_bf16 v[96:111], v[172:175], a[172:175], v[96:111]
    buffer_load_dwordx4 v[172:175], v1, s[8:11], s21 offen offset:1024
    s_waitcnt vmcnt(22)
    v_mfma_f32_32x32x16_bf16 v[80:95], v[176:179], a[32:35], v[80:95]
    v_mfma_f32_32x32x16_bf16 v[96:111], v[176:179], a[176:179], v[96:111]
    buffer_load_dwordx4 v[176:179], v1, s[8:11], s21 offen offset:2048
    v_mfma_f32_32x32x16_bf16 v[80:95], v[180:183], a[36:39], v[80:95]
    v_mfma_f32_32x32x16_bf16 v[96:111], v[180:183], a[180:183], v[96:111]
    buffer_load_dwordx4 v[180:183], v1, s[8:11], s21 offen offset:3072
    s_add_u32 s21, s21, 4096
    s_waitcnt lgkmcnt(0)
    s_barrier
    s_waitcnt vmcnt(22)
    v_mfma_f32_32x32x16_bf16 v[80:95], v[184:187], a[40:43], v[80:95]
    ds_read_b128 v[44:47], v13 offset:0
    v_mfma_f32_32x32x16_bf16 v[96:111], v[184:187], a[184:187], v[96:111]
    buffer_load_dwordx4 v[184:187], v1, s[8:11], s21 offen offset:0
    v_mfma_f32_32x32x16_bf16 v[80:95], v[188:191], a[44:47], v[80:95]
    v_mfma_f32_32x32x16_bf16 v[96:111], v[188:191], a[188:191], v[96:111]
    buffer_load_dwordx4 v[188:191], v1, s[8:11], s21 offen offset:1024
    s_waitcnt vmcnt(22)
    v_mfma_f32_32x32x16_bf16 v[80:95], v[192:195], a[48:51], v[80:95]
    s_waitcnt lgkmcnt(0)
    v_add_f32 v240, v240, v44
    v_add_f32 v241, v241, v45
    v_add_f32 v242, v242, v46
    v_add_f32 v243, v243, v47
    ds_read_b128 v[44:47], v13 offset:1024
    v_mfma_f32_32x32x16_bf16 v[96:111], v[192:195], a[192:195], v[96:111]
    s_mov_b32 s21, s22
    s_add_u32 s22, s22, 36864
    buffer_load_dwordx4 v[192:195], v1, s[8:11], s21 offen offset:0
    v_mfma_f32_32x32x16_bf16 v[80:95], v[196:199], a[52:55], v[80:95]
    v_mfma_f32_32x32x16_bf16 v[96:111], v[196:199], a[196:199], v[96:111]
    buffer_load_dwordx4 v[196:199], v1, s[8:11], s21 offen offset:1024
    s_waitcnt vmcnt(22)
    v_mfma_f32_32x32x16_bf16 v[80:95], v[200:203], a[56:59], v[80:95]
    s_waitcnt lgkmcnt(0)
    v_add_f32 v244, v244, v44
    v_add_f32 v245, v245, v45
    v_add_f32 v246, v246, v46
    v_add_f32 v247, v247, v47
    ds_read_b128 v[44:47], v13 offset:36864
    v_mfma_f32_32x32x16_bf16 v[96:111], v[200:203], a[200:203], v[96:111]
    buffer_load_dwordx4 v[200:203], v1, s[8:11], s21 offen offset:2048
    v_add_u32 v2, s43, v4
    v_add_u32 v3, s43, v5
    ds_read_b128 a[72:75], v2 offset:0
    ds_read_b128 a[216:219], v3 offset:0
    v_mfma_f32_32x32x16_bf16 v[80:95], v[204:207], a[60:63], v[80:95]
    v_mfma_f32_32x32x16_bf16 v[96:111], v[204:207], a[204:207], v[96:111]
    buffer_load_dwordx4 v[204:207], v1, s[8:11], s21 offen offset:3072
    s_add_u32 s21, s21, 4096
    ds_read_b128 a[76:79], v2 offset:1024
    ds_read_b128 a[220:223], v3 offset:1024
    s_waitcnt vmcnt(22)
    v_mfma_f32_32x32x16_bf16 v[80:95], v[208:211], a[64:67], v[80:95]
    s_waitcnt lgkmcnt(4)
    v_add_f32 v248, v248, v44
    v_add_f32 v249, v249, v45
    v_add_f32 v250, v250, v46
    v_add_f32 v251, v251, v47
    ds_read_b128 v[44:47], v13 offset:37888
    v_mfma_f32_32x32x16_bf16 v[96:111], v[208:211], a[208:211], v[96:111]
    buffer_load_dwordx4 v[208:211], v1, s[8:11], s21 offen offset:0
    ds_read_b128 a[80:83], v2 offset:2048
    ds_read_b128 a[224:227], v3 offset:2048
    v_mfma_f32_32x32x16_bf16 v[80:95], v[212:215], a[68:71], v[80:95]
    v_mfma_f32_32x32x16_bf16 v[96:111], v[212:215], a[212:215], v[96:111]
    buffer_load_dwordx4 v[212:215], v1, s[8:11], s21 offen offset:1024
    ds_read_b128 a[84:87], v2 offset:3072
    ds_read_b128 a[228:231], v3 offset:3072
    s_waitcnt vmcnt(22)
    s_waitcnt lgkmcnt(7)
    v_mfma_f32_32x32x16_bf16 v[80:95], v[216:219], a[72:75], v[80:95]
    s_waitcnt lgkmcnt(4)
    v_add_f32 v252, v252, v44
    v_add_f32 v253, v253, v45
    v_add_f32 v254, v254, v46
    v_add_f32 v255, v255, v47
    v_mul_f32 v40, v240, v240
    v_mul_f32 v41, v241, v241
    v_mul_f32 v42, v242, v242
    v_mul_f32 v43, v243, v243
    v_fmamk_f32 v40, v40, 0xbdd2d3e8, v11
    v_fmamk_f32 v41, v41, 0xbdd2d3e8, v11
    v_fmamk_f32 v42, v42, 0xbdd2d3e8, v11
    v_fmamk_f32 v43, v43, 0xbdd2d3e8, v11
    v_mul_f32 v40, v240, v40
    v_mul_f32 v41, v241, v41
    v_mul_f32 v42, v242, v42
    v_mul_f32 v43, v243, v43
    v_exp_f32 v40, v40
    v_exp_f32 v41, v41
    v_exp_f32 v42, v42
    v_exp_f32 v43, v43
    v_add_f32 v40, 1.0, v40
    v_add_f32 v41, 1.0, v41
    v_add_f32 v42, 1.0, v42
    v_add_f32 v43, 1.0, v43
    v_rcp_f32 v40, v40
    v_rcp_f32 v41, v41
    v_rcp_f32 v42, v42
    v_rcp_f32 v43, v43
    v_mul_f32 v40, v240, v40
    v_mul_f32 v41, v241, v41
    v_mul_f32 v42, v242, v42
    v_mul_f32 v43, v243, v43
    v_cvt_pk_bf16_f32 v32, v40, v41
    v_cvt_pk_bf16_f32 v33, v42, v43
    v_mul_f32 v40, v244, v244
    v_mul_f32 v41, v245, v245
    v_mul_f32 v42, v246, v246
    v_mul_f32 v43, v247, v247
    v_fmamk_f32 v40, v40, 0xbdd2d3e8, v11
    v_fmamk_f32 v41, v41, 0xbdd2d3e8, v11
    v_fmamk_f32 v42, v42, 0xbdd2d3e8, v11
    v_fmamk_f32 v43, v43, 0xbdd2d3e8, v11
    v_mul_f32 v40, v244, v40
    v_mul_f32 v41, v245, v41
    v_mul_f32 v42, v246, v42
    v_mul_f32 v43, v247, v43
    v_exp_f32 v40, v40
    v_exp_f32 v41, v41
    v_exp_f32 v42, v42
    v_exp_f32 v43, v43
    v_add_f32 v40, 1.0, v40
    v_mfma_f32_32x32x16_bf16 v[96:111], v[216:219], a[216:219], v[96:111]
    buffer_load_dwordx4 v[216:219], v1, s[8:11], s21 offen offset:2048
    ds_read_b128 a[88:91], v2 offset:4096
    ds_read_b128 a[232:235], v3 offset:4096
    v_add_f32 v41, 1.0, v41
    v_add_f32 v42, 1.0, v42
    v_add_f32 v43, 1.0, v43
    v_mfma_f32_32x32x16_bf16 v[80:95], v[220:223], a[76:79], v[80:95]
    v_rcp_f32 v40, v40
    v_rcp_f32 v41, v41
    v_mfma_f32_32x32x16_bf16 v[96:111], v[220:223], a[220:223], v[96:111]
    buffer_load_dwordx4 v[220:223], v1, s[8:11], s21 offen offset:3072
    s_add_u32 s21, s21, 4096
    ds_read_b128 a[92:95], v2 offset:5120
    ds_read_b128 a[236:239], v3 offset:5120
    v_rcp_f32 v42, v42
    s_waitcnt vmcnt(22)
    s_waitcnt lgkmcnt(6)
    v_mfma_f32_32x32x16_bf16 v[80:95], v[224:227], a[80:83], v[80:95]
    v_rcp_f32 v43, v43
    v_mul_f32 v40, v244, v40
    v_mfma_f32_32x32x16_bf16 v[96:111], v[224:227], a[224:227], v[96:111]
    buffer_load_dwordx4 v[224:227], v1, s[8:11], s21 offen offset:0
    ds_read_b128 a[96:99], v2 offset:6144
    ds_read_b128 a[240:243], v3 offset:6144
    v_mul_f32 v41, v245, v41
    v_mul_f32 v42, v246, v42
    v_mul_f32 v43, v247, v43
    s_waitcnt lgkmcnt(6)
    v_mfma_f32_32x32x16_bf16 v[80:95], v[228:231], a[84:87], v[80:95]
    v_cvt_pk_bf16_f32 v34, v40, v41
    v_cvt_pk_bf16_f32 v35, v42, v43
    ds_write_b128 v8, v[32:35] offset:0
    v_mfma_f32_32x32x16_bf16 v[96:111], v[228:231], a[228:231], v[96:111]
    buffer_load_dwordx4 v[228:231], v1, s[8:11], s21 offen offset:1024
    ds_read_b128 a[100:103], v2 offset:7168
    ds_read_b128 a[244:247], v3 offset:7168
    v_mul_f32 v40, v248, v248
    v_mul_f32 v41, v249, v249
    s_waitcnt vmcnt(22)
    s_waitcnt lgkmcnt(7)
    v_mfma_f32_32x32x16_bf16 v[80:95], v[232:235], a[88:91], v[80:95]
    v_mul_f32 v42, v250, v250
    v_mul_f32 v43, v251, v251
    v_fmamk_f32 v40, v40, 0xbdd2d3e8, v11
    v_mfma_f32_32x32x16_bf16 v[96:111], v[232:235], a[232:235], v[96:111]
    buffer_load_dwordx4 v[232:235], v1, s[8:11], s21 offen offset:2048
    ds_read_b128 a[104:107], v2 offset:8192
    ds_read_b128 a[248:251], v3 offset:8192
    v_fmamk_f32 v41, v41, 0xbdd2d3e8, v11
    v_fmamk_f32 v42, v42, 0xbdd2d3e8, v11
    v_fmamk_f32 v43, v43, 0xbdd2d3e8, v11
    s_waitcnt lgkmcnt(7)
    v_mfma_f32_32x32x16_bf16 v[80:95], v[236:239], a[92:95], v[80:95]
    v_mul_f32 v40, v248, v40
    v_mul_f32 v41, v249, v41
    v_mul_f32 v42, v250, v42
    v_mfma_f32_32x32x16_bf16 v[96:111], v[236:239], a[236:239], v[96:111]
    buffer_load_dwordx4 v[236:239], v1, s[8:11], s21 offen offset:3072
    s_add_u32 s21, s21, 4096
    ds_read_b128 a[108:111], v2 offset:9216
    ds_read_b128 a[252:255], v3 offset:9216
    v_mul_f32 v43, v251, v43
    v_exp_f32 v40, v40
    s_waitcnt vmcnt(22)
    s_waitcnt lgkmcnt(7)
    v_mfma_f32_32x32x16_bf16 v[80:95], v[144:147], a[96:99], v[80:95]
    v_exp_f32 v41, v41
    v_exp_f32 v42, v42
    v_mfma_f32_32x32x16_bf16 v[96:111], v[144:147], a[240:243], v[96:111]
    buffer_load_dwordx4 v[144:147], v1, s[8:11], s21 offen offset:0
    ds_read_b128 a[112:115], v2 offset:10240
    ds_read_b128 v[48:51], v3 offset:10240
    v_exp_f32 v43, v43
    s_waitcnt lgkmcnt(6)
    v_mfma_f32_32x32x16_bf16 v[80:95], v[148:151], a[100:103], v[80:95]
    v_add_f32 v40, 1.0, v40
    v_add_f32 v41, 1.0, v41
    v_add_f32 v42, 1.0, v42
    v_mfma_f32_32x32x16_bf16 v[96:111], v[148:151], a[244:247], v[96:111]
    buffer_load_dwordx4 v[148:151], v1, s[8:11], s21 offen offset:1024
    ds_read_b128 a[116:119], v2 offset:11264
    ds_read_b128 v[52:55], v3 offset:11264
    v_add_f32 v43, 1.0, v43
    v_rcp_f32 v40, v40
    s_waitcnt vmcnt(22)
    s_waitcnt lgkmcnt(6)
    v_mfma_f32_32x32x16_bf16 v[80:95], v[152:155], a[104:107], v[80:95]
    v_rcp_f32 v41, v41
    v_rcp_f32 v42, v42
    v_mfma_f32_32x32x16_bf16 v[96:111], v[152:155], a[248:251], v[96:111]
    buffer_load_dwordx4 v[152:155], v1, s[8:11], s21 offen offset:2048
    ds_read_b128 a[120:123], v2 offset:12288
    ds_read_b128 v[56:59], v3 offset:12288
    v_rcp_f32 v43, v43
    s_waitcnt lgkmcnt(6)
    v_mfma_f32_32x32x16_bf16 v[80:95], v[156:159], a[108:111], v[80:95]
    v_mul_f32 v40, v248, v40
    v_mul_f32 v41, v249, v41
    v_mul_f32 v42, v250, v42
    v_mfma_f32_32x32x16_bf16 v[96:111], v[156:159], a[252:255], v[96:111]
    buffer_load_dwordx4 v[156:159], v1, s[8:11], s21 offen offset:3072
    s_add_u32 s21, s21, 4096
    ds_read_b128 a[124:127], v2 offset:13312
    ds_read_b128 v[60:63], v3 offset:13312
    v_mul_f32 v43, v251, v43
    v_cvt_pk_bf16_f32 v36, v40, v41
    v_cvt_pk_bf16_f32 v37, v42, v43
    s_waitcnt vmcnt(22)
    s_waitcnt lgkmcnt(6)
    v_mfma_f32_32x32x16_bf16 v[80:95], v[160:163], a[112:115], v[80:95]
    v_mul_f32 v40, v252, v252
    v_mul_f32 v41, v253, v253
    v_mul_f32 v42, v254, v254
    v_mfma_f32_32x32x16_bf16 v[96:111], v[160:163], v[48:51], v[96:111]
    buffer_load_dwordx4 v[160:163], v1, s[8:11], s21 offen offset:0
    ds_read_b128 a[128:131], v2 offset:14336
    ds_read_b128 v[64:67], v3 offset:14336
    v_mul_f32 v43, v255, v255
    v_fmamk_f32 v40, v40, 0xbdd2d3e8, v11
    v_fmamk_f32 v41, v41, 0xbdd2d3e8, v11
    s_waitcnt lgkmcnt(6)
    v_mfma_f32_32x32x16_bf16 v[80:95], v[164:167], a[116:119], v[80:95]
    v_fmamk_f32 v42, v42, 0xbdd2d3e8, v11
    v_fmamk_f32 v43, v43, 0xbdd2d3e8, v11
    v_mul_f32 v40, v252, v40
    v_mfma_f32_32x32x16_bf16 v[96:111], v[164:167], v[52:55], v[96:111]
    buffer_load_dwordx4 v[164:167], v1, s[8:11], s21 offen offset:1024
    ds_read_b128 a[132:135], v2 offset:15360
    ds_read_b128 v[68:71], v3 offset:15360
    v_mul_f32 v41, v253, v41
    v_mul_f32 v42, v254, v42
    v_mul_f32 v43, v255, v43
    s_waitcnt vmcnt(22)
    s_waitcnt lgkmcnt(6)
    v_mfma_f32_32x32x16_bf16 v[80:95], v[168:171], a[120:123], v[80:95]
    v_exp_f32 v40, v40
    v_exp_f32 v41, v41
    v_mfma_f32_32x32x16_bf16 v[96:111], v[168:171], v[56:59], v[96:111]
    s_add_u32 s21, s21, 2048
    s_add_u32 s21, s21, s28
    buffer_load_dwordx4 v[168:171], v1, s[8:11], s21 offen offset:0
    ds_read_b128 a[136:139], v2 offset:16384
    ds_read_b128 v[72:75], v3 offset:16384
    ds_read_b128 v[16:19], v9 offset:128
    ds_read_b128 v[20:23], v9 offset:144
    ds_read_b128 v[24:27], v9 offset:160
    ds_read_b128 v[28:31], v9 offset:176
    v_exp_f32 v42, v42
    s_waitcnt lgkmcnt(10)
    v_mfma_f32_32x32x16_bf16 v[80:95], v[172:175], a[124:127], v[80:95]
    v_exp_f32 v43, v43
    v_add_f32 v40, 1.0, v40
    v_mfma_f32_32x32x16_bf16 v[96:111], v[172:175], v[60:63], v[96:111]
    buffer_load_dwordx4 v[172:175], v1, s[8:11], s21 offen offset:1024
    ds_read_b128 a[140:143], v2 offset:17408
    ds_read_b128 v[76:79], v3 offset:17408
    v_add_f32 v41, 1.0, v41
    v_add_f32 v42, 1.0, v42
    v_add_f32 v43, 1.0, v43
    s_waitcnt vmcnt(22)
    s_waitcnt lgkmcnt(10)
    v_mfma_f32_32x32x16_bf16 v[80:95], v[176:179], a[128:131], v[80:95]
    v_rcp_f32 v40, v40
    v_rcp_f32 v41, v41
    v_mfma_f32_32x32x16_bf16 v[96:111], v[176:179], v[64:67], v[96:111]
    buffer_load_dwordx4 v[176:179], v1, s[8:11], s21 offen offset:2048
    v_rcp_f32 v42, v42
    s_waitcnt lgkmcnt(8)
    v_mfma_f32_32x32x16_bf16 v[80:95], v[180:183], a[132:135], v[80:95]
    v_rcp_f32 v43, v43
    v_mul_f32 v40, v252, v40
    v_mfma_f32_32x32x16_bf16 v[96:111], v[180:183], v[68:71], v[96:111]
    buffer_load_dwordx4 v[180:183], v1, s[8:11], s21 offen offset:3072
    s_add_u32 s21, s21, 4096
    v_mul_f32 v41, v253, v41
    v_mul_f32 v42, v254, v42
    v_mul_f32 v43, v255, v43
    s_waitcnt vmcnt(22)
    s_waitcnt lgkmcnt(6)
    v_mfma_f32_32x32x16_bf16 v[80:95], v[184:187], a[136:139], v[80:95]
    v_cvt_pk_bf16_f32 v38, v40, v41
    v_cvt_pk_bf16_f32 v39, v42, v43
    ds_write_b128 v8, v[36:39] offset:1024
    v_mfma_f32_32x32x16_bf16 v[96:111], v[184:187], v[72:75], v[96:111]
    buffer_load_dwordx4 v[184:187], v1, s[8:11], s21 offen offset:0
    s_waitcnt lgkmcnt(1)
    v_mfma_f32_32x32x16_bf16 v[80:95], v[188:191], a[140:143], v[80:95]
    v_mfma_f32_32x32x16_bf16 v[96:111], v[188:191], v[76:79], v[96:111]
    buffer_load_dwordx4 v[188:191], v1, s[8:11], s21 offen offset:1024
    s_waitcnt vmcnt(22)
    v_mfma_f32_32x32x16_bf16 v[112:127], v[192:195], a[0:3], v[16:31]
    v_mfma_f32_32x32x16_bf16 v[128:143], v[192:195], a[144:147], v[16:31]
    buffer_load_dwordx4 v[192:195], v1, s[8:11], s21 offen offset:2048
    v_mfma_f32_32x32x16_bf16 v[112:127], v[196:199], a[4:7], v[112:127]
    s_nop 4
    v_mul_f32 v40, v80, v80
    v_mul_f32 v41, v81, v81
    v_mul_f32 v42, v82, v82
    v_mul_f32 v43, v83, v83
    v_fmamk_f32 v40, v40, 0xbdd2d3e8, v11
    v_mfma_f32_32x32x16_bf16 v[128:143], v[196:199], a[148:151], v[128:143]
    buffer_load_dwordx4 v[196:199], v1, s[8:11], s21 offen offset:3072
    s_add_u32 s21, s21, 4096
    v_fmamk_f32 v41, v41, 0xbdd2d3e8, v11
    v_fmamk_f32 v42, v42, 0xbdd2d3e8, v11
    v_fmamk_f32 v43, v43, 0xbdd2d3e8, v11
    v_mul_f32 v40, v80, v40
    v_mul_f32 v41, v81, v41
    s_waitcnt vmcnt(22)
    v_mfma_f32_32x32x16_bf16 v[112:127], v[200:203], a[8:11], v[112:127]
    v_mul_f32 v42, v82, v42
    v_mul_f32 v43, v83, v43
    v_exp_f32 v40, v40
    v_mfma_f32_32x32x16_bf16 v[128:143], v[200:203], a[152:155], v[128:143]
    buffer_load_dwordx4 v[200:203], v1, s[8:11], s21 offen offset:0
    v_exp_f32 v41, v41
    v_exp_f32 v42, v42
    v_exp_f32 v43, v43
    v_mfma_f32_32x32x16_bf16 v[112:127], v[204:207], a[12:15], v[112:127]
    v_add_f32 v40, 1.0, v40
    v_add_f32 v41, 1.0, v41
    v_add_f32 v42, 1.0, v42
    v_mfma_f32_32x32x16_bf16 v[128:143], v[204:207], a[156:159], v[128:143]
    buffer_load_dwordx4 v[204:207], v1, s[8:11], s21 offen offset:1024
    v_add_f32 v43, 1.0, v43
    v_rcp_f32 v40, v40
    v_rcp_f32 v41, v41
    s_waitcnt vmcnt(22)
    v_mfma_f32_32x32x16_bf16 v[112:127], v[208:211], a[16:19], v[112:127]
    v_rcp_f32 v42, v42
    v_rcp_f32 v43, v43
    v_mfma_f32_32x32x16_bf16 v[128:143], v[208:211], a[160:163], v[128:143]
    buffer_load_dwordx4 v[208:211], v1, s[8:11], s21 offen offset:2048
    v_mul_f32 v40, v80, v40
    v_mul_f32 v41, v81, v41
    v_mul_f32 v42, v82, v42
    v_mul_f32 v43, v83, v43
    v_cvt_pk_bf16_f32 v32, v40, v41
    v_mfma_f32_32x32x16_bf16 v[112:127], v[212:215], a[20:23], v[112:127]
    v_cvt_pk_bf16_f32 v33, v42, v43
    v_mul_f32 v40, v84, v84
    v_mul_f32 v41, v85, v85
    v_mul_f32 v42, v86, v86
    v_mfma_f32_32x32x16_bf16 v[128:143], v[212:215], a[164:167], v[128:143]
    buffer_load_dwordx4 v[212:215], v1, s[8:11], s21 offen offset:3072
    s_add_u32 s21, s21, 4096
    v_mul_f32 v43, v87, v87
    v_fmamk_f32 v40, v40, 0xbdd2d3e8, v11
    v_fmamk_f32 v41, v41, 0xbdd2d3e8, v11
    v_fmamk_f32 v42, v42, 0xbdd2d3e8, v11
    v_fmamk_f32 v43, v43, 0xbdd2d3e8, v11
    s_waitcnt vmcnt(22)
    v_mfma_f32_32x32x16_bf16 v[112:127], v[216:219], a[24:27], v[112:127]
    v_mul_f32 v40, v84, v40
    v_mul_f32 v41, v85, v41
    v_mul_f32 v42, v86, v42
    v_mul_f32 v43, v87, v43
    v_mfma_f32_32x32x16_bf16 v[128:143], v[216:219], a[168:171], v[128:143]
    buffer_load_dwordx4 v[216:219], v1, s[8:11], s21 offen offset:0
    v_exp_f32 v40, v40
    v_exp_f32 v41, v41
    v_exp_f32 v42, v42
    v_mfma_f32_32x32x16_bf16 v[112:127], v[220:223], a[28:31], v[112:127]
    v_exp_f32 v43, v43
    v_add_f32 v40, 1.0, v40
    v_mfma_f32_32x32x16_bf16 v[128:143], v[220:223], a[172:175], v[128:143]
    buffer_load_dwordx4 v[220:223], v1, s[8:11], s21 offen offset:1024
    v_add_f32 v41, 1.0, v41
    v_add_f32 v42, 1.0, v42
    v_add_f32 v43, 1.0, v43
    v_rcp_f32 v40, v40
    s_waitcnt vmcnt(22)
    v_mfma_f32_32x32x16_bf16 v[112:127], v[224:227], a[32:35], v[112:127]
    v_rcp_f32 v41, v41
    v_rcp_f32 v42, v42
    v_mfma_f32_32x32x16_bf16 v[128:143], v[224:227], a[176:179], v[128:143]
    buffer_load_dwordx4 v[224:227], v1, s[8:11], s21 offen offset:2048
    v_rcp_f32 v43, v43
    v_mul_f32 v40, v84, v40
    v_mul_f32 v41, v85, v41
    v_mul_f32 v42, v86, v42
    v_mfma_f32_32x32x16_bf16 v[112:127], v[228:231], a[36:39], v[112:127]
    v_mul_f32 v43, v87, v43
    v_cvt_pk_bf16_f32 v34, v40, v41
    v_cvt_pk_bf16_f32 v35, v42, v43
    ds_write_b128 v6, v[32:35] offset:0
    v_mfma_f32_32x32x16_bf16 v[128:143], v[228:231], a[180:183], v[128:143]
    buffer_load_dwordx4 v[228:231], v1, s[8:11], s21 offen offset:3072
    s_add_u32 s21, s21, 4096
    v_mul_f32 v40, v88, v88
    v_mul_f32 v41, v89, v89
    v_mul_f32 v42, v90, v90
    v_mul_f32 v43, v91, v91
    s_waitcnt vmcnt(22)
    v_mfma_f32_32x32x16_bf16 v[112:127], v[232:235], a[40:43], v[112:127]
    v_fmamk_f32 v40, v40, 0xbdd2d3e8, v11
    v_fmamk_f32 v41, v41, 0xbdd2d3e8, v11
    v_fmamk_f32 v42, v42, 0xbdd2d3e8, v11
    v_fmamk_f32 v43, v43, 0xbdd2d3e8, v11
    v_mfma_f32_32x32x16_bf16 v[128:143], v[232:235], a[184:187], v[128:143]
    buffer_load_dwordx4 v[232:235], v1, s[8:11], s21 offen offset:0
    v_mul_f32 v40, v88, v40
    v_mul_f32 v41, v89, v41
    v_mul_f32 v42, v90, v42
    v_mul_f32 v43, v91, v43
    v_exp_f32 v40, v40
    v_mfma_f32_32x32x16_bf16 v[112:127], v[236:239], a[44:47], v[112:127]
    v_exp_f32 v41, v41
    v_exp_f32 v42, v42
    v_mfma_f32_32x32x16_bf16 v[128:143], v[236:239], a[188:191], v[128:143]
    buffer_load_dwordx4 v[236:239], v1, s[8:11], s21 offen offset:1024
    v_exp_f32 v43, v43
    v_add_f32 v40, 1.0, v40
    v_add_f32 v41, 1.0, v41
    s_waitcnt vmcnt(22)
    v_mfma_f32_32x32x16_bf16 v[112:127], v[144:147], a[48:51], v[112:127]
    v_add_f32 v42, 1.0, v42
    v_add_f32 v43, 1.0, v43
    v_rcp_f32 v40, v40
    v_mfma_f32_32x32x16_bf16 v[128:143], v[144:147], a[192:195], v[128:143]
    s_mov_b32 s21, s22
    s_add_u32 s22, s22, 36864
    buffer_load_dwordx4 v[144:147], v1, s[8:11], s21 offen offset:0
    v_rcp_f32 v41, v41
    v_rcp_f32 v42, v42
    v_rcp_f32 v43, v43
    v_mfma_f32_32x32x16_bf16 v[112:127], v[148:151], a[52:55], v[112:127]
    v_mul_f32 v40, v88, v40
    v_mul_f32 v41, v89, v41
    v_mul_f32 v42, v90, v42
    v_mul_f32 v43, v91, v43
    v_mfma_f32_32x32x16_bf16 v[128:143], v[148:151], a[196:199], v[128:143]
    buffer_load_dwordx4 v[148:151], v1, s[8:11], s21 offen offset:1024
    v_cvt_pk_bf16_f32 v36, v40, v41
    v_cvt_pk_bf16_f32 v37, v42, v43
    v_mul_f32 v40, v92, v92
    v_mul_f32 v41, v93, v93
    s_waitcnt vmcnt(22)
    v_mfma_f32_32x32x16_bf16 v[112:127], v[152:155], a[56:59], v[112:127]
    v_mul_f32 v42, v94, v94
    v_mul_f32 v43, v95, v95
    v_fmamk_f32 v40, v40, 0xbdd2d3e8, v11
    v_fmamk_f32 v41, v41, 0xbdd2d3e8, v11
    v_fmamk_f32 v42, v42, 0xbdd2d3e8, v11
    v_mfma_f32_32x32x16_bf16 v[128:143], v[152:155], a[200:203], v[128:143]
    buffer_load_dwordx4 v[152:155], v1, s[8:11], s21 offen offset:2048
    v_fmamk_f32 v43, v43, 0xbdd2d3e8, v11
    v_mul_f32 v40, v92, v40
    v_mul_f32 v41, v93, v41
    v_mul_f32 v42, v94, v42
    v_mfma_f32_32x32x16_bf16 v[112:127], v[156:159], a[60:63], v[112:127]
    v_mul_f32 v43, v95, v43
    v_exp_f32 v40, v40
    v_exp_f32 v41, v41
    v_mfma_f32_32x32x16_bf16 v[128:143], v[156:159], a[204:207], v[128:143]
    buffer_load_dwordx4 v[156:159], v1, s[8:11], s21 offen offset:3072
    s_add_u32 s21, s21, 4096
    v_exp_f32 v42, v42
    v_exp_f32 v43, v43
    s_waitcnt vmcnt(22)
    v_mfma_f32_32x32x16_bf16 v[112:127], v[160:163], a[64:67], v[112:127]
    v_add_f32 v40, 1.0, v40
    v_add_f32 v41, 1.0, v41
    v_add_f32 v42, 1.0, v42
    v_add_f32 v43, 1.0, v43
    v_rcp_f32 v40, v40
    v_mfma_f32_32x32x16_bf16 v[128:143], v[160:163], a[208:211], v[128:143]
    buffer_load_dwordx4 v[160:163], v1, s[8:11], s21 offen offset:0
    v_rcp_f32 v41, v41
    v_rcp_f32 v42, v42
    v_mfma_f32_32x32x16_bf16 v[112:127], v[164:167], a[68:71], v[112:127]
    v_rcp_f32 v43, v43
    v_mul_f32 v40, v92, v40
    v_mul_f32 v41, v93, v41
    v_mfma_f32_32x32x16_bf16 v[128:143], v[164:167], a[212:215], v[128:143]
    buffer_load_dwordx4 v[164:167], v1, s[8:11], s21 offen offset:1024
    v_mul_f32 v42, v94, v42
    v_mul_f32 v43, v95, v43
    v_cvt_pk_bf16_f32 v38, v40, v41
    v_cvt_pk_bf16_f32 v39, v42, v43
    s_waitcnt vmcnt(22)
    v_mfma_f32_32x32x16_bf16 v[112:127], v[168:171], a[72:75], v[112:127]
    ds_write_b128 v6, v[36:39] offset:1024
    v_mul_f32 v40, v96, v96
    v_mul_f32 v41, v97, v97
    v_mul_f32 v42, v98, v98
    v_mfma_f32_32x32x16_bf16 v[128:143], v[168:171], a[216:219], v[128:143]
    buffer_load_dwordx4 v[168:171], v1, s[8:11], s21 offen offset:2048
    v_mul_f32 v43, v99, v99
    v_fmamk_f32 v40, v40, 0xbdd2d3e8, v11
    v_fmamk_f32 v41, v41, 0xbdd2d3e8, v11
    v_fmamk_f32 v42, v42, 0xbdd2d3e8, v11
    v_mfma_f32_32x32x16_bf16 v[112:127], v[172:175], a[76:79], v[112:127]
    v_fmamk_f32 v43, v43, 0xbdd2d3e8, v11
    v_mul_f32 v40, v96, v40
    v_mul_f32 v41, v97, v41
    v_mul_f32 v42, v98, v42
    v_mul_f32 v43, v99, v43
    v_mfma_f32_32x32x16_bf16 v[128:143], v[172:175], a[220:223], v[128:143]
    buffer_load_dwordx4 v[172:175], v1, s[8:11], s21 offen offset:3072
    s_add_u32 s21, s21, 4096
    v_exp_f32 v40, v40
    v_exp_f32 v41, v41
    s_waitcnt vmcnt(22)
    v_mfma_f32_32x32x16_bf16 v[112:127], v[176:179], a[80:83], v[112:127]
    v_exp_f32 v42, v42
    v_exp_f32 v43, v43
    v_add_f32 v40, 1.0, v40
    v_mfma_f32_32x32x16_bf16 v[128:143], v[176:179], a[224:227], v[128:143]
    buffer_load_dwordx4 v[176:179], v1, s[8:11], s21 offen offset:0
    v_add_f32 v41, 1.0, v41
    v_add_f32 v42, 1.0, v42
    v_add_f32 v43, 1.0, v43
    v_rcp_f32 v40, v40
    v_mfma_f32_32x32x16_bf16 v[112:127], v[180:183], a[84:87], v[112:127]
    v_rcp_f32 v41, v41
    v_rcp_f32 v42, v42
    v_mfma_f32_32x32x16_bf16 v[128:143], v[180:183], a[228:231], v[128:143]
    buffer_load_dwordx4 v[180:183], v1, s[8:11], s21 offen offset:1024
    v_rcp_f32 v43, v43
    v_mul_f32 v40, v96, v40
    v_mul_f32 v41, v97, v41
    s_waitcnt vmcnt(22)
    v_mfma_f32_32x32x16_bf16 v[112:127], v[184:187], a[88:91], v[112:127]
    v_mul_f32 v42, v98, v42
    v_mul_f32 v43, v99, v43
    v_cvt_pk_bf16_f32 v32, v40, v41
    v_cvt_pk_bf16_f32 v33, v42, v43
    v_mul_f32 v40, v100, v100
    v_mfma_f32_32x32x16_bf16 v[128:143], v[184:187], a[232:235], v[128:143]
    buffer_load_dwordx4 v[184:187], v1, s[8:11], s21 offen offset:2048
    v_mul_f32 v41, v101, v101
    v_mul_f32 v42, v102, v102
    v_mul_f32 v43, v103, v103
    v_fmamk_f32 v40, v40, 0xbdd2d3e8, v11
    v_mfma_f32_32x32x16_bf16 v[112:127], v[188:191], a[92:95], v[112:127]
    v_fmamk_f32 v41, v41, 0xbdd2d3e8, v11
    v_fmamk_f32 v42, v42, 0xbdd2d3e8, v11
    v_fmamk_f32 v43, v43, 0xbdd2d3e8, v11
    v_mul_f32 v40, v100, v40
    v_mul_f32 v41, v101, v41
    v_mfma_f32_32x32x16_bf16 v[128:143], v[188:191], a[236:239], v[128:143]
    buffer_load_dwordx4 v[188:191], v1, s[8:11], s21 offen offset:3072
    s_add_u32 s21, s21, 4096
    v_mul_f32 v42, v102, v42
    v_mul_f32 v43, v103, v43
    v_exp_f32 v40, v40
    s_waitcnt vmcnt(22)
    v_mfma_f32_32x32x16_bf16 v[112:127], v[192:195], a[96:99], v[112:127]
    v_exp_f32 v41, v41
    v_exp_f32 v42, v42
    v_exp_f32 v43, v43
    v_mfma_f32_32x32x16_bf16 v[128:143], v[192:195], a[240:243], v[128:143]
    buffer_load_dwordx4 v[192:195], v1, s[8:11], s21 offen offset:0
    v_add_f32 v40, 1.0, v40
    v_add_f32 v41, 1.0, v41
    v_add_f32 v42, 1.0, v42
    v_add_f32 v43, 1.0, v43
    v_mfma_f32_32x32x16_bf16 v[112:127], v[196:199], a[100:103], v[112:127]
    v_rcp_f32 v40, v40
    v_rcp_f32 v41, v41
    v_mfma_f32_32x32x16_bf16 v[128:143], v[196:199], a[244:247], v[128:143]
    buffer_load_dwordx4 v[196:199], v1, s[8:11], s21 offen offset:1024
    v_rcp_f32 v42, v42
    v_rcp_f32 v43, v43
    v_mul_f32 v40, v100, v40
    s_waitcnt vmcnt(22)
    v_mfma_f32_32x32x16_bf16 v[112:127], v[200:203], a[104:107], v[112:127]
    v_mul_f32 v41, v101, v41
    v_mul_f32 v42, v102, v42
    v_mul_f32 v43, v103, v43
    v_cvt_pk_bf16_f32 v34, v40, v41
    v_mfma_f32_32x32x16_bf16 v[128:143], v[200:203], a[248:251], v[128:143]
    buffer_load_dwordx4 v[200:203], v1, s[8:11], s21 offen offset:2048
    v_cvt_pk_bf16_f32 v35, v42, v43
    ds_write_b128 v7, v[32:35] offset:0
    v_mul_f32 v40, v104, v104
    v_mul_f32 v41, v105, v105
    v_mfma_f32_32x32x16_bf16 v[112:127], v[204:207], a[108:111], v[112:127]
    v_mul_f32 v42, v106, v106
    v_mul_f32 v43, v107, v107
    v_fmamk_f32 v40, v40, 0xbdd2d3e8, v11
    v_fmamk_f32 v41, v41, 0xbdd2d3e8, v11
    v_mfma_f32_32x32x16_bf16 v[128:143], v[204:207], a[252:255], v[128:143]
    buffer_load_dwordx4 v[204:207], v1, s[8:11], s21 offen offset:3072
    s_add_u32 s21, s21, 4096
    v_fmamk_f32 v42, v42, 0xbdd2d3e8, v11
    v_fmamk_f32 v43, v43, 0xbdd2d3e8, v11
    v_mul_f32 v40, v104, v40
    v_mul_f32 v41, v105, v41
    v_mul_f32 v42, v106, v42
    s_waitcnt vmcnt(22)
    v_mfma_f32_32x32x16_bf16 v[112:127], v[208:211], a[112:115], v[112:127]
    v_mul_f32 v43, v107, v43
    v_exp_f32 v40, v40
    v_exp_f32 v41, v41
    v_mfma_f32_32x32x16_bf16 v[128:143], v[208:211], v[48:51], v[128:143]
    buffer_load_dwordx4 v[208:211], v1, s[8:11], s21 offen offset:0
    v_exp_f32 v42, v42
    v_exp_f32 v43, v43
    v_mfma_f32_32x32x16_bf16 v[112:127], v[212:215], a[116:119], v[112:127]
    v_add_f32 v40, 1.0, v40
    v_add_f32 v41, 1.0, v41
    v_add_f32 v42, 1.0, v42
    v_add_f32 v43, 1.0, v43
    v_mfma_f32_32x32x16_bf16 v[128:143], v[212:215], v[52:55], v[128:143]
    buffer_load_dwordx4 v[212:215], v1, s[8:11], s21 offen offset:1024
    v_rcp_f32 v40, v40
    v_rcp_f32 v41, v41
    v_rcp_f32 v42, v42
    s_waitcnt vmcnt(22)
    v_mfma_f32_32x32x16_bf16 v[112:127], v[216:219], a[120:123], v[112:127]
    v_rcp_f32 v43, v43
    v_mul_f32 v40, v104, v40
    v_mfma_f32_32x32x16_bf16 v[128:143], v[216:219], v[56:59], v[128:143]
    s_add_u32 s21, s21, 2048
    s_add_u32 s21, s21, s28
    buffer_load_dwordx4 v[216:219], v1, s[8:11], s21 offen offset:0
    ds_read_b128 v[16:19], v9 offset:256
    ds_read_b128 v[20:23], v9 offset:272
    ds_read_b128 v[24:27], v9 offset:288
    ds_read_b128 v[28:31], v9 offset:304
    v_mul_f32 v41, v105, v41
    v_mul_f32 v42, v106, v42
    v_mul_f32 v43, v107, v43
    v_cvt_pk_bf16_f32 v36, v40, v41
    v_cvt_pk_bf16_f32 v37, v42, v43
    v_mfma_f32_32x32x16_bf16 v[112:127], v[220:223], a[124:127], v[112:127]
    v_mul_f32 v40, v108, v108
    v_mul_f32 v41, v109, v109
    v_mul_f32 v42, v110, v110
    v_mul_f32 v43, v111, v111
    v_mfma_f32_32x32x16_bf16 v[128:143], v[220:223], v[60:63], v[128:143]
    buffer_load_dwordx4 v[220:223], v1, s[8:11], s21 offen offset:1024
    v_fmamk_f32 v40, v40, 0xbdd2d3e8, v11
    v_fmamk_f32 v41, v41, 0xbdd2d3e8, v11
    v_fmamk_f32 v42, v42, 0xbdd2d3e8, v11
    v_fmamk_f32 v43, v43, 0xbdd2d3e8, v11
    v_mul_f32 v40, v108, v40
    s_waitcnt vmcnt(22)
    v_mfma_f32_32x32x16_bf16 v[112:127], v[224:227], a[128:131], v[112:127]
    v_mul_f32 v41, v109, v41
    v_mul_f32 v42, v110, v42
    v_mul_f32 v43, v111, v43
    v_exp_f32 v40, v40
    v_mfma_f32_32x32x16_bf16 v[128:143], v[224:227], v[64:67], v[128:143]
    buffer_load_dwordx4 v[224:227], v1, s[8:11], s21 offen offset:2048
    v_exp_f32 v41, v41
    v_exp_f32 v42, v42
    v_mfma_f32_32x32x16_bf16 v[112:127], v[228:231], a[132:135], v[112:127]
    v_exp_f32 v43, v43
    v_add_f32 v40, 1.0, v40
    v_add_f32 v41, 1.0, v41
    v_mfma_f32_32x32x16_bf16 v[128:143], v[228:231], v[68:71], v[128:143]
    buffer_load_dwordx4 v[228:231], v1, s[8:11], s21 offen offset:3072
    s_add_u32 s21, s21, 4096
    v_add_f32 v42, 1.0, v42
    v_add_f32 v43, 1.0, v43
    v_rcp_f32 v40, v40
    v_rcp_f32 v41, v41
    s_waitcnt vmcnt(22)
    v_mfma_f32_32x32x16_bf16 v[112:127], v[232:235], a[136:139], v[112:127]
    v_rcp_f32 v42, v42
    v_rcp_f32 v43, v43
    v_mfma_f32_32x32x16_bf16 v[128:143], v[232:235], v[72:75], v[128:143]
    buffer_load_dwordx4 v[232:235], v1, s[8:11], s21 offen offset:0
    v_mul_f32 v40, v108, v40
    v_mul_f32 v41, v109, v41
    v_mul_f32 v42, v110, v42
    v_mul_f32 v43, v111, v43
    v_mfma_f32_32x32x16_bf16 v[112:127], v[236:239], a[140:143], v[112:127]
    v_cvt_pk_bf16_f32 v38, v40, v41
    v_cvt_pk_bf16_f32 v39, v42, v43
    ds_write_b128 v7, v[36:39] offset:1024
    v_mfma_f32_32x32x16_bf16 v[128:143], v[236:239], v[76:79], v[128:143]
    buffer_load_dwordx4 v[236:239], v1, s[8:11], s21 offen offset:1024
    s_waitcnt lgkmcnt(1)
    s_waitcnt vmcnt(22)
    v_mfma_f32_32x32x16_bf16 v[80:95], v[144:147], a[0:3], v[16:31]
    v_mfma_f32_32x32x16_bf16 v[96:111], v[144:147], a[144:147], v[16:31]
    buffer_load_dwordx4 v[144:147], v1, s[8:11], s21 offen offset:2048
    v_mfma_f32_32x32x16_bf16 v[80:95], v[148:151], a[4:7], v[80:95]
    s_nop 0
    v_mul_f32 v40, v112, v112
    v_mul_f32 v41, v113, v113
    v_mul_f32 v42, v114, v114
    v_mul_f32 v43, v115, v115
    v_fmamk_f32 v40, v40, 0xbdd2d3e8, v11
    v_mfma_f32_32x32x16_bf16 v[96:111], v[148:151], a[148:151], v[96:111]
    buffer_load_dwordx4 v[148:151], v1, s[8:11], s21 offen offset:3072
    s_add_u32 s21, s21, 4096
    v_fmamk_f32 v41, v41, 0xbdd2d3e8, v11
    v_fmamk_f32 v42, v42, 0xbdd2d3e8, v11
    v_fmamk_f32 v43, v43, 0xbdd2d3e8, v11
    v_mul_f32 v40, v112, v40
    v_mul_f32 v41, v113, v41
    s_waitcnt vmcnt(22)
    v_mfma_f32_32x32x16_bf16 v[80:95], v[152:155], a[8:11], v[80:95]
    v_mul_f32 v42, v114, v42
    v_mul_f32 v43, v115, v43
    v_exp_f32 v40, v40
    v_mfma_f32_32x32x16_bf16 v[96:111], v[152:155], a[152:155], v[96:111]
    buffer_load_dwordx4 v[152:155], v1, s[8:11], s21 offen offset:0
    v_exp_f32 v41, v41
    v_exp_f32 v42, v42
    v_exp_f32 v43, v43
    v_mfma_f32_32x32x16_bf16 v[80:95], v[156:159], a[12:15], v[80:95]
    v_add_f32 v40, 1.0, v40
    v_add_f32 v41, 1.0, v41
    v_add_f32 v42, 1.0, v42
    v_mfma_f32_32x32x16_bf16 v[96:111], v[156:159], a[156:159], v[96:111]
    buffer_load_dwordx4 v[156:159], v1, s[8:11], s21 offen offset:1024
    v_add_f32 v43, 1.0, v43
    v_rcp_f32 v40, v40
    v_rcp_f32 v41, v41
    s_waitcnt vmcnt(22)
    v_mfma_f32_32x32x16_bf16 v[80:95], v[160:163], a[16:19], v[80:95]
    v_rcp_f32 v42, v42
    v_rcp_f32 v43, v43
    v_mfma_f32_32x32x16_bf16 v[96:111], v[160:163], a[160:163], v[96:111]
    buffer_load_dwordx4 v[160:163], v1, s[8:11], s21 offen offset:2048
    v_mul_f32 v40, v112, v40
    v_mul_f32 v41, v113, v41
    v_mul_f32 v42, v114, v42
    v_mul_f32 v43, v115, v43
    v_cvt_pk_bf16_f32 v32, v40, v41
    v_mfma_f32_32x32x16_bf16 v[80:95], v[164:167], a[20:23], v[80:95]
    v_cvt_pk_bf16_f32 v33, v42, v43
    v_mul_f32 v40, v116, v116
    v_mul_f32 v41, v117, v117
    v_mul_f32 v42, v118, v118
    v_mfma_f32_32x32x16_bf16 v[96:111], v[164:167], a[164:167], v[96:111]
    buffer_load_dwordx4 v[164:167], v1, s[8:11], s21 offen offset:3072
    s_add_u32 s21, s21, 4096
    v_mul_f32 v43, v119, v119
    v_fmamk_f32 v40, v40, 0xbdd2d3e8, v11
    v_fmamk_f32 v41, v41, 0xbdd2d3e8, v11
    v_fmamk_f32 v42, v42, 0xbdd2d3e8, v11
    v_fmamk_f32 v43, v43, 0xbdd2d3e8, v11
    s_waitcnt vmcnt(22)
    v_mfma_f32_32x32x16_bf16 v[80:95], v[168:171], a[24:27], v[80:95]
    v_mul_f32 v40, v116, v40
    v_mul_f32 v41, v117, v41
    v_mul_f32 v42, v118, v42
    v_mul_f32 v43, v119, v43
    v_mfma_f32_32x32x16_bf16 v[96:111], v[168:171], a[168:171], v[96:111]
    buffer_load_dwordx4 v[168:171], v1, s[8:11], s21 offen offset:0
    v_exp_f32 v40, v40
    v_exp_f32 v41, v41
    v_exp_f32 v42, v42
    v_mfma_f32_32x32x16_bf16 v[80:95], v[172:175], a[28:31], v[80:95]
    v_exp_f32 v43, v43
    v_add_f32 v40, 1.0, v40
    v_mfma_f32_32x32x16_bf16 v[96:111], v[172:175], a[172:175], v[96:111]
    buffer_load_dwordx4 v[172:175], v1, s[8:11], s21 offen offset:1024
    v_add_f32 v41, 1.0, v41
    v_add_f32 v42, 1.0, v42
    v_add_f32 v43, 1.0, v43
    v_rcp_f32 v40, v40
    s_waitcnt vmcnt(22)
    v_mfma_f32_32x32x16_bf16 v[80:95], v[176:179], a[32:35], v[80:95]
    v_rcp_f32 v41, v41
    v_rcp_f32 v42, v42
    v_mfma_f32_32x32x16_bf16 v[96:111], v[176:179], a[176:179], v[96:111]
    buffer_load_dwordx4 v[176:179], v1, s[8:11], s21 offen offset:2048
    v_rcp_f32 v43, v43
    v_mul_f32 v40, v116, v40
    v_mul_f32 v41, v117, v41
    v_mul_f32 v42, v118, v42
    v_mfma_f32_32x32x16_bf16 v[80:95], v[180:183], a[36:39], v[80:95]
    v_mul_f32 v43, v119, v43
    v_cvt_pk_bf16_f32 v34, v40, v41
    v_cvt_pk_bf16_f32 v35, v42, v43
    ds_write_b128 v6, v[32:35] offset:2048
    v_mfma_f32_32x32x16_bf16 v[96:111], v[180:183], a[180:183], v[96:111]
    buffer_load_dwordx4 v[180:183], v1, s[8:11], s21 offen offset:3072
    s_add_u32 s21, s21, 4096
    v_mul_f32 v40, v120, v120
    v_mul_f32 v41, v121, v121
    v_mul_f32 v42, v122, v122
    v_mul_f32 v43, v123, v123
    s_waitcnt vmcnt(22)
    v_mfma_f32_32x32x16_bf16 v[80:95], v[184:187], a[40:43], v[80:95]
    v_fmamk_f32 v40, v40, 0xbdd2d3e8, v11
    v_fmamk_f32 v41, v41, 0xbdd2d3e8, v11
    v_fmamk_f32 v42, v42, 0xbdd2d3e8, v11
    v_fmamk_f32 v43, v43, 0xbdd2d3e8, v11
    v_mfma_f32_32x32x16_bf16 v[96:111], v[184:187], a[184:187], v[96:111]
    buffer_load_dwordx4 v[184:187], v1, s[8:11], s21 offen offset:0
    v_mul_f32 v40, v120, v40
    v_mul_f32 v41, v121, v41
    v_mul_f32 v42, v122, v42
    v_mul_f32 v43, v123, v43
    v_exp_f32 v40, v40
    v_mfma_f32_32x32x16_bf16 v[80:95], v[188:191], a[44:47], v[80:95]
    v_exp_f32 v41, v41
    v_exp_f32 v42, v42
    v_mfma_f32_32x32x16_bf16 v[96:111], v[188:191], a[188:191], v[96:111]
    buffer_load_dwordx4 v[188:191], v1, s[8:11], s21 offen offset:1024
    v_exp_f32 v43, v43
    v_add_f32 v40, 1.0, v40
    v_add_f32 v41, 1.0, v41
    s_waitcnt vmcnt(22)
    v_mfma_f32_32x32x16_bf16 v[80:95], v[192:195], a[48:51], v[80:95]
    v_add_f32 v42, 1.0, v42
    v_add_f32 v43, 1.0, v43
    v_rcp_f32 v40, v40
    v_mfma_f32_32x32x16_bf16 v[96:111], v[192:195], a[192:195], v[96:111]
    s_mov_b32 s21, s22
    s_add_u32 s22, s22, 36864
    buffer_load_dwordx4 v[192:195], v1, s[8:11], s21 offen offset:0
    v_rcp_f32 v41, v41
    v_rcp_f32 v42, v42
    v_rcp_f32 v43, v43
    v_mfma_f32_32x32x16_bf16 v[80:95], v[196:199], a[52:55], v[80:95]
    v_mul_f32 v40, v120, v40
    v_mul_f32 v41, v121, v41
    v_mul_f32 v42, v122, v42
    v_mul_f32 v43, v123, v43
    v_mfma_f32_32x32x16_bf16 v[96:111], v[196:199], a[196:199], v[96:111]
    buffer_load_dwordx4 v[196:199], v1, s[8:11], s21 offen offset:1024
    v_cvt_pk_bf16_f32 v36, v40, v41
    v_cvt_pk_bf16_f32 v37, v42, v43
    v_mul_f32 v40, v124, v124
    v_mul_f32 v41, v125, v125
    s_waitcnt vmcnt(22)
    v_mfma_f32_32x32x16_bf16 v[80:95], v[200:203], a[56:59], v[80:95]
    v_mul_f32 v42, v126, v126
    v_mul_f32 v43, v127, v127
    v_fmamk_f32 v40, v40, 0xbdd2d3e8, v11
    v_fmamk_f32 v41, v41, 0xbdd2d3e8, v11
    v_fmamk_f32 v42, v42, 0xbdd2d3e8, v11
    v_mfma_f32_32x32x16_bf16 v[96:111], v[200:203], a[200:203], v[96:111]
    buffer_load_dwordx4 v[200:203], v1, s[8:11], s21 offen offset:2048
    v_fmamk_f32 v43, v43, 0xbdd2d3e8, v11
    v_mul_f32 v40, v124, v40
    v_mul_f32 v41, v125, v41
    v_mul_f32 v42, v126, v42
    v_mfma_f32_32x32x16_bf16 v[80:95], v[204:207], a[60:63], v[80:95]
    v_mul_f32 v43, v127, v43
    v_exp_f32 v40, v40
    v_exp_f32 v41, v41
    v_mfma_f32_32x32x16_bf16 v[96:111], v[204:207], a[204:207], v[96:111]
    buffer_load_dwordx4 v[204:207], v1, s[8:11], s21 offen offset:3072
    s_add_u32 s21, s21, 4096
    v_exp_f32 v42, v42
    v_exp_f32 v43, v43
    s_waitcnt vmcnt(22)
    v_mfma_f32_32x32x16_bf16 v[80:95], v[208:211], a[64:67], v[80:95]
    v_add_f32 v40, 1.0, v40
    v_add_f32 v41, 1.0, v41
    v_add_f32 v42, 1.0, v42
    v_add_f32 v43, 1.0, v43
    v_rcp_f32 v40, v40
    v_mfma_f32_32x32x16_bf16 v[96:111], v[208:211], a[208:211], v[96:111]
    buffer_load_dwordx4 v[208:211], v1, s[8:11], s21 offen offset:0
    v_rcp_f32 v41, v41
    v_rcp_f32 v42, v42
    v_mfma_f32_32x32x16_bf16 v[80:95], v[212:215], a[68:71], v[80:95]
    v_rcp_f32 v43, v43
    v_mul_f32 v40, v124, v40
    v_mul_f32 v41, v125, v41
    v_mfma_f32_32x32x16_bf16 v[96:111], v[212:215], a[212:215], v[96:111]
    buffer_load_dwordx4 v[212:215], v1, s[8:11], s21 offen offset:1024
    v_mul_f32 v42, v126, v42
    v_mul_f32 v43, v127, v43
    v_cvt_pk_bf16_f32 v38, v40, v41
    v_cvt_pk_bf16_f32 v39, v42, v43
    s_waitcnt vmcnt(22)
    v_mfma_f32_32x32x16_bf16 v[80:95], v[216:219], a[72:75], v[80:95]
    ds_write_b128 v6, v[36:39] offset:3072
    v_mul_f32 v40, v128, v128
    v_mul_f32 v41, v129, v129
    v_mul_f32 v42, v130, v130
    v_mfma_f32_32x32x16_bf16 v[96:111], v[216:219], a[216:219], v[96:111]
    buffer_load_dwordx4 v[216:219], v1, s[8:11], s21 offen offset:2048
    v_mul_f32 v43, v131, v131
    v_fmamk_f32 v40, v40, 0xbdd2d3e8, v11
    v_fmamk_f32 v41, v41, 0xbdd2d3e8, v11
    v_fmamk_f32 v42, v42, 0xbdd2d3e8, v11
    v_mfma_f32_32x32x16_bf16 v[80:95], v[220:223], a[76:79], v[80:95]
    v_fmamk_f32 v43, v43, 0xbdd2d3e8, v11
    v_mul_f32 v40, v128, v40
    v_mul_f32 v41, v129, v41
    v_mul_f32 v42, v130, v42
    v_mul_f32 v43, v131, v43
    v_mfma_f32_32x32x16_bf16 v[96:111], v[220:223], a[220:223], v[96:111]
    buffer_load_dwordx4 v[220:223], v1, s[8:11], s21 offen offset:3072
    s_add_u32 s21, s21, 4096
    v_exp_f32 v40, v40
    v_exp_f32 v41, v41
    s_waitcnt vmcnt(22)
    v_mfma_f32_32x32x16_bf16 v[80:95], v[224:227], a[80:83], v[80:95]
    v_exp_f32 v42, v42
    v_exp_f32 v43, v43
    v_add_f32 v40, 1.0, v40
    v_mfma_f32_32x32x16_bf16 v[96:111], v[224:227], a[224:227], v[96:111]
    buffer_load_dwordx4 v[224:227], v1, s[8:11], s21 offen offset:0
    v_add_f32 v41, 1.0, v41
    v_add_f32 v42, 1.0, v42
    v_add_f32 v43, 1.0, v43
    v_rcp_f32 v40, v40
    v_mfma_f32_32x32x16_bf16 v[80:95], v[228:231], a[84:87], v[80:95]
    v_rcp_f32 v41, v41
    v_rcp_f32 v42, v42
    v_mfma_f32_32x32x16_bf16 v[96:111], v[228:231], a[228:231], v[96:111]
    buffer_load_dwordx4 v[228:231], v1, s[8:11], s21 offen offset:1024
    v_rcp_f32 v43, v43
    v_mul_f32 v40, v128, v40
    v_mul_f32 v41, v129, v41
    s_waitcnt vmcnt(22)
    v_mfma_f32_32x32x16_bf16 v[80:95], v[232:235], a[88:91], v[80:95]
    v_mul_f32 v42, v130, v42
    v_mul_f32 v43, v131, v43
    v_cvt_pk_bf16_f32 v32, v40, v41
    v_cvt_pk_bf16_f32 v33, v42, v43
    v_mul_f32 v40, v132, v132
    v_mfma_f32_32x32x16_bf16 v[96:111], v[232:235], a[232:235], v[96:111]
    buffer_load_dwordx4 v[232:235], v1, s[8:11], s21 offen offset:2048
    v_mul_f32 v41, v133, v133
    v_mul_f32 v42, v134, v134
    v_mul_f32 v43, v135, v135
    v_fmamk_f32 v40, v40, 0xbdd2d3e8, v11
    v_mfma_f32_32x32x16_bf16 v[80:95], v[236:239], a[92:95], v[80:95]
    v_fmamk_f32 v41, v41, 0xbdd2d3e8, v11
    v_fmamk_f32 v42, v42, 0xbdd2d3e8, v11
    v_fmamk_f32 v43, v43, 0xbdd2d3e8, v11
    v_mul_f32 v40, v132, v40
    v_mul_f32 v41, v133, v41
    v_mfma_f32_32x32x16_bf16 v[96:111], v[236:239], a[236:239], v[96:111]
    buffer_load_dwordx4 v[236:239], v1, s[8:11], s21 offen offset:3072
    s_add_u32 s21, s21, 4096
    v_mul_f32 v42, v134, v42
    v_mul_f32 v43, v135, v43
    v_exp_f32 v40, v40
    s_waitcnt vmcnt(22)
    v_mfma_f32_32x32x16_bf16 v[80:95], v[144:147], a[96:99], v[80:95]
    v_exp_f32 v41, v41
    v_exp_f32 v42, v42
    v_exp_f32 v43, v43
    v_mfma_f32_32x32x16_bf16 v[96:111], v[144:147], a[240:243], v[96:111]
    buffer_load_dwordx4 v[144:147], v1, s[8:11], s21 offen offset:0
    v_add_f32 v40, 1.0, v40
    v_add_f32 v41, 1.0, v41
    v_add_f32 v42, 1.0, v42
    v_add_f32 v43, 1.0, v43
    v_mfma_f32_32x32x16_bf16 v[80:95], v[148:151], a[100:103], v[80:95]
    v_rcp_f32 v40, v40
    v_rcp_f32 v41, v41
    v_mfma_f32_32x32x16_bf16 v[96:111], v[148:151], a[244:247], v[96:111]
    buffer_load_dwordx4 v[148:151], v1, s[8:11], s21 offen offset:1024
    v_rcp_f32 v42, v42
    v_rcp_f32 v43, v43
    v_mul_f32 v40, v132, v40
    s_waitcnt vmcnt(22)
    v_mfma_f32_32x32x16_bf16 v[80:95], v[152:155], a[104:107], v[80:95]
    v_mul_f32 v41, v133, v41
    v_mul_f32 v42, v134, v42
    v_mul_f32 v43, v135, v43
    v_cvt_pk_bf16_f32 v34, v40, v41
    v_mfma_f32_32x32x16_bf16 v[96:111], v[152:155], a[248:251], v[96:111]
    buffer_load_dwordx4 v[152:155], v1, s[8:11], s21 offen offset:2048
    v_cvt_pk_bf16_f32 v35, v42, v43
    ds_write_b128 v7, v[32:35] offset:2048
    v_mul_f32 v40, v136, v136
    v_mul_f32 v41, v137, v137
    v_mfma_f32_32x32x16_bf16 v[80:95], v[156:159], a[108:111], v[80:95]
    v_mul_f32 v42, v138, v138
    v_mul_f32 v43, v139, v139
    v_fmamk_f32 v40, v40, 0xbdd2d3e8, v11
    v_fmamk_f32 v41, v41, 0xbdd2d3e8, v11
    v_mfma_f32_32x32x16_bf16 v[96:111], v[156:159], a[252:255], v[96:111]
    buffer_load_dwordx4 v[156:159], v1, s[8:11], s21 offen offset:3072
    s_add_u32 s21, s21, 4096
    v_fmamk_f32 v42, v42, 0xbdd2d3e8, v11
    v_fmamk_f32 v43, v43, 0xbdd2d3e8, v11
    v_mul_f32 v40, v136, v40
    v_mul_f32 v41, v137, v41
    v_mul_f32 v42, v138, v42
    s_waitcnt vmcnt(22)
    v_mfma_f32_32x32x16_bf16 v[80:95], v[160:163], a[112:115], v[80:95]
    v_mul_f32 v43, v139, v43
    v_exp_f32 v40, v40
    v_exp_f32 v41, v41
    v_mfma_f32_32x32x16_bf16 v[96:111], v[160:163], v[48:51], v[96:111]
    buffer_load_dwordx4 v[160:163], v1, s[8:11], s21 offen offset:0
    v_exp_f32 v42, v42
    v_exp_f32 v43, v43
    v_mfma_f32_32x32x16_bf16 v[80:95], v[164:167], a[116:119], v[80:95]
    v_add_f32 v40, 1.0, v40
    v_add_f32 v41, 1.0, v41
    v_add_f32 v42, 1.0, v42
    v_add_f32 v43, 1.0, v43
    v_mfma_f32_32x32x16_bf16 v[96:111], v[164:167], v[52:55], v[96:111]
    buffer_load_dwordx4 v[164:167], v1, s[8:11], s21 offen offset:1024
    v_rcp_f32 v40, v40
    v_rcp_f32 v41, v41
    v_rcp_f32 v42, v42
    s_waitcnt vmcnt(22)
    v_mfma_f32_32x32x16_bf16 v[80:95], v[168:171], a[120:123], v[80:95]
    v_rcp_f32 v43, v43
    v_mul_f32 v40, v136, v40
    v_mfma_f32_32x32x16_bf16 v[96:111], v[168:171], v[56:59], v[96:111]
    s_add_u32 s21, s21, 2048
    s_add_u32 s21, s21, s28
    buffer_load_dwordx4 v[168:171], v1, s[8:11], s21 offen offset:0
    ds_read_b128 v[16:19], v9 offset:384
    ds_read_b128 v[20:23], v9 offset:400
    ds_read_b128 v[24:27], v9 offset:416
    ds_read_b128 v[28:31], v9 offset:432
    v_mul_f32 v41, v137, v41
    v_mul_f32 v42, v138, v42
    v_mul_f32 v43, v139, v43
    v_cvt_pk_bf16_f32 v36, v40, v41
    v_cvt_pk_bf16_f32 v37, v42, v43
    v_mfma_f32_32x32x16_bf16 v[80:95], v[172:175], a[124:127], v[80:95]
    v_mul_f32 v40, v140, v140
    v_mul_f32 v41, v141, v141
    v_mul_f32 v42, v142, v142
    v_mul_f32 v43, v143, v143
    v_mfma_f32_32x32x16_bf16 v[96:111], v[172:175], v[60:63], v[96:111]
    buffer_load_dwordx4 v[172:175], v1, s[8:11], s21 offen offset:1024
    v_fmamk_f32 v40, v40, 0xbdd2d3e8, v11
    v_fmamk_f32 v41, v41, 0xbdd2d3e8, v11
    v_fmamk_f32 v42, v42, 0xbdd2d3e8, v11
    v_fmamk_f32 v43, v43, 0xbdd2d3e8, v11
    v_mul_f32 v40, v140, v40
    s_waitcnt vmcnt(22)
    v_mfma_f32_32x32x16_bf16 v[80:95], v[176:179], a[128:131], v[80:95]
    v_mul_f32 v41, v141, v41
    v_mul_f32 v42, v142, v42
    v_mul_f32 v43, v143, v43
    v_exp_f32 v40, v40
    v_mfma_f32_32x32x16_bf16 v[96:111], v[176:179], v[64:67], v[96:111]
    buffer_load_dwordx4 v[176:179], v1, s[8:11], s21 offen offset:2048
    v_exp_f32 v41, v41
    v_exp_f32 v42, v42
    v_mfma_f32_32x32x16_bf16 v[80:95], v[180:183], a[132:135], v[80:95]
    v_exp_f32 v43, v43
    v_add_f32 v40, 1.0, v40
    v_add_f32 v41, 1.0, v41
    v_mfma_f32_32x32x16_bf16 v[96:111], v[180:183], v[68:71], v[96:111]
    buffer_load_dwordx4 v[180:183], v1, s[8:11], s21 offen offset:3072
    s_add_u32 s21, s21, 4096
    v_add_f32 v42, 1.0, v42
    v_add_f32 v43, 1.0, v43
    v_rcp_f32 v40, v40
    v_rcp_f32 v41, v41
    s_waitcnt vmcnt(22)
    v_mfma_f32_32x32x16_bf16 v[80:95], v[184:187], a[136:139], v[80:95]
    v_rcp_f32 v42, v42
    v_rcp_f32 v43, v43
    v_mfma_f32_32x32x16_bf16 v[96:111], v[184:187], v[72:75], v[96:111]
    buffer_load_dwordx4 v[184:187], v1, s[8:11], s21 offen offset:0
    v_mul_f32 v40, v140, v40
    v_mul_f32 v41, v141, v41
    v_mul_f32 v42, v142, v42
    v_mul_f32 v43, v143, v43
    v_mfma_f32_32x32x16_bf16 v[80:95], v[188:191], a[140:143], v[80:95]
    v_cvt_pk_bf16_f32 v38, v40, v41
    v_cvt_pk_bf16_f32 v39, v42, v43
    ds_write_b128 v7, v[36:39] offset:3072
    v_mfma_f32_32x32x16_bf16 v[96:111], v[188:191], v[76:79], v[96:111]
    buffer_load_dwordx4 v[188:191], v1, s[8:11], s21 offen offset:1024
    s_waitcnt lgkmcnt(1)
    s_waitcnt vmcnt(22)
    v_mfma_f32_32x32x16_bf16 v[112:127], v[192:195], a[0:3], v[16:31]
    v_mfma_f32_32x32x16_bf16 v[128:143], v[192:195], a[144:147], v[16:31]
    buffer_load_dwordx4 v[192:195], v1, s[8:11], s21 offen offset:2048
    v_mfma_f32_32x32x16_bf16 v[112:127], v[196:199], a[4:7], v[112:127]
    s_nop 0
    v_mul_f32 v40, v80, v80
    v_mul_f32 v41, v81, v81
    v_mul_f32 v42, v82, v82
    v_mul_f32 v43, v83, v83
    v_fmamk_f32 v40, v40, 0xbdd2d3e8, v11
    v_mfma_f32_32x32x16_bf16 v[128:143], v[196:199], a[148:151], v[128:143]
    buffer_load_dwordx4 v[196:199], v1, s[8:11], s21 offen offset:3072
    s_add_u32 s21, s21, 4096
    v_fmamk_f32 v41, v41, 0xbdd2d3e8, v11
    v_fmamk_f32 v42, v42, 0xbdd2d3e8, v11
    v_fmamk_f32 v43, v43, 0xbdd2d3e8, v11
    v_mul_f32 v40, v80, v40
    v_mul_f32 v41, v81, v41
    s_waitcnt vmcnt(22)
    v_mfma_f32_32x32x16_bf16 v[112:127], v[200:203], a[8:11], v[112:127]
    v_mul_f32 v42, v82, v42
    v_mul_f32 v43, v83, v43
    v_exp_f32 v40, v40
    v_mfma_f32_32x32x16_bf16 v[128:143], v[200:203], a[152:155], v[128:143]
    buffer_load_dwordx4 v[200:203], v1, s[8:11], s21 offen offset:0
    v_exp_f32 v41, v41
    v_exp_f32 v42, v42
    v_exp_f32 v43, v43
    v_mfma_f32_32x32x16_bf16 v[112:127], v[204:207], a[12:15], v[112:127]
    v_add_f32 v40, 1.0, v40
    v_add_f32 v41, 1.0, v41
    v_add_f32 v42, 1.0, v42
    v_mfma_f32_32x32x16_bf16 v[128:143], v[204:207], a[156:159], v[128:143]
    buffer_load_dwordx4 v[204:207], v1, s[8:11], s21 offen offset:1024
    v_add_f32 v43, 1.0, v43
    v_rcp_f32 v40, v40
    v_rcp_f32 v41, v41
    s_waitcnt vmcnt(22)
    v_mfma_f32_32x32x16_bf16 v[112:127], v[208:211], a[16:19], v[112:127]
    v_rcp_f32 v42, v42
    v_rcp_f32 v43, v43
    v_mfma_f32_32x32x16_bf16 v[128:143], v[208:211], a[160:163], v[128:143]
    buffer_load_dwordx4 v[208:211], v1, s[8:11], s21 offen offset:2048
    v_mul_f32 v40, v80, v40
    v_mul_f32 v41, v81, v41
    v_mul_f32 v42, v82, v42
    v_mul_f32 v43, v83, v43
    v_cvt_pk_bf16_f32 v32, v40, v41
    v_mfma_f32_32x32x16_bf16 v[112:127], v[212:215], a[20:23], v[112:127]
    v_cvt_pk_bf16_f32 v33, v42, v43
    v_mul_f32 v40, v84, v84
    v_mul_f32 v41, v85, v85
    v_mul_f32 v42, v86, v86
    v_mfma_f32_32x32x16_bf16 v[128:143], v[212:215], a[164:167], v[128:143]
    buffer_load_dwordx4 v[212:215], v1, s[8:11], s21 offen offset:3072
    s_add_u32 s21, s21, 4096
    v_mul_f32 v43, v87, v87
    v_fmamk_f32 v40, v40, 0xbdd2d3e8, v11
    v_fmamk_f32 v41, v41, 0xbdd2d3e8, v11
    v_fmamk_f32 v42, v42, 0xbdd2d3e8, v11
    v_fmamk_f32 v43, v43, 0xbdd2d3e8, v11
    s_waitcnt vmcnt(22)
    v_mfma_f32_32x32x16_bf16 v[112:127], v[216:219], a[24:27], v[112:127]
    v_mul_f32 v40, v84, v40
    v_mul_f32 v41, v85, v41
    v_mul_f32 v42, v86, v42
    v_mul_f32 v43, v87, v43
    v_mfma_f32_32x32x16_bf16 v[128:143], v[216:219], a[168:171], v[128:143]
    buffer_load_dwordx4 v[216:219], v1, s[8:11], s21 offen offset:0
    v_exp_f32 v40, v40
    v_exp_f32 v41, v41
    v_exp_f32 v42, v42
    v_mfma_f32_32x32x16_bf16 v[112:127], v[220:223], a[28:31], v[112:127]
    v_exp_f32 v43, v43
    v_add_f32 v40, 1.0, v40
    v_mfma_f32_32x32x16_bf16 v[128:143], v[220:223], a[172:175], v[128:143]
    buffer_load_dwordx4 v[220:223], v1, s[8:11], s21 offen offset:1024
    v_add_f32 v41, 1.0, v41
    v_add_f32 v42, 1.0, v42
    v_add_f32 v43, 1.0, v43
    v_rcp_f32 v40, v40
    s_waitcnt vmcnt(22)
    v_mfma_f32_32x32x16_bf16 v[112:127], v[224:227], a[32:35], v[112:127]
    v_rcp_f32 v41, v41
    v_rcp_f32 v42, v42
    v_mfma_f32_32x32x16_bf16 v[128:143], v[224:227], a[176:179], v[128:143]
    buffer_load_dwordx4 v[224:227], v1, s[8:11], s21 offen offset:2048
    v_rcp_f32 v43, v43
    v_mul_f32 v40, v84, v40
    v_mul_f32 v41, v85, v41
    v_mul_f32 v42, v86, v42
    v_mfma_f32_32x32x16_bf16 v[112:127], v[228:231], a[36:39], v[112:127]
    v_mul_f32 v43, v87, v43
    v_cvt_pk_bf16_f32 v34, v40, v41
    v_cvt_pk_bf16_f32 v35, v42, v43
    ds_write_b128 v6, v[32:35] offset:4096
    v_mfma_f32_32x32x16_bf16 v[128:143], v[228:231], a[180:183], v[128:143]
    buffer_load_dwordx4 v[228:231], v1, s[8:11], s21 offen offset:3072
    s_add_u32 s21, s21, 4096
    v_mul_f32 v40, v88, v88
    v_mul_f32 v41, v89, v89
    v_mul_f32 v42, v90, v90
    v_mul_f32 v43, v91, v91
    s_waitcnt vmcnt(22)
    v_mfma_f32_32x32x16_bf16 v[112:127], v[232:235], a[40:43], v[112:127]
    v_fmamk_f32 v40, v40, 0xbdd2d3e8, v11
    v_fmamk_f32 v41, v41, 0xbdd2d3e8, v11
    v_fmamk_f32 v42, v42, 0xbdd2d3e8, v11
    v_fmamk_f32 v43, v43, 0xbdd2d3e8, v11
    v_mfma_f32_32x32x16_bf16 v[128:143], v[232:235], a[184:187], v[128:143]
    buffer_load_dwordx4 v[232:235], v1, s[8:11], s21 offen offset:0
    v_mul_f32 v40, v88, v40
    v_mul_f32 v41, v89, v41
    v_mul_f32 v42, v90, v42
    v_mul_f32 v43, v91, v43
    v_exp_f32 v40, v40
    v_mfma_f32_32x32x16_bf16 v[112:127], v[236:239], a[44:47], v[112:127]
    v_exp_f32 v41, v41
    v_exp_f32 v42, v42
    v_mfma_f32_32x32x16_bf16 v[128:143], v[236:239], a[188:191], v[128:143]
    buffer_load_dwordx4 v[236:239], v1, s[8:11], s21 offen offset:1024
    v_exp_f32 v43, v43
    v_add_f32 v40, 1.0, v40
    v_add_f32 v41, 1.0, v41
    s_waitcnt vmcnt(22)
    v_mfma_f32_32x32x16_bf16 v[112:127], v[144:147], a[48:51], v[112:127]
    v_add_f32 v42, 1.0, v42
    v_add_f32 v43, 1.0, v43
    v_rcp_f32 v40, v40
    v_mfma_f32_32x32x16_bf16 v[128:143], v[144:147], a[192:195], v[128:143]
    s_mov_b32 s21, s23
    s_add_u32 s23, s23, 36864
    buffer_load_dwordx4 v[144:147], v1, s[8:11], s21 offen offset:0
    v_rcp_f32 v41, v41
    v_rcp_f32 v42, v42
    v_rcp_f32 v43, v43
    v_mfma_f32_32x32x16_bf16 v[112:127], v[148:151], a[52:55], v[112:127]
    v_mul_f32 v40, v88, v40
    v_mul_f32 v41, v89, v41
    v_mul_f32 v42, v90, v42
    v_mul_f32 v43, v91, v43
    v_mfma_f32_32x32x16_bf16 v[128:143], v[148:151], a[196:199], v[128:143]
    buffer_load_dwordx4 v[148:151], v1, s[8:11], s21 offen offset:1024
    v_cvt_pk_bf16_f32 v36, v40, v41
    v_cvt_pk_bf16_f32 v37, v42, v43
    v_mul_f32 v40, v92, v92
    v_mul_f32 v41, v93, v93
    s_waitcnt vmcnt(22)
    v_mfma_f32_32x32x16_bf16 v[112:127], v[152:155], a[56:59], v[112:127]
    v_mul_f32 v42, v94, v94
    v_mul_f32 v43, v95, v95
    v_fmamk_f32 v40, v40, 0xbdd2d3e8, v11
    v_fmamk_f32 v41, v41, 0xbdd2d3e8, v11
    v_fmamk_f32 v42, v42, 0xbdd2d3e8, v11
    v_mfma_f32_32x32x16_bf16 v[128:143], v[152:155], a[200:203], v[128:143]
    buffer_load_dwordx4 v[152:155], v1, s[8:11], s21 offen offset:2048
    v_fmamk_f32 v43, v43, 0xbdd2d3e8, v11
    v_mul_f32 v40, v92, v40
    v_mul_f32 v41, v93, v41
    v_mul_f32 v42, v94, v42
    v_mfma_f32_32x32x16_bf16 v[112:127], v[156:159], a[60:63], v[112:127]
    v_mul_f32 v43, v95, v43
    v_exp_f32 v40, v40
    v_exp_f32 v41, v41
    v_mfma_f32_32x32x16_bf16 v[128:143], v[156:159], a[204:207], v[128:143]
    buffer_load_dwordx4 v[156:159], v1, s[8:11], s21 offen offset:3072
    s_add_u32 s21, s21, 4096
    v_exp_f32 v42, v42
    v_exp_f32 v43, v43
    s_waitcnt vmcnt(22)
    v_mfma_f32_32x32x16_bf16 v[112:127], v[160:163], a[64:67], v[112:127]
    v_add_f32 v40, 1.0, v40
    v_add_f32 v41, 1.0, v41
    v_add_f32 v42, 1.0, v42
    v_add_f32 v43, 1.0, v43
    v_rcp_f32 v40, v40
    v_mfma_f32_32x32x16_bf16 v[128:143], v[160:163], a[208:211], v[128:143]
    buffer_load_dwordx4 v[160:163], v1, s[8:11], s21 offen offset:0
    v_rcp_f32 v41, v41
    v_rcp_f32 v42, v42
    v_mfma_f32_32x32x16_bf16 v[112:127], v[164:167], a[68:71], v[112:127]
    v_rcp_f32 v43, v43
    v_mul_f32 v40, v92, v40
    v_mul_f32 v41, v93, v41
    v_mfma_f32_32x32x16_bf16 v[128:143], v[164:167], a[212:215], v[128:143]
    buffer_load_dwordx4 v[164:167], v1, s[8:11], s21 offen offset:1024
    v_mul_f32 v42, v94, v42
    v_mul_f32 v43, v95, v43
    v_cvt_pk_bf16_f32 v38, v40, v41
    v_cvt_pk_bf16_f32 v39, v42, v43
    s_waitcnt vmcnt(22)
    v_mfma_f32_32x32x16_bf16 v[112:127], v[168:171], a[72:75], v[112:127]
    ds_write_b128 v6, v[36:39] offset:5120
    v_mul_f32 v40, v96, v96
    v_mul_f32 v41, v97, v97
    v_mul_f32 v42, v98, v98
    v_mfma_f32_32x32x16_bf16 v[128:143], v[168:171], a[216:219], v[128:143]
    buffer_load_dwordx4 v[168:171], v1, s[8:11], s21 offen offset:2048
    v_mul_f32 v43, v99, v99
    v_fmamk_f32 v40, v40, 0xbdd2d3e8, v11
    v_fmamk_f32 v41, v41, 0xbdd2d3e8, v11
    v_fmamk_f32 v42, v42, 0xbdd2d3e8, v11
    v_mfma_f32_32x32x16_bf16 v[112:127], v[172:175], a[76:79], v[112:127]
    v_fmamk_f32 v43, v43, 0xbdd2d3e8, v11
    v_mul_f32 v40, v96, v40
    v_mul_f32 v41, v97, v41
    v_mul_f32 v42, v98, v42
    v_mul_f32 v43, v99, v43
    v_mfma_f32_32x32x16_bf16 v[128:143], v[172:175], a[220:223], v[128:143]
    buffer_load_dwordx4 v[172:175], v1, s[8:11], s21 offen offset:3072
    s_add_u32 s21, s21, 4096
    v_exp_f32 v40, v40
    v_exp_f32 v41, v41
    s_waitcnt vmcnt(22)
    v_mfma_f32_32x32x16_bf16 v[112:127], v[176:179], a[80:83], v[112:127]
    v_exp_f32 v42, v42
    v_exp_f32 v43, v43
    v_add_f32 v40, 1.0, v40
    v_mfma_f32_32x32x16_bf16 v[128:143], v[176:179], a[224:227], v[128:143]
    buffer_load_dwordx4 v[176:179], v1, s[8:11], s21 offen offset:0
    v_add_f32 v41, 1.0, v41
    v_add_f32 v42, 1.0, v42
    v_add_f32 v43, 1.0, v43
    v_rcp_f32 v40, v40
    v_mfma_f32_32x32x16_bf16 v[112:127], v[180:183], a[84:87], v[112:127]
    v_rcp_f32 v41, v41
    v_rcp_f32 v42, v42
    v_mfma_f32_32x32x16_bf16 v[128:143], v[180:183], a[228:231], v[128:143]
    buffer_load_dwordx4 v[180:183], v1, s[8:11], s21 offen offset:1024
    v_rcp_f32 v43, v43
    v_mul_f32 v40, v96, v40
    v_mul_f32 v41, v97, v41
    s_waitcnt vmcnt(22)
    v_mfma_f32_32x32x16_bf16 v[112:127], v[184:187], a[88:91], v[112:127]
    v_mul_f32 v42, v98, v42
    v_mul_f32 v43, v99, v43
    v_cvt_pk_bf16_f32 v32, v40, v41
    v_cvt_pk_bf16_f32 v33, v42, v43
    v_mul_f32 v40, v100, v100
    v_mfma_f32_32x32x16_bf16 v[128:143], v[184:187], a[232:235], v[128:143]
    buffer_load_dwordx4 v[184:187], v1, s[8:11], s21 offen offset:2048
    v_mul_f32 v41, v101, v101
    v_mul_f32 v42, v102, v102
    v_mul_f32 v43, v103, v103
    v_fmamk_f32 v40, v40, 0xbdd2d3e8, v11
    v_mfma_f32_32x32x16_bf16 v[112:127], v[188:191], a[92:95], v[112:127]
    v_fmamk_f32 v41, v41, 0xbdd2d3e8, v11
    v_fmamk_f32 v42, v42, 0xbdd2d3e8, v11
    v_fmamk_f32 v43, v43, 0xbdd2d3e8, v11
    v_mul_f32 v40, v100, v40
    v_mul_f32 v41, v101, v41
    v_mfma_f32_32x32x16_bf16 v[128:143], v[188:191], a[236:239], v[128:143]
    buffer_load_dwordx4 v[188:191], v1, s[8:11], s21 offen offset:3072
    s_add_u32 s21, s21, 4096
    v_mul_f32 v42, v102, v42
    v_mul_f32 v43, v103, v43
    v_exp_f32 v40, v40
    s_waitcnt vmcnt(22)
    v_mfma_f32_32x32x16_bf16 v[112:127], v[192:195], a[96:99], v[112:127]
    v_exp_f32 v41, v41
    v_exp_f32 v42, v42
    v_exp_f32 v43, v43
    v_mfma_f32_32x32x16_bf16 v[128:143], v[192:195], a[240:243], v[128:143]
    buffer_load_dwordx4 v[192:195], v1, s[8:11], s21 offen offset:0
    v_add_f32 v40, 1.0, v40
    v_add_f32 v41, 1.0, v41
    v_add_f32 v42, 1.0, v42
    v_add_f32 v43, 1.0, v43
    v_mfma_f32_32x32x16_bf16 v[112:127], v[196:199], a[100:103], v[112:127]
    v_rcp_f32 v40, v40
    v_rcp_f32 v41, v41
    v_mfma_f32_32x32x16_bf16 v[128:143], v[196:199], a[244:247], v[128:143]
    buffer_load_dwordx4 v[196:199], v1, s[8:11], s21 offen offset:1024
    v_rcp_f32 v42, v42
    v_rcp_f32 v43, v43
    v_mul_f32 v40, v100, v40
    s_waitcnt vmcnt(22)
    v_mfma_f32_32x32x16_bf16 v[112:127], v[200:203], a[104:107], v[112:127]
    v_mul_f32 v41, v101, v41
    v_mul_f32 v42, v102, v42
    v_mul_f32 v43, v103, v43
    v_cvt_pk_bf16_f32 v34, v40, v41
    v_mfma_f32_32x32x16_bf16 v[128:143], v[200:203], a[248:251], v[128:143]
    s_add_u32 s21, s21, 2048
    s_add_u32 s21, s21, s29
    buffer_load_dwordx4 v[200:203], v1, s[8:11], s21 offen offset:0
    v_cvt_pk_bf16_f32 v35, v42, v43
    ds_write_b128 v7, v[32:35] offset:4096
    v_mul_f32 v40, v104, v104
    v_mul_f32 v41, v105, v105
    v_mfma_f32_32x32x16_bf16 v[112:127], v[204:207], a[108:111], v[112:127]
    v_mul_f32 v42, v106, v106
    v_mul_f32 v43, v107, v107
    v_fmamk_f32 v40, v40, 0xbdd2d3e8, v11
    v_fmamk_f32 v41, v41, 0xbdd2d3e8, v11
    v_mfma_f32_32x32x16_bf16 v[128:143], v[204:207], a[252:255], v[128:143]
    buffer_load_dwordx4 v[204:207], v1, s[8:11], s21 offen offset:1024
    v_fmamk_f32 v42, v42, 0xbdd2d3e8, v11
    v_fmamk_f32 v43, v43, 0xbdd2d3e8, v11
    v_mul_f32 v40, v104, v40
    v_mul_f32 v41, v105, v41
    v_mul_f32 v42, v106, v42
    s_waitcnt vmcnt(22)
    v_mfma_f32_32x32x16_bf16 v[112:127], v[208:211], a[112:115], v[112:127]
    v_mul_f32 v43, v107, v43
    v_exp_f32 v40, v40
    v_exp_f32 v41, v41
    v_mfma_f32_32x32x16_bf16 v[128:143], v[208:211], v[48:51], v[128:143]
    buffer_load_dwordx4 v[208:211], v1, s[8:11], s21 offen offset:2048
    v_exp_f32 v42, v42
    v_exp_f32 v43, v43
    v_mfma_f32_32x32x16_bf16 v[112:127], v[212:215], a[116:119], v[112:127]
    v_add_f32 v40, 1.0, v40
    v_add_f32 v41, 1.0, v41
    v_add_f32 v42, 1.0, v42
    v_add_f32 v43, 1.0, v43
    v_mfma_f32_32x32x16_bf16 v[128:143], v[212:215], v[52:55], v[128:143]
    buffer_load_dwordx4 v[212:215], v1, s[8:11], s21 offen offset:3072
    s_add_u32 s21, s21, 4096
    v_rcp_f32 v40, v40
    v_rcp_f32 v41, v41
    v_rcp_f32 v42, v42
    s_waitcnt vmcnt(22)
    v_mfma_f32_32x32x16_bf16 v[112:127], v[216:219], a[120:123], v[112:127]
    v_rcp_f32 v43, v43
    v_mul_f32 v40, v104, v40
    v_mfma_f32_32x32x16_bf16 v[128:143], v[216:219], v[56:59], v[128:143]
    buffer_load_dwordx4 v[216:219], v1, s[8:11], s21 offen offset:0
    v_mul_f32 v41, v105, v41
    v_mul_f32 v42, v106, v42
    v_mul_f32 v43, v107, v43
    v_cvt_pk_bf16_f32 v36, v40, v41
    v_cvt_pk_bf16_f32 v37, v42, v43
    v_mfma_f32_32x32x16_bf16 v[112:127], v[220:223], a[124:127], v[112:127]
    v_mul_f32 v40, v108, v108
    v_mul_f32 v41, v109, v109
    v_mul_f32 v42, v110, v110
    v_mul_f32 v43, v111, v111
    v_mfma_f32_32x32x16_bf16 v[128:143], v[220:223], v[60:63], v[128:143]
    buffer_load_dwordx4 v[220:223], v1, s[8:11], s21 offen offset:1024
    v_fmamk_f32 v40, v40, 0xbdd2d3e8, v11
    v_fmamk_f32 v41, v41, 0xbdd2d3e8, v11
    v_fmamk_f32 v42, v42, 0xbdd2d3e8, v11
    v_fmamk_f32 v43, v43, 0xbdd2d3e8, v11
    v_mul_f32 v40, v108, v40
    s_waitcnt vmcnt(22)
    v_mfma_f32_32x32x16_bf16 v[112:127], v[224:227], a[128:131], v[112:127]
    v_mul_f32 v41, v109, v41
    v_mul_f32 v42, v110, v42
    v_mul_f32 v43, v111, v43
    v_exp_f32 v40, v40
    v_mfma_f32_32x32x16_bf16 v[128:143], v[224:227], v[64:67], v[128:143]
    buffer_load_dwordx4 v[224:227], v1, s[8:11], s21 offen offset:2048
    v_exp_f32 v41, v41
    v_exp_f32 v42, v42
    v_mfma_f32_32x32x16_bf16 v[112:127], v[228:231], a[132:135], v[112:127]
    v_exp_f32 v43, v43
    v_add_f32 v40, 1.0, v40
    v_add_f32 v41, 1.0, v41
    v_mfma_f32_32x32x16_bf16 v[128:143], v[228:231], v[68:71], v[128:143]
    buffer_load_dwordx4 v[228:231], v1, s[8:11], s21 offen offset:3072
    s_add_u32 s21, s21, 4096
    v_add_f32 v42, 1.0, v42
    v_add_f32 v43, 1.0, v43
    v_rcp_f32 v40, v40
    v_rcp_f32 v41, v41
    s_waitcnt vmcnt(22)
    v_mfma_f32_32x32x16_bf16 v[112:127], v[232:235], a[136:139], v[112:127]
    v_rcp_f32 v42, v42
    v_rcp_f32 v43, v43
    v_mfma_f32_32x32x16_bf16 v[128:143], v[232:235], v[72:75], v[128:143]
    buffer_load_dwordx4 v[232:235], v1, s[8:11], s21 offen offset:0
    v_mul_f32 v40, v108, v40
    v_mul_f32 v41, v109, v41
    v_mul_f32 v42, v110, v42
    v_mul_f32 v43, v111, v43
    v_mfma_f32_32x32x16_bf16 v[112:127], v[236:239], a[140:143], v[112:127]
    v_cvt_pk_bf16_f32 v38, v40, v41
    v_cvt_pk_bf16_f32 v39, v42, v43
    ds_write_b128 v7, v[36:39] offset:5120
    v_mfma_f32_32x32x16_bf16 v[128:143], v[236:239], v[76:79], v[128:143]
    buffer_load_dwordx4 v[236:239], v1, s[8:11], s21 offen offset:1024
    buffer_load_dwordx4 v[16:19], v1, s[8:11], s21 offen offset:2048
    buffer_load_dwordx4 v[20:23], v1, s[8:11], s21 offen offset:3072
    s_add_u32 s21, s21, 4096
    buffer_load_dwordx4 v[24:27], v1, s[8:11], s21 offen offset:0
    buffer_load_dwordx4 v[28:31], v1, s[8:11], s21 offen offset:1024
    v_add_u32 v6, s48, v6
    v_add_u32 v7, s48, v7
    v_add_u32 v4, 73728, v4
    v_add_u32 v5, 73728, v5
    s_lshl_b32 s37, s20, 12
    v_add_u32 v12, s37, v1
    s_xor_b32 s37, s37, 4096
    v_add_u32 v13, s37, v1
    s_waitcnt lgkmcnt(0)
    s_barrier
    v_add_u32 v2, s44, v4
    v_add_u32 v3, s44, v5
    ds_read_b128 a[0:3], v2 offset:0
    ds_read_b128 a[144:147], v3 offset:0
    ds_read_b128 a[4:7], v2 offset:1024
    ds_read_b128 a[148:151], v3 offset:1024
    ds_read_b128 a[8:11], v2 offset:2048
    ds_read_b128 a[152:155], v3 offset:2048
    ds_read_b128 a[12:15], v2 offset:3072
    ds_read_b128 a[156:159], v3 offset:3072
    s_waitcnt vmcnt(26)
    s_waitcnt lgkmcnt(6)
    v_mfma_f32_32x32x16_bf16 v[80:95], v[144:147], a[0:3], 0
    v_mfma_f32_32x32x16_bf16 v[96:111], v[144:147], a[144:147], 0
    s_add_u32 s21, s21, 2048
    s_add_u32 s21, s21, s30
    buffer_load_dwordx4 v[144:147], v1, s[8:11], s21 offen offset:0
    ds_read_b128 a[16:19], v2 offset:4096
    ds_read_b128 a[160:163], v3 offset:4096
    s_waitcnt lgkmcnt(6)
    v_mfma_f32_32x32x16_bf16 v[80:95], v[148:151], a[4:7], v[80:95]
    v_mul_f32 v40, v112, v112
    v_mul_f32 v41, v113, v113
    v_mul_f32 v42, v114, v114
    v_mul_f32 v43, v115, v115
    v_fmamk_f32 v40, v40, 0xbdd2d3e8, v11
    v_fmamk_f32 v41, v41, 0xbdd2d3e8, v11
    v_mfma_f32_32x32x16_bf16 v[96:111], v[148:151], a[148:151], v[96:111]
    buffer_load_dwordx4 v[148:151], v1, s[8:11], s21 offen offset:1024
    ds_read_b128 a[20:23], v2 offset:5120
    ds_read_b128 a[164:167], v3 offset:5120
    v_fmamk_f32 v42, v42, 0xbdd2d3e8, v11
    v_fmamk_f32 v43, v43, 0xbdd2d3e8, v11
    v_mul_f32 v40, v112, v40
    v_mul_f32 v41, v113, v41
    v_mul_f32 v42, v114, v42
    v_mul_f32 v43, v115, v43
    s_waitcnt vmcnt(26)
    s_waitcnt lgkmcnt(6)
    v_mfma_f32_32x32x16_bf16 v[80:95], v[152:155], a[8:11], v[80:95]
    v_exp_f32 v40, v40
    v_exp_f32 v41, v41
    v_exp_f32 v42, v42
    v_mfma_f32_32x32x16_bf16 v[96:111], v[152:155], a[152:155], v[96:111]
    buffer_load_dwordx4 v[152:155], v1, s[8:11], s21 offen offset:2048
    ds_read_b128 a[24:27], v2 offset:6144
    ds_read_b128 a[168:171], v3 offset:6144
    v_exp_f32 v43, v43
    v_add_f32 v40, 1.0, v40
    v_add_f32 v41, 1.0, v41
    v_add_f32 v42, 1.0, v42
    v_add_f32 v43, 1.0, v43
    s_waitcnt lgkmcnt(6)
    v_mfma_f32_32x32x16_bf16 v[80:95], v[156:159], a[12:15], v[80:95]
    v_rcp_f32 v40, v40
    v_rcp_f32 v41, v41
    v_rcp_f32 v42, v42
    v_mfma_f32_32x32x16_bf16 v[96:111], v[156:159], a[156:159], v[96:111]
    buffer_load_dwordx4 v[156:159], v1, s[8:11], s21 offen offset:3072
    s_add_u32 s21, s21, 4096
    ds_read_b128 a[28:31], v2 offset:7168
    ds_read_b128 a[172:175], v3 offset:7168
    v_rcp_f32 v43, v43
    v_mul_f32 v40, v112, v40
    v_mul_f32 v41, v113, v41
    v_mul_f32 v42, v114, v42
    v_mul_f32 v43, v115, v43
    s_waitcnt vmcnt(26)
    s_waitcnt lgkmcnt(6)
    v_mfma_f32_32x32x16_bf16 v[80:95], v[160:163], a[16:19], v[80:95]
    v_cvt_pk_bf16_f32 v32, v40, v41
    v_cvt_pk_bf16_f32 v33, v42, v43
    v_mul_f32 v40, v116, v116
    v_mul_f32 v41, v117, v117
    v_mul_f32 v42, v118, v118
    v_mul_f32 v43, v119, v119
    v_mfma_f32_32x32x16_bf16 v[96:111], v[160:163], a[160:163], v[96:111]
    s_add_u32 s21, s21, s31
    buffer_load_dwordx4 v[160:163], v1, s[8:11], s21 offen offset:0
    ds_read_b128 a[32:35], v2 offset:8192
    ds_read_b128 a[176:179], v3 offset:8192
    v_fmamk_f32 v40, v40, 0xbdd2d3e8, v11
    v_fmamk_f32 v41, v41, 0xbdd2d3e8, v11
    v_fmamk_f32 v42, v42, 0xbdd2d3e8, v11
    v_fmamk_f32 v43, v43, 0xbdd2d3e8, v11
    v_mul_f32 v40, v116, v40
    v_mul_f32 v41, v117, v41
    s_waitcnt lgkmcnt(6)
    v_mfma_f32_32x32x16_bf16 v[80:95], v[164:167], a[20:23], v[80:95]
    v_mul_f32 v42, v118, v42
    v_mul_f32 v43, v119, v43
    v_exp_f32 v40, v40
    v_exp_f32 v41, v41
    v_mfma_f32_32x32x16_bf16 v[96:111], v[164:167], a[164:167], v[96:111]
    buffer_load_dwordx4 v[164:167], v1, s[8:11], s21 offen offset:1024
    ds_read_b128 a[36:39], v2 offset:9216
    ds_read_b128 a[180:183], v3 offset:9216
    v_exp_f32 v42, v42
    v_exp_f32 v43, v43
    v_add_f32 v40, 1.0, v40
    s_waitcnt vmcnt(26)
    s_waitcnt lgkmcnt(6)
    v_mfma_f32_32x32x16_bf16 v[80:95], v[168:171], a[24:27], v[80:95]
    v_add_f32 v41, 1.0, v41
    v_add_f32 v42, 1.0, v42
    v_add_f32 v43, 1.0, v43
    v_rcp_f32 v40, v40
    v_rcp_f32 v41, v41
    v_mfma_f32_32x32x16_bf16 v[96:111], v[168:171], a[168:171], v[96:111]
    buffer_load_dwordx4 v[168:171], v1, s[8:11], s21 offen offset:2048
    ds_read_b128 a[40:43], v2 offset:10240
    ds_read_b128 a[184:187], v3 offset:10240
    v_rcp_f32 v42, v42
    v_rcp_f32 v43, v43
    v_mul_f32 v40, v116, v40
    s_waitcnt lgkmcnt(6)
    v_mfma_f32_32x32x16_bf16 v[80:95], v[172:175], a[28:31], v[80:95]
    v_mul_f32 v41, v117, v41
    v_mul_f32 v42, v118, v42
    v_mul_f32 v43, v119, v43
    v_cvt_pk_bf16_f32 v34, v40, v41
    v_cvt_pk_bf16_f32 v35, v42, v43
    ds_write_b128 v6, v[32:35] offset:0
    v_mfma_f32_32x32x16_bf16 v[96:111], v[172:175], a[172:175], v[96:111]
    buffer_load_dwordx4 v[172:175], v1, s[8:11], s21 offen offset:3072
    s_add_u32 s21, s21, 4096
    ds_read_b128 a[44:47], v2 offset:11264
    ds_read_b128 a[188:191], v3 offset:11264
    v_mul_f32 v40, v120, v120
    v_mul_f32 v41, v121, v121
    v_mul_f32 v42, v122, v122
    v_mul_f32 v43, v123, v123
    v_fmamk_f32 v40, v40, 0xbdd2d3e8, v11
    s_waitcnt vmcnt(26)
    s_waitcnt lgkmcnt(7)
    v_mfma_f32_32x32x16_bf16 v[80:95], v[176:179], a[32:35], v[80:95]
    v_fmamk_f32 v41, v41, 0xbdd2d3e8, v11
    v_fmamk_f32 v42, v42, 0xbdd2d3e8, v11
    v_fmamk_f32 v43, v43, 0xbdd2d3e8, v11
    v_mul_f32 v40, v120, v40
    v_mul_f32 v41, v121, v41
    v_mul_f32 v42, v122, v42
    v_mfma_f32_32x32x16_bf16 v[96:111], v[176:179], a[176:179], v[96:111]
    s_mov_b32 s21, s24
    buffer_load_dwordx4 v[176:179], v1, s[8:11], s21 offen offset:0
    ds_read_b128 a[48:51], v2 offset:12288
    ds_read_b128 a[192:195], v3 offset:12288
    v_mul_f32 v43, v123, v43
    v_exp_f32 v40, v40
    v_exp_f32 v41, v41
    v_exp_f32 v42, v42
    s_waitcnt lgkmcnt(7)
    v_mfma_f32_32x32x16_bf16 v[80:95], v[180:183], a[36:39], v[80:95]
    v_exp_f32 v43, v43
    v_add_f32 v40, 1.0, v40
    v_add_f32 v41, 1.0, v41
    v_add_f32 v42, 1.0, v42
    v_mfma_f32_32x32x16_bf16 v[96:111], v[180:183], a[180:183], v[96:111]
    buffer_load_dwordx4 v[180:183], v1, s[8:11], s21 offen offset:1024
    ds_read_b128 a[52:55], v2 offset:13312
    ds_read_b128 a[196:199], v3 offset:13312
    v_add_f32 v43, 1.0, v43
    v_rcp_f32 v40, v40
    v_rcp_f32 v41, v41
    s_waitcnt vmcnt(26)
    s_waitcnt lgkmcnt(7)
    v_mfma_f32_32x32x16_bf16 v[80:95], v[184:187], a[40:43], v[80:95]
    v_rcp_f32 v42, v42
    v_rcp_f32 v43, v43
    v_mul_f32 v40, v120, v40
    v_mul_f32 v41, v121, v41
    v_mfma_f32_32x32x16_bf16 v[96:111], v[184:187], a[184:187], v[96:111]
    buffer_load_dwordx4 v[184:187], v1, s[8:11], s21 offen offset:2048
    v_add_u32 v2, s45, v4
    v_add_u32 v3, s45, v5
    ds_read_b128 a[56:59], v2 offset:0
    ds_read_b128 a[200:203], v3 offset:0
    v_mul_f32 v42, v122, v42
    v_mul_f32 v43, v123, v43
    v_cvt_pk_bf16_f32 v36, v40, v41
    v_cvt_pk_bf16_f32 v37, v42, v43
    v_mul_f32 v40, v124, v124
    v_mul_f32 v41, v125, v125
    s_waitcnt lgkmcnt(6)
    v_mfma_f32_32x32x16_bf16 v[80:95], v[188:191], a[44:47], v[80:95]
    v_mul_f32 v42, v126, v126
    v_mul_f32 v43, v127, v127
    v_fmamk_f32 v40, v40, 0xbdd2d3e8, v11
    v_fmamk_f32 v41, v41, 0xbdd2d3e8, v11
    v_fmamk_f32 v42, v42, 0xbdd2d3e8, v11
    v_fmamk_f32 v43, v43, 0xbdd2d3e8, v11
    v_mfma_f32_32x32x16_bf16 v[96:111], v[188:191], a[188:191], v[96:111]
    buffer_load_dwordx4 v[188:191], v1, s[8:11], s21 offen offset:3072
    s_add_u32 s21, s21, 4096
    ds_read_b128 a[60:63], v2 offset:1024
    ds_read_b128 a[204:207], v3 offset:1024
    v_mul_f32 v40, v124, v40
    v_mul_f32 v41, v125, v41
    v_mul_f32 v42, v126, v42
    v_mul_f32 v43, v127, v43
    v_exp_f32 v40, v40
    s_waitcnt vmcnt(26)
    s_waitcnt lgkmcnt(6)
    v_mfma_f32_32x32x16_bf16 v[80:95], v[192:195], a[48:51], v[80:95]
    v_exp_f32 v41, v41
    v_exp_f32 v42, v42
    v_exp_f32 v43, v43
    v_mfma_f32_32x32x16_bf16 v[96:111], v[192:195], a[192:195], v[96:111]
    buffer_load_dwordx4 v[192:195], v1, s[8:11], s21 offen offset:0
    ds_read_b128 a[64:67], v2 offset:2048
    ds_read_b128 a[208:211], v3 offset:2048
    v_add_f32 v40, 1.0, v40
    v_add_f32 v41, 1.0, v41
    v_add_f32 v42, 1.0, v42
    v_add_f32 v43, 1.0, v43
    v_rcp_f32 v40, v40
    s_waitcnt lgkmcnt(6)
    v_mfma_f32_32x32x16_bf16 v[80:95], v[196:199], a[52:55], v[80:95]
    v_rcp_f32 v41, v41
    v_rcp_f32 v42, v42
    v_rcp_f32 v43, v43
    v_mfma_f32_32x32x16_bf16 v[96:111], v[196:199], a[196:199], v[96:111]
    buffer_load_dwordx4 v[196:199], v1, s[8:11], s21 offen offset:1024
    ds_read_b128 a[68:71], v2 offset:3072
    ds_read_b128 a[212:215], v3 offset:3072
    v_mul_f32 v40, v124, v40
    v_mul_f32 v41, v125, v41
    v_mul_f32 v42, v126, v42
    v_mul_f32 v43, v127, v43
    v_cvt_pk_bf16_f32 v38, v40, v41
    v_cvt_pk_bf16_f32 v39, v42, v43
    s_waitcnt vmcnt(26)
    s_waitcnt lgkmcnt(6)
    v_mfma_f32_32x32x16_bf16 v[80:95], v[200:203], a[56:59], v[80:95]
    ds_write_b128 v6, v[36:39] offset:1024
    v_mul_f32 v40, v128, v128
    v_mul_f32 v41, v129, v129
    v_mul_f32 v42, v130, v130
    v_mfma_f32_32x32x16_bf16 v[96:111], v[200:203], a[200:203], v[96:111]
    buffer_load_dwordx4 v[200:203], v1, s[8:11], s21 offen offset:2048
    ds_read_b128 a[72:75], v2 offset:4096
    ds_read_b128 a[216:219], v3 offset:4096
    v_mul_f32 v43, v131, v131
    v_fmamk_f32 v40, v40, 0xbdd2d3e8, v11
    v_fmamk_f32 v41, v41, 0xbdd2d3e8, v11
    v_fmamk_f32 v42, v42, 0xbdd2d3e8, v11
    v_fmamk_f32 v43, v43, 0xbdd2d3e8, v11
    v_mul_f32 v40, v128, v40
    s_waitcnt lgkmcnt(7)
    v_mfma_f32_32x32x16_bf16 v[80:95], v[204:207], a[60:63], v[80:95]
    v_mul_f32 v41, v129, v41
    v_mul_f32 v42, v130, v42
    v_mul_f32 v43, v131, v43
    v_exp_f32 v40, v40
    v_exp_f32 v41, v41
    v_mfma_f32_32x32x16_bf16 v[96:111], v[204:207], a[204:207], v[96:111]
    buffer_load_dwordx4 v[204:207], v1, s[8:11], s21 offen offset:3072
    s_add_u32 s21, s21, 4096
    ds_read_b128 a[76:79], v2 offset:5120
    ds_read_b128 a[220:223], v3 offset:5120
    v_exp_f32 v42, v42
    v_exp_f32 v43, v43
    v_add_f32 v40, 1.0, v40
    s_waitcnt vmcnt(26)
    s_waitcnt lgkmcnt(7)
    v_mfma_f32_32x32x16_bf16 v[80:95], v[208:211], a[64:67], v[80:95]
    v_add_f32 v41, 1.0, v41
    v_add_f32 v42, 1.0, v42
    v_add_f32 v43, 1.0, v43
    v_rcp_f32 v40, v40
    v_rcp_f32 v41, v41
    v_mfma_f32_32x32x16_bf16 v[96:111], v[208:211], a[208:211], v[96:111]
    buffer_load_dwordx4 v[208:211], v1, s[8:11], s21 offen offset:0
    ds_read_b128 a[80:83], v2 offset:6144
    ds_read_b128 a[224:227], v3 offset:6144
    v_rcp_f32 v42, v42
    v_rcp_f32 v43, v43
    v_mul_f32 v40, v128, v40
    s_waitcnt lgkmcnt(7)
    v_mfma_f32_32x32x16_bf16 v[80:95], v[212:215], a[68:71], v[80:95]
    v_mul_f32 v41, v129, v41
    v_mul_f32 v42, v130, v42
    v_mul_f32 v43, v131, v43
    v_cvt_pk_bf16_f32 v32, v40, v41
    v_cvt_pk_bf16_f32 v33, v42, v43
    v_mul_f32 v40, v132, v132
    v_mfma_f32_32x32x16_bf16 v[96:111], v[212:215], a[212:215], v[96:111]
    buffer_load_dwordx4 v[212:215], v1, s[8:11], s21 offen offset:1024
    ds_read_b128 a[84:87], v2 offset:7168
    ds_read_b128 a[228:231], v3 offset:7168
    v_mul_f32 v41, v133, v133
    v_mul_f32 v42, v134, v134
    v_mul_f32 v43, v135, v135
    v_fmamk_f32 v40, v40, 0xbdd2d3e8, v11
    v_fmamk_f32 v41, v41, 0xbdd2d3e8, v11
    v_fmamk_f32 v42, v42, 0xbdd2d3e8, v11
    s_waitcnt vmcnt(26)
    s_waitcnt lgkmcnt(6)
    v_mfma_f32_32x32x16_bf16 v[80:95], v[216:219], a[72:75], v[80:95]
    v_fmamk_f32 v43, v43, 0xbdd2d3e8, v11
    v_mul_f32 v40, v132, v40
    v_mul_f32 v41, v133, v41
    v_mul_f32 v42, v134, v42
    v_mul_f32 v43, v135, v43
    v_exp_f32 v40, v40
    v_mfma_f32_32x32x16_bf16 v[96:111], v[216:219], a[216:219], v[96:111]
    buffer_load_dwordx4 v[216:219], v1, s[8:11], s21 offen offset:2048
    ds_read_b128 a[88:91], v2 offset:8192
    ds_read_b128 a[232:235], v3 offset:8192
    v_exp_f32 v41, v41
    v_exp_f32 v42, v42
    s_waitcnt lgkmcnt(6)
    v_mfma_f32_32x32x16_bf16 v[80:95], v[220:223], a[76:79], v[80:95]
    v_exp_f32 v43, v43
    v_add_f32 v40, 1.0, v40
    v_add_f32 v41, 1.0, v41
    v_add_f32 v42, 1.0, v42
    v_add_f32 v43, 1.0, v43
    v_mfma_f32_32x32x16_bf16 v[96:111], v[220:223], a[220:223], v[96:111]
    buffer_load_dwordx4 v[220:223], v1, s[8:11], s21 offen offset:3072
    s_add_u32 s21, s21, 4096
    ds_read_b128 a[92:95], v2 offset:9216
    ds_read_b128 a[236:239], v3 offset:9216
    v_rcp_f32 v40, v40
    v_rcp_f32 v41, v41
    v_rcp_f32 v42, v42
    s_waitcnt vmcnt(26)
    s_waitcnt lgkmcnt(6)
    v_mfma_f32_32x32x16_bf16 v[80:95], v[224:227], a[80:83], v[80:95]
    v_rcp_f32 v43, v43
    v_mul_f32 v40, v132, v40
    v_mul_f32 v41, v133, v41
    v_mul_f32 v42, v134, v42
    v_mul_f32 v43, v135, v43
    v_mfma_f32_32x32x16_bf16 v[96:111], v[224:227], a[224:227], v[96:111]
    buffer_load_dwordx4 v[224:227], v1, s[8:11], s21 offen offset:0
    ds_read_b128 a[96:99], v2 offset:10240
    ds_read_b128 a[240:243], v3 offset:10240
    v_cvt_pk_bf16_f32 v34, v40, v41
    v_cvt_pk_bf16_f32 v35, v42, v43
    ds_write_b128 v7, v[32:35] offset:0
    v_mul_f32 v40, v136, v136
    v_mul_f32 v41, v137, v137
    s_waitcnt lgkmcnt(7)
    v_mfma_f32_32x32x16_bf16 v[80:95], v[228:231], a[84:87], v[80:95]
    v_mul_f32 v42, v138, v138
    v_mul_f32 v43, v139, v139
    v_fmamk_f32 v40, v40, 0xbdd2d3e8, v11
    v_fmamk_f32 v41, v41, 0xbdd2d3e8, v11
    v_fmamk_f32 v42, v42, 0xbdd2d3e8, v11
    v_fmamk_f32 v43, v43, 0xbdd2d3e8, v11
    v_mfma_f32_32x32x16_bf16 v[96:111], v[228:231], a[228:231], v[96:111]
    buffer_load_dwordx4 v[228:231], v1, s[8:11], s21 offen offset:1024
    ds_read_b128 a[100:103], v2 offset:11264
    ds_read_b128 a[244:247], v3 offset:11264
    v_mul_f32 v40, v136, v40
    v_mul_f32 v41, v137, v41
    v_mul_f32 v42, v138, v42
    v_mul_f32 v43, v139, v43
    v_exp_f32 v40, v40
    s_waitcnt vmcnt(26)
    s_waitcnt lgkmcnt(7)
    v_mfma_f32_32x32x16_bf16 v[80:95], v[232:235], a[88:91], v[80:95]
    v_exp_f32 v41, v41
    v_exp_f32 v42, v42
    v_exp_f32 v43, v43
    v_mfma_f32_32x32x16_bf16 v[96:111], v[232:235], a[232:235], v[96:111]
    s_add_u32 s21, s21, 2048
    s_add_u32 s21, s21, s32
    buffer_load_dwordx4 v[232:235], v1, s[8:11], s21 offen offset:0
    ds_read_b128 a[104:107], v2 offset:12288
    ds_read_b128 a[248:251], v3 offset:12288
    v_add_f32 v40, 1.0, v40
    v_add_f32 v41, 1.0, v41
    v_add_f32 v42, 1.0, v42
    v_add_f32 v43, 1.0, v43
    v_rcp_f32 v40, v40
    s_waitcnt lgkmcnt(7)
    v_mfma_f32_32x32x16_bf16 v[80:95], v[236:239], a[92:95], v[80:95]
    v_rcp_f32 v41, v41
    v_rcp_f32 v42, v42
    v_rcp_f32 v43, v43
    v_mfma_f32_32x32x16_bf16 v[96:111], v[236:239], a[236:239], v[96:111]
    buffer_load_dwordx4 v[236:239], v1, s[8:11], s21 offen offset:1024
    ds_read_b128 a[108:111], v2 offset:13312
    ds_read_b128 a[252:255], v3 offset:13312
    v_mul_f32 v40, v136, v40
    v_mul_f32 v41, v137, v41
    v_mul_f32 v42, v138, v42
    v_mul_f32 v43, v139, v43
    v_cvt_pk_bf16_f32 v36, v40, v41
    s_waitcnt vmcnt(26)
    s_waitcnt lgkmcnt(7)
    v_mfma_f32_32x32x16_bf16 v[80:95], v[16:19], a[96:99], v[80:95]
    v_cvt_pk_bf16_f32 v37, v42, v43
    v_mul_f32 v40, v140, v140
    v_mul_f32 v41, v141, v141
    v_mul_f32 v42, v142, v142
    v_mul_f32 v43, v143, v143
    v_fmamk_f32 v40, v40, 0xbdd2d3e8, v11
    v_mfma_f32_32x32x16_bf16 v[96:111], v[16:19], a[240:243], v[96:111]
    buffer_load_dwordx4 v[16:19], v1, s[8:11], s21 offen offset:2048
    v_fmamk_f32 v41, v41, 0xbdd2d3e8, v11
    v_fmamk_f32 v42, v42, 0xbdd2d3e8, v11
    v_fmamk_f32 v43, v43, 0xbdd2d3e8, v11
    v_mul_f32 v40, v140, v40
    v_mul_f32 v41, v141, v41
    v_mul_f32 v42, v142, v42
    s_waitcnt lgkmcnt(4)
    v_mfma_f32_32x32x16_bf16 v[80:95], v[20:23], a[100:103], v[80:95]
    v_mul_f32 v43, v143, v43
    v_exp_f32 v40, v40
    v_exp_f32 v41, v41
    v_exp_f32 v42, v42
    v_mfma_f32_32x32x16_bf16 v[96:111], v[20:23], a[244:247], v[96:111]
    buffer_load_dwordx4 v[20:23], v1, s[8:11], s21 offen offset:3072
    s_add_u32 s21, s21, 4096
    v_exp_f32 v43, v43
    v_add_f32 v40, 1.0, v40
    v_add_f32 v41, 1.0, v41
    v_add_f32 v42, 1.0, v42
    s_waitcnt vmcnt(26)
    s_waitcnt lgkmcnt(2)
    v_mfma_f32_32x32x16_bf16 v[80:95], v[24:27], a[104:107], v[80:95]
    v_add_f32 v43, 1.0, v43
    v_rcp_f32 v40, v40
    v_rcp_f32 v41, v41
    v_rcp_f32 v42, v42
    v_mfma_f32_32x32x16_bf16 v[96:111], v[24:27], a[248:251], v[96:111]
    s_mov_b32 s21, s23
    s_add_u32 s23, s23, 36864
    buffer_load_dwordx4 v[24:27], v1, s[8:11], s21 offen offset:0
    v_rcp_f32 v43, v43
    v_mul_f32 v40, v140, v40
    v_mul_f32 v41, v141, v41
    v_mul_f32 v42, v142, v42
    s_waitcnt lgkmcnt(0)
    v_mfma_f32_32x32x16_bf16 v[80:95], v[28:31], a[108:111], v[80:95]
    v_mul_f32 v43, v143, v43
    v_cvt_pk_bf16_f32 v38, v40, v41
    v_cvt_pk_bf16_f32 v39, v42, v43
    ds_write_b128 v7, v[36:39] offset:1024
    v_mfma_f32_32x32x16_bf16 v[96:111], v[28:31], a[252:255], v[96:111]
    buffer_load_dwordx4 v[28:31], v1, s[8:11], s21 offen offset:1024
    s_waitcnt lgkmcnt(0)
    s_barrier
    v_add_u32 v2, s46, v4
    v_add_u32 v3, s46, v5
    ds_read_b128 a[112:115], v2 offset:0
    ds_read_b128 v[48:51], v3 offset:0
    ds_read_b128 a[116:119], v2 offset:1024
    ds_read_b128 v[52:55], v3 offset:1024
    ds_read_b128 a[120:123], v2 offset:2048
    ds_read_b128 v[56:59], v3 offset:2048
    ds_read_b128 a[124:127], v2 offset:3072
    ds_read_b128 v[60:63], v3 offset:3072
    s_waitcnt vmcnt(26)
    s_waitcnt lgkmcnt(6)
    v_mfma_f32_32x32x16_bf16 v[80:95], v[144:147], a[112:115], v[80:95]
    v_mfma_f32_32x32x16_bf16 v[96:111], v[144:147], v[48:51], v[96:111]
    buffer_load_dwordx4 v[144:147], v1, s[8:11], s21 offen offset:2048
    v_add_u32 v2, s47, v4
    v_add_u32 v3, s47, v5
    ds_read_b128 a[128:131], v2 offset:0
    ds_read_b128 v[64:67], v3 offset:0
    s_waitcnt lgkmcnt(6)
    v_mfma_f32_32x32x16_bf16 v[80:95], v[148:151], a[116:119], v[80:95]
    v_mfma_f32_32x32x16_bf16 v[96:111], v[148:151], v[52:55], v[96:111]
    buffer_load_dwordx4 v[148:151], v1, s[8:11], s21 offen offset:3072
    s_add_u32 s21, s21, 4096
    ds_read_b128 a[132:135], v2 offset:1024
    ds_read_b128 v[68:71], v3 offset:1024
    s_waitcnt vmcnt(26)
    s_waitcnt lgkmcnt(6)
    v_mfma_f32_32x32x16_bf16 v[80:95], v[152:155], a[120:123], v[80:95]
    v_mfma_f32_32x32x16_bf16 v[96:111], v[152:155], v[56:59], v[96:111]
    buffer_load_dwordx4 v[152:155], v1, s[8:11], s21 offen offset:0
    ds_read_b128 a[136:139], v2 offset:2048
    ds_read_b128 v[72:75], v3 offset:2048
    s_waitcnt lgkmcnt(6)
    v_mfma_f32_32x32x16_bf16 v[80:95], v[156:159], a[124:127], v[80:95]
    v_mfma_f32_32x32x16_bf16 v[96:111], v[156:159], v[60:63], v[96:111]
    buffer_load_dwordx4 v[156:159], v1, s[8:11], s21 offen offset:1024
    ds_read_b128 a[140:143], v2 offset:3072
    ds_read_b128 v[76:79], v3 offset:3072
    s_waitcnt vmcnt(26)
    s_waitcnt lgkmcnt(6)
    v_mfma_f32_32x32x16_bf16 v[80:95], v[160:163], a[128:131], v[80:95]
    v_mfma_f32_32x32x16_bf16 v[96:111], v[160:163], v[64:67], v[96:111]
    buffer_load_dwordx4 v[160:163], v1, s[8:11], s21 offen offset:2048
    s_waitcnt lgkmcnt(4)
    v_mfma_f32_32x32x16_bf16 v[80:95], v[164:167], a[132:135], v[80:95]
    v_mfma_f32_32x32x16_bf16 v[96:111], v[164:167], v[68:71], v[96:111]
    buffer_load_dwordx4 v[164:167], v1, s[8:11], s21 offen offset:3072
    s_add_u32 s21, s21, 4096
    s_waitcnt vmcnt(26)
    s_waitcnt lgkmcnt(2)
    v_mfma_f32_32x32x16_bf16 v[80:95], v[168:171], a[136:139], v[80:95]
    v_mfma_f32_32x32x16_bf16 v[96:111], v[168:171], v[72:75], v[96:111]
    buffer_load_dwordx4 v[168:171], v1, s[8:11], s21 offen offset:0
    s_waitcnt lgkmcnt(0)
    v_mfma_f32_32x32x16_bf16 v[80:95], v[172:175], a[140:143], v[80:95]
    v_mfma_f32_32x32x16_bf16 v[96:111], v[172:175], v[76:79], v[96:111]
    buffer_load_dwordx4 v[172:175], v1, s[8:11], s21 offen offset:1024
    s_waitcnt vmcnt(26)
    v_mfma_f32_32x32x16_bf16 v[240:255], v[176:179], a[0:3], 0
    v_mfma_f32_32x32x16_bf16 v[128:143], v[176:179], a[144:147], 0
    buffer_load_dwordx4 v[176:179], v1, s[8:11], s21 offen offset:2048
    v_mfma_f32_32x32x16_bf16 v[240:255], v[180:183], a[4:7], v[240:255]
    v_mfma_f32_32x32x16_bf16 v[128:143], v[180:183], a[148:151], v[128:143]
    buffer_load_dwordx4 v[180:183], v1, s[8:11], s21 offen offset:3072
    s_add_u32 s21, s21, 4096
    s_nop 1
    v_cvt_pk_bf16_f32 v32, v80, v81
    s_waitcnt vmcnt(26)
    v_mfma_f32_32x32x16_bf16 v[240:255], v[184:187], a[8:11], v[240:255]
    v_cvt_pk_bf16_f32 v33, v82, v83
    v_mfma_f32_32x32x16_bf16 v[128:143], v[184:187], a[152:155], v[128:143]
    buffer_load_dwordx4 v[184:187], v1, s[8:11], s21 offen offset:0
    v_mfma_f32_32x32x16_bf16 v[240:255], v[188:191], a[12:15], v[240:255]
    v_cvt_pk_bf16_f32 v34, v84, v85
    v_mfma_f32_32x32x16_bf16 v[128:143], v[188:191], a[156:159], v[128:143]
    buffer_load_dwordx4 v[188:191], v1, s[8:11], s21 offen offset:1024
    v_cvt_pk_bf16_f32 v35, v86, v87
    s_waitcnt vmcnt(26)
    v_mfma_f32_32x32x16_bf16 v[240:255], v[192:195], a[16:19], v[240:255]
    v_mfma_f32_32x32x16_bf16 v[128:143], v[192:195], a[160:163], v[128:143]
    s_add_u32 s21, s21, 2048
    s_add_u32 s21, s21, s29
    buffer_load_dwordx4 v[192:195], v1, s[8:11], s21 offen offset:0
    buffer_store_dwordx4 v[32:35], v1, s[8:11], s25 offen offset:0 sc1
    v_mfma_f32_32x32x16_bf16 v[240:255], v[196:199], a[20:23], v[240:255]
    v_mfma_f32_32x32x16_bf16 v[128:143], v[196:199], a[164:167], v[128:143]
    buffer_load_dwordx4 v[196:199], v1, s[8:11], s21 offen offset:1024
    v_cvt_pk_bf16_f32 v36, v88, v89
    s_waitcnt vmcnt(27)
    v_mfma_f32_32x32x16_bf16 v[240:255], v[200:203], a[24:27], v[240:255]
    v_cvt_pk_bf16_f32 v37, v90, v91
    v_mfma_f32_32x32x16_bf16 v[128:143], v[200:203], a[168:171], v[128:143]
    buffer_load_dwordx4 v[200:203], v1, s[8:11], s21 offen offset:2048
    v_mfma_f32_32x32x16_bf16 v[240:255], v[204:207], a[28:31], v[240:255]
    v_cvt_pk_bf16_f32 v38, v92, v93
    v_mfma_f32_32x32x16_bf16 v[128:143], v[204:207], a[172:175], v[128:143]
    buffer_load_dwordx4 v[204:207], v1, s[8:11], s21 offen offset:3072
    s_add_u32 s21, s21, 4096
    v_cvt_pk_bf16_f32 v39, v94, v95
    s_waitcnt vmcnt(27)
    v_mfma_f32_32x32x16_bf16 v[240:255], v[208:211], a[32:35], v[240:255]
    v_mfma_f32_32x32x16_bf16 v[128:143], v[208:211], a[176:179], v[128:143]
    buffer_load_dwordx4 v[208:211], v1, s[8:11], s21 offen offset:0
    buffer_store_dwordx4 v[36:39], v1, s[8:11], s25 offen offset:1024 sc1
    v_mfma_f32_32x32x16_bf16 v[240:255], v[212:215], a[36:39], v[240:255]
    v_mfma_f32_32x32x16_bf16 v[128:143], v[212:215], a[180:183], v[128:143]
    buffer_load_dwordx4 v[212:215], v1, s[8:11], s21 offen offset:1024
    v_cvt_pk_bf16_f32 v32, v96, v97
    s_waitcnt vmcnt(28)
    v_mfma_f32_32x32x16_bf16 v[240:255], v[216:219], a[40:43], v[240:255]
    v_cvt_pk_bf16_f32 v33, v98, v99
    v_mfma_f32_32x32x16_bf16 v[128:143], v[216:219], a[184:187], v[128:143]
    buffer_load_dwordx4 v[216:219], v1, s[8:11], s21 offen offset:2048
    v_mfma_f32_32x32x16_bf16 v[240:255], v[220:223], a[44:47], v[240:255]
    v_cvt_pk_bf16_f32 v34, v100, v101
    v_mfma_f32_32x32x16_bf16 v[128:143], v[220:223], a[188:191], v[128:143]
    buffer_load_dwordx4 v[220:223], v1, s[8:11], s21 offen offset:3072
    s_add_u32 s21, s21, 4096
    v_cvt_pk_bf16_f32 v35, v102, v103
    s_waitcnt vmcnt(28)
    v_mfma_f32_32x32x16_bf16 v[240:255], v[224:227], a[48:51], v[240:255]
    v_mfma_f32_32x32x16_bf16 v[128:143], v[224:227], a[192:195], v[128:143]
    buffer_load_dwordx4 v[224:227], v1, s[8:11], s21 offen offset:0
    buffer_store_dwordx4 v[32:35], v1, s[8:11], s26 offen offset:0 sc1
    v_mfma_f32_32x32x16_bf16 v[240:255], v[228:231], a[52:55], v[240:255]
    v_mfma_f32_32x32x16_bf16 v[128:143], v[228:231], a[196:199], v[128:143]
    buffer_load_dwordx4 v[228:231], v1, s[8:11], s21 offen offset:1024
    v_cvt_pk_bf16_f32 v36, v104, v105
    s_waitcnt vmcnt(29)
    v_mfma_f32_32x32x16_bf16 v[240:255], v[232:235], a[112:115], v[240:255]
    v_cvt_pk_bf16_f32 v37, v106, v107
    v_mfma_f32_32x32x16_bf16 v[128:143], v[232:235], v[48:51], v[128:143]
    buffer_load_dwordx4 v[232:235], v1, s[8:11], s21 offen offset:2048
    v_mfma_f32_32x32x16_bf16 v[240:255], v[236:239], a[116:119], v[240:255]
    v_cvt_pk_bf16_f32 v38, v108, v109
    v_mfma_f32_32x32x16_bf16 v[128:143], v[236:239], v[52:55], v[128:143]
    buffer_load_dwordx4 v[236:239], v1, s[8:11], s21 offen offset:3072
    s_add_u32 s21, s21, 4096
    v_cvt_pk_bf16_f32 v39, v110, v111
    s_waitcnt vmcnt(29)
    v_mfma_f32_32x32x16_bf16 v[240:255], v[16:19], a[120:123], v[240:255]
    v_mfma_f32_32x32x16_bf16 v[128:143], v[16:19], v[56:59], v[128:143]
    buffer_load_dwordx4 v[16:19], v1, s[8:11], s21 offen offset:0
    buffer_store_dwordx4 v[36:39], v1, s[8:11], s26 offen offset:1024 sc1
    v_mfma_f32_32x32x16_bf16 v[240:255], v[20:23], a[124:127], v[240:255]
    v_mfma_f32_32x32x16_bf16 v[128:143], v[20:23], v[60:63], v[128:143]
    buffer_load_dwordx4 v[20:23], v1, s[8:11], s21 offen offset:1024
    s_add_u32 s25, s25, 4096
    s_add_u32 s26, s26, 4096
    s_waitcnt vmcnt(30)
    v_mfma_f32_32x32x16_bf16 v[80:95], v[24:27], a[0:3], 0
    v_mfma_f32_32x32x16_bf16 v[96:111], v[24:27], a[144:147], 0
    s_add_u32 s21, s21, 2048
    s_add_u32 s21, s21, s30
    buffer_load_dwordx4 v[24:27], v1, s[8:11], s21 offen offset:0
    v_mfma_f32_32x32x16_bf16 v[80:95], v[28:31], a[4:7], v[80:95]
    v_mfma_f32_32x32x16_bf16 v[96:111], v[28:31], a[148:151], v[96:111]
    buffer_load_dwordx4 v[28:31], v1, s[8:11], s21 offen offset:1024
    s_waitcnt vmcnt(30)
    v_mfma_f32_32x32x16_bf16 v[80:95], v[144:147], a[8:11], v[80:95]
    v_mfma_f32_32x32x16_bf16 v[96:111], v[144:147], a[152:155], v[96:111]
    buffer_load_dwordx4 v[144:147], v1, s[8:11], s21 offen offset:2048
    v_mfma_f32_32x32x16_bf16 v[80:95], v[148:151], a[12:15], v[80:95]
    v_mfma_f32_32x32x16_bf16 v[96:111], v[148:151], a[156:159], v[96:111]
    buffer_load_dwordx4 v[148:151], v1, s[8:11], s21 offen offset:3072
    s_add_u32 s21, s21, 4096
    ds_write_b128 v12, v[128:131] offset:0
    s_waitcnt vmcnt(30)
    v_mfma_f32_32x32x16_bf16 v[80:95], v[152:155], a[16:19], v[80:95]
    v_mfma_f32_32x32x16_bf16 v[96:111], v[152:155], a[160:163], v[96:111]
    s_add_u32 s21, s21, s31
    buffer_load_dwordx4 v[152:155], v1, s[8:11], s21 offen offset:0
    v_mfma_f32_32x32x16_bf16 v[80:95], v[156:159], a[20:23], v[80:95]
    v_mfma_f32_32x32x16_bf16 v[96:111], v[156:159], a[164:167], v[96:111]
    buffer_load_dwordx4 v[156:159], v1, s[8:11], s21 offen offset:1024
    ds_write_b128 v12, v[132:135] offset:1024
    s_waitcnt vmcnt(30)
    v_mfma_f32_32x32x16_bf16 v[80:95], v[160:163], a[24:27], v[80:95]
    v_mfma_f32_32x32x16_bf16 v[96:111], v[160:163], a[168:171], v[96:111]
    buffer_load_dwordx4 v[160:163], v1, s[8:11], s21 offen offset:2048
    v_mfma_f32_32x32x16_bf16 v[80:95], v[164:167], a[28:31], v[80:95]
    v_mfma_f32_32x32x16_bf16 v[96:111], v[164:167], a[172:175], v[96:111]
    buffer_load_dwordx4 v[164:167], v1, s[8:11], s21 offen offset:3072
    s_add_u32 s21, s21, 4096
    ds_write_b128 v12, v[136:139] offset:2048
    s_waitcnt vmcnt(30)
    v_mfma_f32_32x32x16_bf16 v[80:95], v[168:171], a[32:35], v[80:95]
    v_mfma_f32_32x32x16_bf16 v[96:111], v[168:171], a[176:179], v[96:111]
    s_mov_b32 s21, s23
    s_add_u32 s23, s23, 36864
    buffer_load_dwordx4 v[168:171], v1, s[8:11], s21 offen offset:0
    v_mfma_f32_32x32x16_bf16 v[80:95], v[172:175], a[36:39], v[80:95]
    v_mfma_f32_32x32x16_bf16 v[96:111], v[172:175], a[180:183], v[96:111]
    buffer_load_dwordx4 v[172:175], v1, s[8:11], s21 offen offset:1024
    ds_write_b128 v12, v[140:143] offset:3072
    s_waitcnt vmcnt(30)
    v_mfma_f32_32x32x16_bf16 v[80:95], v[176:179], a[40:43], v[80:95]
    v_mfma_f32_32x32x16_bf16 v[96:111], v[176:179], a[184:187], v[96:111]
    buffer_load_dwordx4 v[176:179], v1, s[8:11], s21 offen offset:2048
    v_mfma_f32_32x32x16_bf16 v[80:95], v[180:183], a[44:47], v[80:95]
    v_mfma_f32_32x32x16_bf16 v[96:111], v[180:183], a[188:191], v[96:111]
    buffer_load_dwordx4 v[180:183], v1, s[8:11], s21 offen offset:3072
    s_add_u32 s21, s21, 4096
    s_waitcnt vmcnt(30)
    v_mfma_f32_32x32x16_bf16 v[80:95], v[184:187], a[48:51], v[80:95]
    v_mfma_f32_32x32x16_bf16 v[96:111], v[184:187], a[192:195], v[96:111]
    buffer_load_dwordx4 v[184:187], v1, s[8:11], s21 offen offset:0
    v_mfma_f32_32x32x16_bf16 v[80:95], v[188:191], a[52:55], v[80:95]
    v_mfma_f32_32x32x16_bf16 v[96:111], v[188:191], a[196:199], v[96:111]
    buffer_load_dwordx4 v[188:191], v1, s[8:11], s21 offen offset:1024
    s_waitcnt vmcnt(29)
    v_mfma_f32_32x32x16_bf16 v[80:95], v[192:195], a[56:59], v[80:95]
    v_mfma_f32_32x32x16_bf16 v[96:111], v[192:195], a[200:203], v[96:111]
    buffer_load_dwordx4 v[192:195], v1, s[8:11], s21 offen offset:2048
    v_mfma_f32_32x32x16_bf16 v[80:95], v[196:199], a[60:63], v[80:95]
    v_mfma_f32_32x32x16_bf16 v[96:111], v[196:199], a[204:207], v[96:111]
    buffer_load_dwordx4 v[196:199], v1, s[8:11], s21 offen offset:3072
    s_add_u32 s21, s21, 4096
    s_waitcnt vmcnt(29)
    v_mfma_f32_32x32x16_bf16 v[80:95], v[200:203], a[64:67], v[80:95]
    v_mfma_f32_32x32x16_bf16 v[96:111], v[200:203], a[208:211], v[96:111]
    buffer_load_dwordx4 v[200:203], v1, s[8:11], s21 offen offset:0
    v_mfma_f32_32x32x16_bf16 v[80:95], v[204:207], a[68:71], v[80:95]
    v_mfma_f32_32x32x16_bf16 v[96:111], v[204:207], a[212:215], v[96:111]
    buffer_load_dwordx4 v[204:207], v1, s[8:11], s21 offen offset:1024
    s_waitcnt vmcnt(28)
    v_mfma_f32_32x32x16_bf16 v[80:95], v[208:211], a[72:75], v[80:95]
    v_mfma_f32_32x32x16_bf16 v[96:111], v[208:211], a[216:219], v[96:111]
    buffer_load_dwordx4 v[208:211], v1, s[8:11], s21 offen offset:2048
    v_mfma_f32_32x32x16_bf16 v[80:95], v[212:215], a[76:79], v[80:95]
    v_mfma_f32_32x32x16_bf16 v[96:111], v[212:215], a[220:223], v[96:111]
    buffer_load_dwordx4 v[212:215], v1, s[8:11], s21 offen offset:3072
    s_add_u32 s21, s21, 4096
    s_waitcnt vmcnt(28)
    v_mfma_f32_32x32x16_bf16 v[80:95], v[216:219], a[80:83], v[80:95]
    v_mfma_f32_32x32x16_bf16 v[96:111], v[216:219], a[224:227], v[96:111]
    buffer_load_dwordx4 v[216:219], v1, s[8:11], s21 offen offset:0
    v_mfma_f32_32x32x16_bf16 v[80:95], v[220:223], a[84:87], v[80:95]
    v_mfma_f32_32x32x16_bf16 v[96:111], v[220:223], a[228:231], v[96:111]
    buffer_load_dwordx4 v[220:223], v1, s[8:11], s21 offen offset:1024
    s_waitcnt vmcnt(27)
    v_mfma_f32_32x32x16_bf16 v[80:95], v[224:227], a[88:91], v[80:95]
    v_mfma_f32_32x32x16_bf16 v[96:111], v[224:227], a[232:235], v[96:111]
    s_add_u32 s21, s21, 2048
    s_add_u32 s21, s21, s29
    buffer_load_dwordx4 v[224:227], v1, s[8:11], s21 offen offset:0
    v_mfma_f32_32x32x16_bf16 v[80:95], v[228:231], a[92:95], v[80:95]
    v_mfma_f32_32x32x16_bf16 v[96:111], v[228:231], a[236:239], v[96:111]
    buffer_load_dwordx4 v[228:231], v1, s[8:11], s21 offen offset:1024
    s_waitcnt vmcnt(27)
    v_mfma_f32_32x32x16_bf16 v[80:95], v[232:235], a[96:99], v[80:95]
    v_mfma_f32_32x32x16_bf16 v[96:111], v[232:235], a[240:243], v[96:111]
    buffer_load_dwordx4 v[232:235], v1, s[8:11], s21 offen offset:2048
    v_mfma_f32_32x32x16_bf16 v[80:95], v[236:239], a[100:103], v[80:95]
    v_mfma_f32_32x32x16_bf16 v[96:111], v[236:239], a[244:247], v[96:111]
    buffer_load_dwordx4 v[236:239], v1, s[8:11], s21 offen offset:3072
    s_add_u32 s21, s21, 4096
    s_waitcnt vmcnt(26)
    v_mfma_f32_32x32x16_bf16 v[80:95], v[16:19], a[104:107], v[80:95]
    v_mfma_f32_32x32x16_bf16 v[96:111], v[16:19], a[248:251], v[96:111]
    buffer_load_dwordx4 v[16:19], v1, s[8:11], s21 offen offset:0
    v_mfma_f32_32x32x16_bf16 v[80:95], v[20:23], a[108:111], v[80:95]
    v_mfma_f32_32x32x16_bf16 v[96:111], v[20:23], a[252:255], v[96:111]
    buffer_load_dwordx4 v[20:23], v1, s[8:11], s21 offen offset:1024
    s_waitcnt vmcnt(26)
    v_mfma_f32_32x32x16_bf16 v[80:95], v[24:27], a[112:115], v[80:95]
    v_mfma_f32_32x32x16_bf16 v[96:111], v[24:27], v[48:51], v[96:111]
    buffer_load_dwordx4 v[24:27], v1, s[8:11], s21 offen offset:2048
    v_mfma_f32_32x32x16_bf16 v[80:95], v[28:31], a[116:119], v[80:95]
    v_mfma_f32_32x32x16_bf16 v[96:111], v[28:31], v[52:55], v[96:111]
    buffer_load_dwordx4 v[28:31], v1, s[8:11], s21 offen offset:3072
    s_add_u32 s21, s21, 4096
    s_waitcnt vmcnt(26)
    v_mfma_f32_32x32x16_bf16 v[80:95], v[144:147], a[120:123], v[80:95]
    v_mfma_f32_32x32x16_bf16 v[96:111], v[144:147], v[56:59], v[96:111]
    buffer_load_dwordx4 v[144:147], v1, s[8:11], s21 offen offset:0
    v_mfma_f32_32x32x16_bf16 v[80:95], v[148:151], a[124:127], v[80:95]
    v_mfma_f32_32x32x16_bf16 v[96:111], v[148:151], v[60:63], v[96:111]
    buffer_load_dwordx4 v[148:151], v1, s[8:11], s21 offen offset:1024
    s_waitcnt vmcnt(26)
    v_mfma_f32_32x32x16_bf16 v[80:95], v[152:155], a[128:131], v[80:95]
    v_mfma_f32_32x32x16_bf16 v[96:111], v[152:155], v[64:67], v[96:111]
    buffer_load_dwordx4 v[152:155], v1, s[8:11], s21 offen offset:2048
    v_mfma_f32_32x32x16_bf16 v[80:95], v[156:159], a[132:135], v[80:95]
    v_mfma_f32_32x32x16_bf16 v[96:111], v[156:159], v[68:71], v[96:111]
    buffer_load_dwordx4 v[156:159], v1, s[8:11], s21 offen offset:3072
    s_add_u32 s21, s21, 4096
    s_waitcnt vmcnt(26)
    v_mfma_f32_32x32x16_bf16 v[80:95], v[160:163], a[136:139], v[80:95]
    v_mfma_f32_32x32x16_bf16 v[96:111], v[160:163], v[72:75], v[96:111]
    buffer_load_dwordx4 v[160:163], v1, s[8:11], s21 offen offset:0
    v_mfma_f32_32x32x16_bf16 v[80:95], v[164:167], a[140:143], v[80:95]
    v_mfma_f32_32x32x16_bf16 v[96:111], v[164:167], v[76:79], v[96:111]
    buffer_load_dwordx4 v[164:167], v1, s[8:11], s21 offen offset:1024
    s_waitcnt lgkmcnt(0)
    s_barrier
    s_waitcnt vmcnt(26)
    v_mfma_f32_32x32x16_bf16 v[112:127], v[168:171], a[0:3], 0
    v_mfma_f32_32x32x16_bf16 v[128:143], v[168:171], a[144:147], 0
    s_add_u32 s21, s21, 2048
    s_add_u32 s21, s21, s30
    buffer_load_dwordx4 v[168:171], v1, s[8:11], s21 offen offset:0
    v_mfma_f32_32x32x16_bf16 v[112:127], v[172:175], a[4:7], v[112:127]
    s_nop 0
    v_cvt_pk_bf16_f32 v32, v80, v81
    v_mfma_f32_32x32x16_bf16 v[128:143], v[172:175], a[148:151], v[128:143]
    buffer_load_dwordx4 v[172:175], v1, s[8:11], s21 offen offset:1024
    v_cvt_pk_bf16_f32 v33, v82, v83
    s_waitcnt vmcnt(26)
    v_mfma_f32_32x32x16_bf16 v[112:127], v[176:179], a[8:11], v[112:127]
    v_cvt_pk_bf16_f32 v34, v84, v85
    v_mfma_f32_32x32x16_bf16 v[128:143], v[176:179], a[152:155], v[128:143]
    buffer_load_dwordx4 v[176:179], v1, s[8:11], s21 offen offset:2048
    v_cvt_pk_bf16_f32 v35, v86, v87
    v_mfma_f32_32x32x16_bf16 v[112:127], v[180:183], a[12:15], v[112:127]
    buffer_store_dwordx4 v[32:35], v1, s[8:11], s25 offen offset:0 sc1
    v_mfma_f32_32x32x16_bf16 v[128:143], v[180:183], a[156:159], v[128:143]
    buffer_load_dwordx4 v[180:183], v1, s[8:11], s21 offen offset:3072
    s_add_u32 s21, s21, 4096
    v_cvt_pk_bf16_f32 v36, v88, v89
    s_waitcnt vmcnt(27)
    v_mfma_f32_32x32x16_bf16 v[112:127], v[184:187], a[16:19], v[112:127]
    v_mfma_f32_32x32x16_bf16 v[128:143], v[184:187], a[160:163], v[128:143]
    s_add_u32 s21, s21, s31
    buffer_load_dwordx4 v[184:187], v1, s[8:11], s21 offen offset:0
    v_cvt_pk_bf16_f32 v37, v90, v91
    v_mfma_f32_32x32x16_bf16 v[112:127], v[188:191], a[20:23], v[112:127]
    v_cvt_pk_bf16_f32 v38, v92, v93
    v_mfma_f32_32x32x16_bf16 v[128:143], v[188:191], a[164:167], v[128:143]
    buffer_load_dwordx4 v[188:191], v1, s[8:11], s21 offen offset:1024
    v_cvt_pk_bf16_f32 v39, v94, v95
    s_waitcnt vmcnt(27)
    v_mfma_f32_32x32x16_bf16 v[112:127], v[192:195], a[24:27], v[112:127]
    buffer_store_dwordx4 v[36:39], v1, s[8:11], s25 offen offset:1024 sc1
    v_mfma_f32_32x32x16_bf16 v[128:143], v[192:195], a[168:171], v[128:143]
    buffer_load_dwordx4 v[192:195], v1, s[8:11], s21 offen offset:2048
    v_cvt_pk_bf16_f32 v32, v96, v97
    v_mfma_f32_32x32x16_bf16 v[112:127], v[196:199], a[28:31], v[112:127]
    v_mfma_f32_32x32x16_bf16 v[128:143], v[196:199], a[172:175], v[128:143]
    buffer_load_dwordx4 v[196:199], v1, s[8:11], s21 offen offset:3072
    s_add_u32 s21, s21, 4096
    v_cvt_pk_bf16_f32 v33, v98, v99
    s_waitcnt vmcnt(28)
    v_mfma_f32_32x32x16_bf16 v[112:127], v[200:203], a[32:35], v[112:127]
    v_cvt_pk_bf16_f32 v34, v100, v101
    v_mfma_f32_32x32x16_bf16 v[128:143], v[200:203], a[176:179], v[128:143]
    s_mov_b32 s21, s23
    s_add_u32 s23, s23, 36864
    buffer_load_dwordx4 v[200:203], v1, s[8:11], s21 offen offset:0
    v_cvt_pk_bf16_f32 v35, v102, v103
    v_mfma_f32_32x32x16_bf16 v[112:127], v[204:207], a[36:39], v[112:127]
    buffer_store_dwordx4 v[32:35], v1, s[8:11], s26 offen offset:0 sc1
    v_mfma_f32_32x32x16_bf16 v[128:143], v[204:207], a[180:183], v[128:143]
    buffer_load_dwordx4 v[204:207], v1, s[8:11], s21 offen offset:1024
    v_cvt_pk_bf16_f32 v36, v104, v105
    s_waitcnt vmcnt(29)
    v_mfma_f32_32x32x16_bf16 v[112:127], v[208:211], a[40:43], v[112:127]
    v_mfma_f32_32x32x16_bf16 v[128:143], v[208:211], a[184:187], v[128:143]
    buffer_load_dwordx4 v[208:211], v1, s[8:11], s21 offen offset:2048
    v_cvt_pk_bf16_f32 v37, v106, v107
    v_mfma_f32_32x32x16_bf16 v[112:127], v[212:215], a[44:47], v[112:127]
    v_cvt_pk_bf16_f32 v38, v108, v109
    v_mfma_f32_32x32x16_bf16 v[128:143], v[212:215], a[188:191], v[128:143]
    buffer_load_dwordx4 v[212:215], v1, s[8:11], s21 offen offset:3072
    s_add_u32 s21, s21, 4096
    v_cvt_pk_bf16_f32 v39, v110, v111
    s_waitcnt vmcnt(29)
    v_mfma_f32_32x32x16_bf16 v[112:127], v[216:219], a[48:51], v[112:127]
    buffer_store_dwordx4 v[36:39], v1, s[8:11], s26 offen offset:1024 sc1
    v_mfma_f32_32x32x16_bf16 v[128:143], v[216:219], a[192:195], v[128:143]
    buffer_load_dwordx4 v[216:219], v1, s[8:11], s21 offen offset:0
    ds_read_b128 v[44:47], v13 offset:0
    v_mfma_f32_32x32x16_bf16 v[112:127], v[220:223], a[52:55], v[112:127]
    v_mfma_f32_32x32x16_bf16 v[128:143], v[220:223], a[196:199], v[128:143]
    buffer_load_dwordx4 v[220:223], v1, s[8:11], s21 offen offset:1024
    s_waitcnt vmcnt(30)
    v_mfma_f32_32x32x16_bf16 v[112:127], v[224:227], a[56:59], v[112:127]
    v_mfma_f32_32x32x16_bf16 v[128:143], v[224:227], a[200:203], v[128:143]
    buffer_load_dwordx4 v[224:227], v1, s[8:11], s21 offen offset:2048
    v_mfma_f32_32x32x16_bf16 v[112:127], v[228:231], a[60:63], v[112:127]
    s_waitcnt lgkmcnt(0)
    v_add_f32 v240, v240, v44
    v_add_f32 v241, v241, v45
    v_add_f32 v242, v242, v46
    v_mfma_f32_32x32x16_bf16 v[128:143], v[228:231], a[204:207], v[128:143]
    buffer_load_dwordx4 v[228:231], v1, s[8:11], s21 offen offset:3072
    s_add_u32 s21, s21, 4096
    v_add_f32 v243, v243, v47
    s_waitcnt vmcnt(30)
    v_mfma_f32_32x32x16_bf16 v[112:127], v[232:235], a[64:67], v[112:127]
    ds_read_b128 v[44:47], v13 offset:1024
    v_mfma_f32_32x32x16_bf16 v[128:143], v[232:235], a[208:211], v[128:143]
    buffer_load_dwordx4 v[232:235], v1, s[8:11], s21 offen offset:0
    v_mfma_f32_32x32x16_bf16 v[112:127], v[236:239], a[68:71], v[112:127]
    v_mfma_f32_32x32x16_bf16 v[128:143], v[236:239], a[212:215], v[128:143]
    buffer_load_dwordx4 v[236:239], v1, s[8:11], s21 offen offset:1024
    s_waitcnt vmcnt(30)
    v_mfma_f32_32x32x16_bf16 v[112:127], v[16:19], a[72:75], v[112:127]
    v_mfma_f32_32x32x16_bf16 v[128:143], v[16:19], a[216:219], v[128:143]
    buffer_load_dwordx4 v[16:19], v1, s[8:11], s21 offen offset:2048
    v_mfma_f32_32x32x16_bf16 v[112:127], v[20:23], a[76:79], v[112:127]
    s_waitcnt lgkmcnt(0)
    v_add_f32 v244, v244, v44
    v_add_f32 v245, v245, v45
    v_add_f32 v246, v246, v46
    v_add_f32 v247, v247, v47
    v_mfma_f32_32x32x16_bf16 v[128:143], v[20:23], a[220:223], v[128:143]
    buffer_load_dwordx4 v[20:23], v1, s[8:11], s21 offen offset:3072
    s_add_u32 s21, s21, 4096
    s_waitcnt vmcnt(30)
    v_mfma_f32_32x32x16_bf16 v[112:127], v[24:27], a[80:83], v[112:127]
    ds_read_b128 v[44:47], v13 offset:2048
    v_mfma_f32_32x32x16_bf16 v[128:143], v[24:27], a[224:227], v[128:143]
    buffer_load_dwordx4 v[24:27], v1, s[8:11], s21 offen offset:0
    v_mfma_f32_32x32x16_bf16 v[112:127], v[28:31], a[84:87], v[112:127]
    v_mfma_f32_32x32x16_bf16 v[128:143], v[28:31], a[228:231], v[128:143]
    buffer_load_dwordx4 v[28:31], v1, s[8:11], s21 offen offset:1024
    s_waitcnt vmcnt(30)
    v_mfma_f32_32x32x16_bf16 v[112:127], v[144:147], a[88:91], v[112:127]
    v_mfma_f32_32x32x16_bf16 v[128:143], v[144:147], a[232:235], v[128:143]
    s_add_u32 s21, s21, 2048
    s_add_u32 s21, s21, s29
    buffer_load_dwordx4 v[144:147], v1, s[8:11], s21 offen offset:0
    s_waitcnt lgkmcnt(0)
    v_add_f32 v248, v248, v44
    v_add_f32 v249, v249, v45
    v_add_f32 v250, v250, v46
    v_mfma_f32_32x32x16_bf16 v[112:127], v[148:151], a[92:95], v[112:127]
    v_add_f32 v251, v251, v47
    v_mfma_f32_32x32x16_bf16 v[128:143], v[148:151], a[236:239], v[128:143]
    buffer_load_dwordx4 v[148:151], v1, s[8:11], s21 offen offset:1024
    ds_read_b128 v[44:47], v13 offset:3072
    s_waitcnt vmcnt(30)
    v_mfma_f32_32x32x16_bf16 v[112:127], v[152:155], a[96:99], v[112:127]
    v_mfma_f32_32x32x16_bf16 v[128:143], v[152:155], a[240:243], v[128:143]
    buffer_load_dwordx4 v[152:155], v1, s[8:11], s21 offen offset:2048
    v_mfma_f32_32x32x16_bf16 v[112:127], v[156:159], a[100:103], v[112:127]
    v_mfma_f32_32x32x16_bf16 v[128:143], v[156:159], a[244:247], v[128:143]
    buffer_load_dwordx4 v[156:159], v1, s[8:11], s21 offen offset:3072
    s_add_u32 s21, s21, 4096
    s_waitcnt vmcnt(30)
    v_mfma_f32_32x32x16_bf16 v[112:127], v[160:163], a[104:107], v[112:127]
    s_waitcnt lgkmcnt(0)
    v_add_f32 v252, v252, v44
    v_add_f32 v253, v253, v45
    v_add_f32 v254, v254, v46
    v_mfma_f32_32x32x16_bf16 v[128:143], v[160:163], a[248:251], v[128:143]
    buffer_load_dwordx4 v[160:163], v1, s[8:11], s21 offen offset:0
    v_add_f32 v255, v255, v47
    v_mfma_f32_32x32x16_bf16 v[112:127], v[164:167], a[108:111], v[112:127]
    v_cvt_pk_bf16_f32 v32, v240, v241
    v_mfma_f32_32x32x16_bf16 v[128:143], v[164:167], a[252:255], v[128:143]
    buffer_load_dwordx4 v[164:167], v1, s[8:11], s21 offen offset:1024
    v_cvt_pk_bf16_f32 v33, v242, v243
    s_waitcnt vmcnt(30)
    v_mfma_f32_32x32x16_bf16 v[112:127], v[168:171], a[112:115], v[112:127]
    v_cvt_pk_bf16_f32 v34, v244, v245
    v_mfma_f32_32x32x16_bf16 v[128:143], v[168:171], v[48:51], v[128:143]
    buffer_load_dwordx4 v[168:171], v1, s[8:11], s21 offen offset:2048
    v_cvt_pk_bf16_f32 v35, v246, v247
    v_mfma_f32_32x32x16_bf16 v[112:127], v[172:175], a[116:119], v[112:127]
    v_mfma_f32_32x32x16_bf16 v[128:143], v[172:175], v[52:55], v[128:143]
    buffer_load_dwordx4 v[172:175], v1, s[8:11], s21 offen offset:3072
    s_add_u32 s21, s21, 4096
    buffer_store_dwordx4 v[32:35], v1, s[8:11], s27 offen offset:0 sc1
    s_waitcnt vmcnt(30)
    v_mfma_f32_32x32x16_bf16 v[112:127], v[176:179], a[120:123], v[112:127]
    v_cvt_pk_bf16_f32 v36, v248, v249
    v_mfma_f32_32x32x16_bf16 v[128:143], v[176:179], v[56:59], v[128:143]
    buffer_load_dwordx4 v[176:179], v1, s[8:11], s21 offen offset:0
    v_cvt_pk_bf16_f32 v37, v250, v251
    v_mfma_f32_32x32x16_bf16 v[112:127], v[180:183], a[124:127], v[112:127]
    v_cvt_pk_bf16_f32 v38, v252, v253
    v_mfma_f32_32x32x16_bf16 v[128:143], v[180:183], v[60:63], v[128:143]
    buffer_load_dwordx4 v[180:183], v1, s[8:11], s21 offen offset:1024
    v_cvt_pk_bf16_f32 v39, v254, v255
    s_waitcnt vmcnt(30)
    v_mfma_f32_32x32x16_bf16 v[112:127], v[184:187], a[128:131], v[112:127]
    v_mfma_f32_32x32x16_bf16 v[128:143], v[184:187], v[64:67], v[128:143]
    buffer_load_dwordx4 v[184:187], v1, s[8:11], s21 offen offset:2048
    buffer_store_dwordx4 v[36:39], v1, s[8:11], s27 offen offset:1024 sc1
    v_mfma_f32_32x32x16_bf16 v[112:127], v[188:191], a[132:135], v[112:127]
    v_mfma_f32_32x32x16_bf16 v[128:143], v[188:191], v[68:71], v[128:143]
    buffer_load_dwordx4 v[188:191], v1, s[8:11], s21 offen offset:3072
    s_add_u32 s21, s21, 4096
    s_waitcnt vmcnt(30)
    v_mfma_f32_32x32x16_bf16 v[112:127], v[192:195], a[136:139], v[112:127]
    v_mfma_f32_32x32x16_bf16 v[128:143], v[192:195], v[72:75], v[128:143]
    buffer_load_dwordx4 v[192:195], v1, s[8:11], s21 offen offset:0
    v_mfma_f32_32x32x16_bf16 v[112:127], v[196:199], a[140:143], v[112:127]
    v_mfma_f32_32x32x16_bf16 v[128:143], v[196:199], v[76:79], v[128:143]
    buffer_load_dwordx4 v[196:199], v1, s[8:11], s21 offen offset:1024
    s_add_u32 s25, s25, 4096
    s_add_u32 s26, s26, 4096
    s_waitcnt vmcnt(29)
    v_mfma_f32_32x32x16_bf16 v[80:95], v[200:203], a[0:3], 0
    v_mfma_f32_32x32x16_bf16 v[96:111], v[200:203], a[144:147], 0
    s_add_u32 s21, s21, 2048
    s_add_u32 s21, s21, s30
    buffer_load_dwordx4 v[200:203], v1, s[8:11], s21 offen offset:0
    v_mfma_f32_32x32x16_bf16 v[80:95], v[204:207], a[4:7], v[80:95]
    s_nop 0
    v_cvt_pk_bf16_f32 v32, v112, v113
    v_cvt_pk_bf16_f32 v33, v114, v115
    v_mfma_f32_32x32x16_bf16 v[96:111], v[204:207], a[148:151], v[96:111]
    buffer_load_dwordx4 v[204:207], v1, s[8:11], s21 offen offset:1024
    v_cvt_pk_bf16_f32 v34, v116, v117
    v_cvt_pk_bf16_f32 v35, v118, v119
    s_waitcnt vmcnt(29)
    v_mfma_f32_32x32x16_bf16 v[80:95], v[208:211], a[8:11], v[80:95]
    buffer_store_dwordx4 v[32:35], v1, s[8:11], s25 offen offset:0 sc1
    v_cvt_pk_bf16_f32 v36, v120, v121
    v_mfma_f32_32x32x16_bf16 v[96:111], v[208:211], a[152:155], v[96:111]
    buffer_load_dwordx4 v[208:211], v1, s[8:11], s21 offen offset:2048
    v_cvt_pk_bf16_f32 v37, v122, v123
    v_cvt_pk_bf16_f32 v38, v124, v125
    v_mfma_f32_32x32x16_bf16 v[80:95], v[212:215], a[12:15], v[80:95]
    v_cvt_pk_bf16_f32 v39, v126, v127
    buffer_store_dwordx4 v[36:39], v1, s[8:11], s25 offen offset:1024 sc1
    v_mfma_f32_32x32x16_bf16 v[96:111], v[212:215], a[156:159], v[96:111]
    buffer_load_dwordx4 v[212:215], v1, s[8:11], s21 offen offset:3072
    s_add_u32 s21, s21, 4096
    v_cvt_pk_bf16_f32 v32, v128, v129
    s_waitcnt vmcnt(30)
    v_mfma_f32_32x32x16_bf16 v[80:95], v[216:219], a[16:19], v[80:95]
    v_cvt_pk_bf16_f32 v33, v130, v131
    v_cvt_pk_bf16_f32 v34, v132, v133
    v_mfma_f32_32x32x16_bf16 v[96:111], v[216:219], a[160:163], v[96:111]
    s_add_u32 s21, s21, s31
    buffer_load_dwordx4 v[216:219], v1, s[8:11], s21 offen offset:0
    v_cvt_pk_bf16_f32 v35, v134, v135
    buffer_store_dwordx4 v[32:35], v1, s[8:11], s26 offen offset:0 sc1
    v_mfma_f32_32x32x16_bf16 v[80:95], v[220:223], a[20:23], v[80:95]
    v_cvt_pk_bf16_f32 v36, v136, v137
    v_cvt_pk_bf16_f32 v37, v138, v139
    v_mfma_f32_32x32x16_bf16 v[96:111], v[220:223], a[164:167], v[96:111]
    buffer_load_dwordx4 v[220:223], v1, s[8:11], s21 offen offset:1024
    v_cvt_pk_bf16_f32 v38, v140, v141
    v_cvt_pk_bf16_f32 v39, v142, v143
    s_waitcnt vmcnt(31)
    v_mfma_f32_32x32x16_bf16 v[80:95], v[224:227], a[24:27], v[80:95]
    buffer_store_dwordx4 v[36:39], v1, s[8:11], s26 offen offset:1024 sc1
    v_mfma_f32_32x32x16_bf16 v[96:111], v[224:227], a[168:171], v[96:111]
    buffer_load_dwordx4 v[224:227], v1, s[8:11], s21 offen offset:2048
    v_mfma_f32_32x32x16_bf16 v[80:95], v[228:231], a[28:31], v[80:95]
    v_mfma_f32_32x32x16_bf16 v[96:111], v[228:231], a[172:175], v[96:111]
    buffer_load_dwordx4 v[228:231], v1, s[8:11], s21 offen offset:3072
    s_add_u32 s21, s21, 4096
    s_waitcnt vmcnt(32)
    v_mfma_f32_32x32x16_bf16 v[80:95], v[232:235], a[32:35], v[80:95]
    v_mfma_f32_32x32x16_bf16 v[96:111], v[232:235], a[176:179], v[96:111]
    v_mfma_f32_32x32x16_bf16 v[80:95], v[236:239], a[36:39], v[80:95]
    v_mfma_f32_32x32x16_bf16 v[96:111], v[236:239], a[180:183], v[96:111]
    s_waitcnt vmcnt(30)
    v_mfma_f32_32x32x16_bf16 v[80:95], v[16:19], a[40:43], v[80:95]
    v_mfma_f32_32x32x16_bf16 v[96:111], v[16:19], a[184:187], v[96:111]
    v_mfma_f32_32x32x16_bf16 v[80:95], v[20:23], a[44:47], v[80:95]
    v_mfma_f32_32x32x16_bf16 v[96:111], v[20:23], a[188:191], v[96:111]
    s_waitcnt vmcnt(28)
    v_mfma_f32_32x32x16_bf16 v[80:95], v[24:27], a[48:51], v[80:95]
    v_mfma_f32_32x32x16_bf16 v[96:111], v[24:27], a[192:195], v[96:111]
    v_mfma_f32_32x32x16_bf16 v[80:95], v[28:31], a[52:55], v[80:95]
    v_mfma_f32_32x32x16_bf16 v[96:111], v[28:31], a[196:199], v[96:111]
    s_waitcnt vmcnt(26)
    v_mfma_f32_32x32x16_bf16 v[80:95], v[144:147], a[56:59], v[80:95]
    v_mfma_f32_32x32x16_bf16 v[96:111], v[144:147], a[200:203], v[96:111]
    v_mfma_f32_32x32x16_bf16 v[80:95], v[148:151], a[60:63], v[80:95]
    v_mfma_f32_32x32x16_bf16 v[96:111], v[148:151], a[204:207], v[96:111]
    s_waitcnt vmcnt(24)
    v_mfma_f32_32x32x16_bf16 v[80:95], v[152:155], a[64:67], v[80:95]
    v_mfma_f32_32x32x16_bf16 v[96:111], v[152:155], a[208:211], v[96:111]
    v_mfma_f32_32x32x16_bf16 v[80:95], v[156:159], a[68:71], v[80:95]
    v_mfma_f32_32x32x16_bf16 v[96:111], v[156:159], a[212:215], v[96:111]
    s_waitcnt vmcnt(22)
    v_mfma_f32_32x32x16_bf16 v[80:95], v[160:163], a[72:75], v[80:95]
    v_mfma_f32_32x32x16_bf16 v[96:111], v[160:163], a[216:219], v[96:111]
    v_mfma_f32_32x32x16_bf16 v[80:95], v[164:167], a[76:79], v[80:95]
    v_mfma_f32_32x32x16_bf16 v[96:111], v[164:167], a[220:223], v[96:111]
    s_waitcnt vmcnt(20)
    v_mfma_f32_32x32x16_bf16 v[80:95], v[168:171], a[80:83], v[80:95]
    v_mfma_f32_32x32x16_bf16 v[96:111], v[168:171], a[224:227], v[96:111]
    v_mfma_f32_32x32x16_bf16 v[80:95], v[172:175], a[84:87], v[80:95]
    v_mfma_f32_32x32x16_bf16 v[96:111], v[172:175], a[228:231], v[96:111]
    s_waitcnt vmcnt(17)
    v_mfma_f32_32x32x16_bf16 v[80:95], v[176:179], a[88:91], v[80:95]
    v_mfma_f32_32x32x16_bf16 v[96:111], v[176:179], a[232:235], v[96:111]
    v_mfma_f32_32x32x16_bf16 v[80:95], v[180:183], a[92:95], v[80:95]
    v_mfma_f32_32x32x16_bf16 v[96:111], v[180:183], a[236:239], v[96:111]
    s_waitcnt vmcnt(14)
    v_mfma_f32_32x32x16_bf16 v[80:95], v[184:187], a[96:99], v[80:95]
    v_mfma_f32_32x32x16_bf16 v[96:111], v[184:187], a[240:243], v[96:111]
    v_mfma_f32_32x32x16_bf16 v[80:95], v[188:191], a[100:103], v[80:95]
    v_mfma_f32_32x32x16_bf16 v[96:111], v[188:191], a[244:247], v[96:111]
    s_waitcnt vmcnt(12)
    v_mfma_f32_32x32x16_bf16 v[80:95], v[192:195], a[104:107], v[80:95]
    v_mfma_f32_32x32x16_bf16 v[96:111], v[192:195], a[248:251], v[96:111]
    v_mfma_f32_32x32x16_bf16 v[80:95], v[196:199], a[108:111], v[80:95]
    v_mfma_f32_32x32x16_bf16 v[96:111], v[196:199], a[252:255], v[96:111]
    s_waitcnt vmcnt(10)
    v_mfma_f32_32x32x16_bf16 v[80:95], v[200:203], a[112:115], v[80:95]
    v_mfma_f32_32x32x16_bf16 v[96:111], v[200:203], v[48:51], v[96:111]
    v_mfma_f32_32x32x16_bf16 v[80:95], v[204:207], a[116:119], v[80:95]
    v_mfma_f32_32x32x16_bf16 v[96:111], v[204:207], v[52:55], v[96:111]
    s_waitcnt vmcnt(6)
    v_mfma_f32_32x32x16_bf16 v[80:95], v[208:211], a[120:123], v[80:95]
    v_mfma_f32_32x32x16_bf16 v[96:111], v[208:211], v[56:59], v[96:111]
    v_mfma_f32_32x32x16_bf16 v[80:95], v[212:215], a[124:127], v[80:95]
    v_mfma_f32_32x32x16_bf16 v[96:111], v[212:215], v[60:63], v[96:111]
    s_waitcnt vmcnt(3)
    v_mfma_f32_32x32x16_bf16 v[80:95], v[216:219], a[128:131], v[80:95]
    v_mfma_f32_32x32x16_bf16 v[96:111], v[216:219], v[64:67], v[96:111]
    v_mfma_f32_32x32x16_bf16 v[80:95], v[220:223], a[132:135], v[80:95]
    v_mfma_f32_32x32x16_bf16 v[96:111], v[220:223], v[68:71], v[96:111]
    s_waitcnt vmcnt(0)
    v_mfma_f32_32x32x16_bf16 v[80:95], v[224:227], a[136:139], v[80:95]
    v_mfma_f32_32x32x16_bf16 v[96:111], v[224:227], v[72:75], v[96:111]
    v_mfma_f32_32x32x16_bf16 v[80:95], v[228:231], a[140:143], v[80:95]
    v_mfma_f32_32x32x16_bf16 v[96:111], v[228:231], v[76:79], v[96:111]
    s_add_u32 s25, s25, 4096
    s_add_u32 s26, s26, 4096
    s_load_dwordx2 s[4:5], s[0:1], 88
    s_load_dwordx2 s[6:7], s[0:1], 112
    s_lshl_b32 s33, s17, 3
    s_add_u32 s46, s33, s16
    s_lshl_b32 s46, s46, 7
    s_add_u32 s46, s46, 0x29b2000
    s_lshl_b32 s33, s33, 7
    s_add_u32 s47, s33, 0x29b2000
    v_mov_b32 v15, 0
    s_waitcnt vmcnt(0)
    s_barrier
    s_cmp_lg_u32 s20, 0
    s_cbranch_scc1 K4_NF1
    v_mov_b32 v14, 1
    s_mov_b64 exec, 1
    buffer_store_dword v14, v15, s[8:11], s46 offen offset:0 sc1
    s_mov_b64 exec, -1
K4_NF1:
    s_lshl_b32 s33, s20, 12
    s_add_u32 s33, s33, 16384
    v_add_u32 v2, s33, v1
    v_cvt_pk_bf16_f32 v32, v80, v81
    v_cvt_pk_bf16_f32 v33, v82, v83
    v_cvt_pk_bf16_f32 v34, v84, v85
    v_cvt_pk_bf16_f32 v35, v86, v87
    ds_write_b128 v2, v[32:35] offset:0
    v_cvt_pk_bf16_f32 v36, v88, v89
    v_cvt_pk_bf16_f32 v37, v90, v91
    v_cvt_pk_bf16_f32 v38, v92, v93
    v_cvt_pk_bf16_f32 v39, v94, v95
    ds_write_b128 v2, v[36:39] offset:1024
    v_cvt_pk_bf16_f32 v32, v96, v97
    v_cvt_pk_bf16_f32 v33, v98, v99
    v_cvt_pk_bf16_f32 v34, v100, v101
    v_cvt_pk_bf16_f32 v35, v102, v103
    ds_write_b128 v2, v[32:35] offset:2048
    v_cvt_pk_bf16_f32 v36, v104, v105
    v_cvt_pk_bf16_f32 v37, v106, v107
    v_cvt_pk_bf16_f32 v38, v108, v109
    v_cvt_pk_bf16_f32 v39, v110, v111
    ds_write_b128 v2, v[36:39] offset:3072
    v_mov_b32 v14, 0
    v_mov_b32 v173, 8192
    ds_write_b32 v173, v14
    s_waitcnt lgkmcnt(0)
    s_barrier
    s_mov_b32 s12, s4
    s_and_b32 s13, s5, 0xffff
    s_mov_b32 s14, 0x480
    s_mov_b32 s15, 0x20000
    s_mov_b32 s36, s6
    s_and_b32 s37, s7, 0xffff
    s_mov_b32 s38, 0x240000
    s_mov_b32 s39, 0x20000
    s_mul_i32 s34, s17, 589824
    s_add_u32 s34, s34, 0x17b2000
    v_lshrrev_b32 v2, 4, v1
    v_and_b32 v3, 31, v2
    v_lshrrev_b32 v4, 5, v2
    v_lshlrev_b32 v4, 4, v4
    v_lshlrev_b32 v172, 3, v3
    v_mul_u32_u24 v3, 1152, v3
    v_lshlrev_b32 v5, 3, v1
    v_mov_b32 v174, 0x3f80
    v_mov_b32 v175, 0x3f800000
    s_cmp_eq_u32 s20, 3
    s_cbranch_scc1 K4_W3
    s_mul_i32 s40, s16, 7
    s_add_u32 s40, s40, s20
    s_lshr_b32 s41, s40, 2
    s_mul_hi_u32 s42, s41, 0x55555556
    s_add_u32 s42, s42, s41
    s_add_u32 s43, s41, 4
    s_cmp_ge_u32 s41, 12
    s_cselect_b32 s42, s43, s42
    s_lshl_b32 s42, s42, 2
    s_and_b32 s40, s40, 3
    s_add_u32 s48, s42, s40
    s_mul_i32 s40, s16, 7
    s_add_u32 s40, s40, s20
    s_add_u32 s40, s40, 3
    s_lshr_b32 s41, s40, 2
    s_mul_hi_u32 s42, s41, 0x55555556
    s_add_u32 s42, s42, s41
    s_add_u32 s43, s41, 4
    s_cmp_ge_u32 s41, 12
    s_cselect_b32 s42, s43, s42
    s_lshl_b32 s42, s42, 2
    s_and_b32 s40, s40, 3
    s_add_u32 s49, s42, s40
    s_mul_i32 s40, s16, 7
    s_add_u32 s40, s40, 6
    s_lshr_b32 s41, s40, 2
    s_mul_hi_u32 s42, s41, 0x55555556
    s_add_u32 s42, s42, s41
    s_add_u32 s43, s41, 4
    s_cmp_ge_u32 s41, 12
    s_cselect_b32 s42, s43, s42
    s_lshl_b32 s42, s42, 2
    s_and_b32 s40, s40, 3
    s_add_u32 s50, s42, s40
    s_cmp_lg_u32 s20, 0
    s_cbranch_scc1 K4_RELAY
    s_mov_b64 exec, 0xff
    s_mov_b32 s35, 16384
K4_POLL1:
    buffer_load_dword v14, v5, s[8:11], s47 offen offset:0 sc1
    s_waitcnt vmcnt(0)
    v_cmp_ne_u32 vcc, 1, v14
    s_sub_u32 s35, s35, 1
    s_cmp_eq_u32 s35, 0
    s_cbranch_scc1 K4_POLL1_X
    s_nop 0
    s_cbranch_vccnz K4_POLL1
K4_POLL1_X:
    s_mov_b64 exec, -1
    v_mov_b32 v14, 1
    ds_write_b32 v173, v14
    s_branch K4_GO
K4_RELAY:
    s_mov_b32 s35, 262144
K4_RELAY_L:
    ds_read_b32 v14, v173
    s_waitcnt lgkmcnt(0)
    v_cmp_ne_u32 vcc, 1, v14
    s_sub_u32 s35, s35, 1
    s_cmp_eq_u32 s35, 0
    s_cbranch_scc1 K4_GO
    s_nop 0
    s_cbranch_vccnz K4_RELAY_L
K4_GO:
    s_lshl_b32 s41, s48, 10
    s_add_u32 s41, s41, s34
    buffer_load_dwordx4 v[16:19], v1, s[8:11], s41 offen sc1
    s_add_u32 s41, s41, 73728
    buffer_load_dwordx4 v[20:23], v1, s[8:11], s41 offen sc1
    s_add_u32 s41, s41, 73728
    buffer_load_dwordx4 v[24:27], v1, s[8:11], s41 offen sc1
    s_add_u32 s41, s41, 73728
    buffer_load_dwordx4 v[28:31], v1, s[8:11], s41 offen sc1
    s_add_u32 s41, s41, 73728
    buffer_load_dwordx4 v[32:35], v1, s[8:11], s41 offen sc1
    s_add_u32 s41, s41, 73728
    buffer_load_dwordx4 v[36:39], v1, s[8:11], s41 offen sc1
    s_add_u32 s41, s41, 73728
    buffer_load_dwordx4 v[40:43], v1, s[8:11], s41 offen sc1
    s_add_u32 s41, s41, 73728
    buffer_load_dwordx4 v[44:47], v1, s[8:11], s41 offen sc1
    s_lshr_b32 s42, s48, 2
    s_lshl_b32 s42, s42, 6
    s_and_b32 s43, s48, 1
    s_lshl_b32 s43, s43, 5
    s_add_u32 s42, s42, s43
    s_bfe_u32 s43, s48, 0x10001
    s_lshl_b32 s43, s43, 5
    s_lshl_b32 s44, s17, 6
    s_add_u32 s43, s43, s44
    s_mul_i32 s43, s43, 1152
    s_add_u32 s43, s43, s42
    v_add_u32 v6, s42, v4
    v_add_u32 v7, v3, v4
    v_add_u32 v7, s43, v7
    s_mov_b32 s45, 0xf680
    v_lshlrev_b32 v12, 11, v6
    s_bfe_u32 s44, s48, 0x10001
    s_lshl_b32 s44, s44, 5
    s_lshl_b32 s51, s17, 6
    s_add_u32 s44, s44, s51
    s_lshl_b32 s44, s44, 3
    s_add_u32 s44, s44, 0x6d2000
    v_add_u32 v12, v12, v172
    v_add_u32 v13, 16384, v12
    buffer_load_dwordx2 v[112:113], v12, s[8:11], s44 offen
    buffer_load_dwordx2 v[114:115], v13, s[8:11], s44 offen
    buffer_load_dwordx4 v[116:119], v6, s[8:11], s45 offen
    buffer_load_dwordx4 v[120:123], v6, s[12:15], 0 offen
    s_lshl_b32 s41, s49, 10
    s_add_u32 s41, s41, s34
    buffer_load_dwordx4 v[48:51], v1, s[8:11], s41 offen sc1
    s_add_u32 s41, s41, 73728
    buffer_load_dwordx4 v[52:55], v1, s[8:11], s41 offen sc1
    s_add_u32 s41, s41, 73728
    buffer_load_dwordx4 v[56:59], v1, s[8:11], s41 offen sc1
    s_add_u32 s41, s41, 73728
    buffer_load_dwordx4 v[60:63], v1, s[8:11], s41 offen sc1
    s_add_u32 s41, s41, 73728
    buffer_load_dwordx4 v[64:67], v1, s[8:11], s41 offen sc1
    s_add_u32 s41, s41, 73728
    buffer_load_dwordx4 v[68:71], v1, s[8:11], s41 offen sc1
    s_add_u32 s41, s41, 73728
    buffer_load_dwordx4 v[72:75], v1, s[8:11], s41 offen sc1
    s_add_u32 s41, s41, 73728
    buffer_load_dwordx4 v[76:79], v1, s[8:11], s41 offen sc1
    s_lshr_b32 s42, s49, 2
    s_lshl_b32 s42, s42, 6
    s_and_b32 s43, s49, 1
    s_lshl_b32 s43, s43, 5
    s_add_u32 s42, s42, s43
    s_bfe_u32 s43, s49, 0x10001
    s_lshl_b32 s43, s43, 5
    s_lshl_b32 s44, s17, 6
    s_add_u32 s43, s43, s44
    s_mul_i32 s43, s43, 1152
    s_add_u32 s43, s43, s42
    v_add_u32 v8, s42, v4
    v_add_u32 v9, v3, v4
    v_add_u32 v9, s43, v9
    s_mov_b32 s45, 0xf680
    v_lshlrev_b32 v12, 11, v8
    s_bfe_u32 s44, s49, 0x10001
    s_lshl_b32 s44, s44, 5
    s_lshl_b32 s51, s17, 6
    s_add_u32 s44, s44, s51
    s_lshl_b32 s44, s44, 3
    s_add_u32 s44, s44, 0x6d2000
    v_add_u32 v12, v12, v172
    v_add_u32 v13, 16384, v12
    buffer_load_dwordx2 v[124:125], v12, s[8:11], s44 offen
    buffer_load_dwordx2 v[126:127], v13, s[8:11], s44 offen
    buffer_load_dwordx4 v[128:131], v8, s[8:11], s45 offen
    buffer_load_dwordx4 v[132:135], v8, s[12:15], 0 offen
    s_cmp_lg_u32 s20, 0
    s_cbranch_scc1 K4_TWO
    s_lshl_b32 s41, s50, 10
    s_add_u32 s41, s41, s34
    buffer_load_dwordx4 v[80:83], v1, s[8:11], s41 offen sc1
    s_add_u32 s41, s41, 73728
    buffer_load_dwordx4 v[84:87], v1, s[8:11], s41 offen sc1
    s_add_u32 s41, s41, 73728
    buffer_load_dwordx4 v[88:91], v1, s[8:11], s41 offen sc1
    s_add_u32 s41, s41, 73728
    buffer_load_dwordx4 v[92:95], v1, s[8:11], s41 offen sc1
    s_add_u32 s41, s41, 73728
    buffer_load_dwordx4 v[96:99], v1, s[8:11], s41 offen sc1
    s_add_u32 s41, s41, 73728
    buffer_load_dwordx4 v[100:103], v1, s[8:11], s41 offen sc1
    s_add_u32 s41, s41, 73728
    buffer_load_dwordx4 v[104:107], v1, s[8:11], s41 offen sc1
    s_add_u32 s41, s41, 73728
    buffer_load_dwordx4 v[108:111], v1, s[8:11], s41 offen sc1
    s_lshr_b32 s42, s50, 2
    s_lshl_b32 s42, s42, 6
    s_and_b32 s43, s50, 1
    s_lshl_b32 s43, s43, 5
    s_add_u32 s42, s42, s43
    s_bfe_u32 s43, s50, 0x10001
    s_lshl_b32 s43, s43, 5
    s_lshl_b32 s44, s17, 6
    s_add_u32 s43, s43, s44
    s_mul_i32 s43, s43, 1152
    s_add_u32 s43, s43, s42
    v_add_u32 v10, s42, v4
    v_add_u32 v11, v3, v4
    v_add_u32 v11, s43, v11
    s_mov_b32 s45, 0xf680
    v_lshlrev_b32 v12, 11, v10
    s_bfe_u32 s44, s50, 0x10001
    s_lshl_b32 s44, s44, 5
    s_lshl_b32 s51, s17, 6
    s_add_u32 s44, s44, s51
    s_lshl_b32 s44, s44, 3
    s_add_u32 s44, s44, 0x6d2000
    v_add_u32 v12, v12, v172
    v_add_u32 v13, 16384, v12
    buffer_load_dwordx2 v[136:137], v12, s[8:11], s44 offen
    buffer_load_dwordx2 v[138:139], v13, s[8:11], s44 offen
    buffer_load_dwordx4 v[140:143], v10, s[8:11], s45 offen
    buffer_load_dwordx4 v[144:147], v10, s[12:15], 0 offen
    s_waitcnt vmcnt(24)
    v_lshlrev_b32 v160, 16, v16
    v_and_b32 v161, 0xffff0000, v16
    v_lshlrev_b32 v162, 16, v17
    v_and_b32 v163, 0xffff0000, v17
    v_lshlrev_b32 v164, 16, v18
    v_and_b32 v165, 0xffff0000, v18
    v_lshlrev_b32 v166, 16, v19
    v_and_b32 v167, 0xffff0000, v19
    v_dot2c_f32_bf16 v160, v20, v174
    v_dot2c_f32_bf16 v161, v20, v175
    v_dot2c_f32_bf16 v162, v21, v174
    v_dot2c_f32_bf16 v163, v21, v175
    v_dot2c_f32_bf16 v164, v22, v174
    v_dot2c_f32_bf16 v165, v22, v175
    v_dot2c_f32_bf16 v166, v23, v174
    v_dot2c_f32_bf16 v167, v23, v175
    v_dot2c_f32_bf16 v160, v24, v174
    v_dot2c_f32_bf16 v161, v24, v175
    v_dot2c_f32_bf16 v162, v25, v174
    v_dot2c_f32_bf16 v163, v25, v175
    v_dot2c_f32_bf16 v164, v26, v174
    v_dot2c_f32_bf16 v165, v26, v175
    v_dot2c_f32_bf16 v166, v27, v174
    v_dot2c_f32_bf16 v167, v27, v175
    v_dot2c_f32_bf16 v160, v28, v174
    v_dot2c_f32_bf16 v161, v28, v175
    v_dot2c_f32_bf16 v162, v29, v174
    v_dot2c_f32_bf16 v163, v29, v175
    v_dot2c_f32_bf16 v164, v30, v174
    v_dot2c_f32_bf16 v165, v30, v175
    v_dot2c_f32_bf16 v166, v31, v174
    v_dot2c_f32_bf16 v167, v31, v175
    v_dot2c_f32_bf16 v160, v32, v174
    v_dot2c_f32_bf16 v161, v32, v175
    v_dot2c_f32_bf16 v162, v33, v174
    v_dot2c_f32_bf16 v163, v33, v175
    v_dot2c_f32_bf16 v164, v34, v174
    v_dot2c_f32_bf16 v165, v34, v175
    v_dot2c_f32_bf16 v166, v35, v174
    v_dot2c_f32_bf16 v167, v35, v175
    v_dot2c_f32_bf16 v160, v36, v174
    v_dot2c_f32_bf16 v161, v36, v175
    v_dot2c_f32_bf16 v162, v37, v174
    v_dot2c_f32_bf16 v163, v37, v175
    v_dot2c_f32_bf16 v164, v38, v174
    v_dot2c_f32_bf16 v165, v38, v175
    v_dot2c_f32_bf16 v166, v39, v174
    v_dot2c_f32_bf16 v167, v39, v175
    v_dot2c_f32_bf16 v160, v40, v174
    v_dot2c_f32_bf16 v161, v40, v175
    v_dot2c_f32_bf16 v162, v41, v174
    v_dot2c_f32_bf16 v163, v41, v175
    v_dot2c_f32_bf16 v164, v42, v174
    v_dot2c_f32_bf16 v165, v42, v175
    v_dot2c_f32_bf16 v166, v43, v174
    v_dot2c_f32_bf16 v167, v43, v175
    v_dot2c_f32_bf16 v160, v44, v174
    v_dot2c_f32_bf16 v161, v44, v175
    v_dot2c_f32_bf16 v162, v45, v174
    v_dot2c_f32_bf16 v163, v45, v175
    v_dot2c_f32_bf16 v164, v46, v174
    v_dot2c_f32_bf16 v165, v46, v175
    v_dot2c_f32_bf16 v166, v47, v174
    v_dot2c_f32_bf16 v167, v47, v175
    v_permlane32_swap_b32 v160, v164
    v_permlane32_swap_b32 v161, v165
    v_permlane32_swap_b32 v162, v166
    v_permlane32_swap_b32 v163, v167
    v_lshlrev_b32 v12, 16, v120
    v_lshlrev_b32 v13, 16, v116
    v_lshlrev_b32 v14, 16, v112
    v_add_f32 v160, v160, v12
    v_fma_f32 v160, v160, v13, v14
    v_and_b32 v12, 0xffff0000, v120
    v_and_b32 v13, 0xffff0000, v116
    v_and_b32 v14, 0xffff0000, v112
    v_add_f32 v161, v161, v12
    v_fma_f32 v161, v161, v13, v14
    v_lshlrev_b32 v12, 16, v121
    v_lshlrev_b32 v13, 16, v117
    v_lshlrev_b32 v14, 16, v113
    v_add_f32 v162, v162, v12
    v_fma_f32 v162, v162, v13, v14
    v_and_b32 v12, 0xffff0000, v121
    v_and_b32 v13, 0xffff0000, v117
    v_and_b32 v14, 0xffff0000, v113
    v_add_f32 v163, v163, v12
    v_fma_f32 v163, v163, v13, v14
    v_lshlrev_b32 v12, 16, v122
    v_lshlrev_b32 v13, 16, v118
    v_lshlrev_b32 v14, 16, v114
    v_add_f32 v164, v164, v12
    v_fma_f32 v164, v164, v13, v14
    v_and_b32 v12, 0xffff0000, v122
    v_and_b32 v13, 0xffff0000, v118
    v_and_b32 v14, 0xffff0000, v114
    v_add_f32 v165, v165, v12
    v_fma_f32 v165, v165, v13, v14
    v_lshlrev_b32 v12, 16, v123
    v_lshlrev_b32 v13, 16, v119
    v_lshlrev_b32 v14, 16, v115
    v_add_f32 v166, v166, v12
    v_fma_f32 v166, v166, v13, v14
    v_and_b32 v12, 0xffff0000, v123
    v_and_b32 v13, 0xffff0000, v119
    v_and_b32 v14, 0xffff0000, v115
    v_add_f32 v167, v167, v12
    v_fma_f32 v167, v167, v13, v14
    v_cvt_pk_bf16_f32 v168, v160, v161
    v_cvt_pk_bf16_f32 v169, v162, v163
    v_cvt_pk_bf16_f32 v170, v164, v165
    v_cvt_pk_bf16_f32 v171, v166, v167
    buffer_store_dwordx4 v[168:171], v7, s[36:39], 0 offen
    s_waitcnt vmcnt(13)
    v_lshlrev_b32 v160, 16, v48
    v_and_b32 v161, 0xffff0000, v48
    v_lshlrev_b32 v162, 16, v49
    v_and_b32 v163, 0xffff0000, v49
    v_lshlrev_b32 v164, 16, v50
    v_and_b32 v165, 0xffff0000, v50
    v_lshlrev_b32 v166, 16, v51
    v_and_b32 v167, 0xffff0000, v51
    v_dot2c_f32_bf16 v160, v52, v174
    v_dot2c_f32_bf16 v161, v52, v175
    v_dot2c_f32_bf16 v162, v53, v174
    v_dot2c_f32_bf16 v163, v53, v175
    v_dot2c_f32_bf16 v164, v54, v174
    v_dot2c_f32_bf16 v165, v54, v175
    v_dot2c_f32_bf16 v166, v55, v174
    v_dot2c_f32_bf16 v167, v55, v175
    v_dot2c_f32_bf16 v160, v56, v174
    v_dot2c_f32_bf16 v161, v56, v175
    v_dot2c_f32_bf16 v162, v57, v174
    v_dot2c_f32_bf16 v163, v57, v175
    v_dot2c_f32_bf16 v164, v58, v174
    v_dot2c_f32_bf16 v165, v58, v175
    v_dot2c_f32_bf16 v166, v59, v174
    v_dot2c_f32_bf16 v167, v59, v175
    v_dot2c_f32_bf16 v160, v60, v174
    v_dot2c_f32_bf16 v161, v60, v175
    v_dot2c_f32_bf16 v162, v61, v174
    v_dot2c_f32_bf16 v163, v61, v175
    v_dot2c_f32_bf16 v164, v62, v174
    v_dot2c_f32_bf16 v165, v62, v175
    v_dot2c_f32_bf16 v166, v63, v174
    v_dot2c_f32_bf16 v167, v63, v175
    v_dot2c_f32_bf16 v160, v64, v174
    v_dot2c_f32_bf16 v161, v64, v175
    v_dot2c_f32_bf16 v162, v65, v174
    v_dot2c_f32_bf16 v163, v65, v175
    v_dot2c_f32_bf16 v164, v66, v174
    v_dot2c_f32_bf16 v165, v66, v175
    v_dot2c_f32_bf16 v166, v67, v174
    v_dot2c_f32_bf16 v167, v67, v175
    v_dot2c_f32_bf16 v160, v68, v174
    v_dot2c_f32_bf16 v161, v68, v175
    v_dot2c_f32_bf16 v162, v69, v174
    v_dot2c_f32_bf16 v163, v69, v175
    v_dot2c_f32_bf16 v164, v70, v174
    v_dot2c_f32_bf16 v165, v70, v175
    v_dot2c_f32_bf16 v166, v71, v174
    v_dot2c_f32_bf16 v167, v71, v175
    v_dot2c_f32_bf16 v160, v72, v174
    v_dot2c_f32_bf16 v161, v72, v175
    v_dot2c_f32_bf16 v162, v73, v174
    v_dot2c_f32_bf16 v163, v73, v175
    v_dot2c_f32_bf16 v164, v74, v174
    v_dot2c_f32_bf16 v165, v74, v175
    v_dot2c_f32_bf16 v166, v75, v174
    v_dot2c_f32_bf16 v167, v75, v175
    v_dot2c_f32_bf16 v160, v76, v174
    v_dot2c_f32_bf16 v161, v76, v175
    v_dot2c_f32_bf16 v162, v77, v174
    v_dot2c_f32_bf16 v163, v77, v175
    v_dot2c_f32_bf16 v164, v78, v174
    v_dot2c_f32_bf16 v165, v78, v175
    v_dot2c_f32_bf16 v166, v79, v174
    v_dot2c_f32_bf16 v167, v79, v175
    v_permlane32_swap_b32 v160, v164
    v_permlane32_swap_b32 v161, v165
    v_permlane32_swap_b32 v162, v166
    v_permlane32_swap_b32 v163, v167
    v_lshlrev_b32 v12, 16, v132
    v_lshlrev_b32 v13, 16, v128
    v_lshlrev_b32 v14, 16, v124
    v_add_f32 v160, v160, v12
    v_fma_f32 v160, v160, v13, v14
    v_and_b32 v12, 0xffff0000, v132
    v_and_b32 v13, 0xffff0000, v128
    v_and_b32 v14, 0xffff0000, v124
    v_add_f32 v161, v161, v12
    v_fma_f32 v161, v161, v13, v14
    v_lshlrev_b32 v12, 16, v133
    v_lshlrev_b32 v13, 16, v129
    v_lshlrev_b32 v14, 16, v125
    v_add_f32 v162, v162, v12
    v_fma_f32 v162, v162, v13, v14
    v_and_b32 v12, 0xffff0000, v133
    v_and_b32 v13, 0xffff0000, v129
    v_and_b32 v14, 0xffff0000, v125
    v_add_f32 v163, v163, v12
    v_fma_f32 v163, v163, v13, v14
    v_lshlrev_b32 v12, 16, v134
    v_lshlrev_b32 v13, 16, v130
    v_lshlrev_b32 v14, 16, v126
    v_add_f32 v164, v164, v12
    v_fma_f32 v164, v164, v13, v14
    v_and_b32 v12, 0xffff0000, v134
    v_and_b32 v13, 0xffff0000, v130
    v_and_b32 v14, 0xffff0000, v126
    v_add_f32 v165, v165, v12
    v_fma_f32 v165, v165, v13, v14
    v_lshlrev_b32 v12, 16, v135
    v_lshlrev_b32 v13, 16, v131
    v_lshlrev_b32 v14, 16, v127
    v_add_f32 v166, v166, v12
    v_fma_f32 v166, v166, v13, v14
    v_and_b32 v12, 0xffff0000, v135
    v_and_b32 v13, 0xffff0000, v131
    v_and_b32 v14, 0xffff0000, v127
    v_add_f32 v167, v167, v12
    v_fma_f32 v167, v167, v13, v14
    v_cvt_pk_bf16_f32 v168, v160, v161
    v_cvt_pk_bf16_f32 v169, v162, v163
    v_cvt_pk_bf16_f32 v170, v164, v165
    v_cvt_pk_bf16_f32 v171, v166, v167
    buffer_store_dwordx4 v[168:171], v9, s[36:39], 0 offen
    s_waitcnt vmcnt(2)
    v_lshlrev_b32 v160, 16, v80
    v_and_b32 v161, 0xffff0000, v80
    v_lshlrev_b32 v162, 16, v81
    v_and_b32 v163, 0xffff0000, v81
    v_lshlrev_b32 v164, 16, v82
    v_and_b32 v165, 0xffff0000, v82
    v_lshlrev_b32 v166, 16, v83
    v_and_b32 v167, 0xffff0000, v83
    v_dot2c_f32_bf16 v160, v84, v174
    v_dot2c_f32_bf16 v161, v84, v175
    v_dot2c_f32_bf16 v162, v85, v174
    v_dot2c_f32_bf16 v163, v85, v175
    v_dot2c_f32_bf16 v164, v86, v174
    v_dot2c_f32_bf16 v165, v86, v175
    v_dot2c_f32_bf16 v166, v87, v174
    v_dot2c_f32_bf16 v167, v87, v175
    v_dot2c_f32_bf16 v160, v88, v174
    v_dot2c_f32_bf16 v161, v88, v175
    v_dot2c_f32_bf16 v162, v89, v174
    v_dot2c_f32_bf16 v163, v89, v175
    v_dot2c_f32_bf16 v164, v90, v174
    v_dot2c_f32_bf16 v165, v90, v175
    v_dot2c_f32_bf16 v166, v91, v174
    v_dot2c_f32_bf16 v167, v91, v175
    v_dot2c_f32_bf16 v160, v92, v174
    v_dot2c_f32_bf16 v161, v92, v175
    v_dot2c_f32_bf16 v162, v93, v174
    v_dot2c_f32_bf16 v163, v93, v175
    v_dot2c_f32_bf16 v164, v94, v174
    v_dot2c_f32_bf16 v165, v94, v175
    v_dot2c_f32_bf16 v166, v95, v174
    v_dot2c_f32_bf16 v167, v95, v175
    v_dot2c_f32_bf16 v160, v96, v174
    v_dot2c_f32_bf16 v161, v96, v175
    v_dot2c_f32_bf16 v162, v97, v174
    v_dot2c_f32_bf16 v163, v97, v175
    v_dot2c_f32_bf16 v164, v98, v174
    v_dot2c_f32_bf16 v165, v98, v175
    v_dot2c_f32_bf16 v166, v99, v174
    v_dot2c_f32_bf16 v167, v99, v175
    v_dot2c_f32_bf16 v160, v100, v174
    v_dot2c_f32_bf16 v161, v100, v175
    v_dot2c_f32_bf16 v162, v101, v174
    v_dot2c_f32_bf16 v163, v101, v175
    v_dot2c_f32_bf16 v164, v102, v174
    v_dot2c_f32_bf16 v165, v102, v175
    v_dot2c_f32_bf16 v166, v103, v174
    v_dot2c_f32_bf16 v167, v103, v175
    v_dot2c_f32_bf16 v160, v104, v174
    v_dot2c_f32_bf16 v161, v104, v175
    v_dot2c_f32_bf16 v162, v105, v174
    v_dot2c_f32_bf16 v163, v105, v175
    v_dot2c_f32_bf16 v164, v106, v174
    v_dot2c_f32_bf16 v165, v106, v175
    v_dot2c_f32_bf16 v166, v107, v174
    v_dot2c_f32_bf16 v167, v107, v175
    v_dot2c_f32_bf16 v160, v108, v174
    v_dot2c_f32_bf16 v161, v108, v175
    v_dot2c_f32_bf16 v162, v109, v174
    v_dot2c_f32_bf16 v163, v109, v175
    v_dot2c_f32_bf16 v164, v110, v174
    v_dot2c_f32_bf16 v165, v110, v175
    v_dot2c_f32_bf16 v166, v111, v174
    v_dot2c_f32_bf16 v167, v111, v175
    v_permlane32_swap_b32 v160, v164
    v_permlane32_swap_b32 v161, v165
    v_permlane32_swap_b32 v162, v166
    v_permlane32_swap_b32 v163, v167
    v_lshlrev_b32 v12, 16, v144
    v_lshlrev_b32 v13, 16, v140
    v_lshlrev_b32 v14, 16, v136
    v_add_f32 v160, v160, v12
    v_fma_f32 v160, v160, v13, v14
    v_and_b32 v12, 0xffff0000, v144
    v_and_b32 v13, 0xffff0000, v140
    v_and_b32 v14, 0xffff0000, v136
    v_add_f32 v161, v161, v12
    v_fma_f32 v161, v161, v13, v14
    v_lshlrev_b32 v12, 16, v145
    v_lshlrev_b32 v13, 16, v141
    v_lshlrev_b32 v14, 16, v137
    v_add_f32 v162, v162, v12
    v_fma_f32 v162, v162, v13, v14
    v_and_b32 v12, 0xffff0000, v145
    v_and_b32 v13, 0xffff0000, v141
    v_and_b32 v14, 0xffff0000, v137
    v_add_f32 v163, v163, v12
    v_fma_f32 v163, v163, v13, v14
    v_lshlrev_b32 v12, 16, v146
    v_lshlrev_b32 v13, 16, v142
    v_lshlrev_b32 v14, 16, v138
    v_add_f32 v164, v164, v12
    v_fma_f32 v164, v164, v13, v14
    v_and_b32 v12, 0xffff0000, v146
    v_and_b32 v13, 0xffff0000, v142
    v_and_b32 v14, 0xffff0000, v138
    v_add_f32 v165, v165, v12
    v_fma_f32 v165, v165, v13, v14
    v_lshlrev_b32 v12, 16, v147
    v_lshlrev_b32 v13, 16, v143
    v_lshlrev_b32 v14, 16, v139
    v_add_f32 v166, v166, v12
    v_fma_f32 v166, v166, v13, v14
    v_and_b32 v12, 0xffff0000, v147
    v_and_b32 v13, 0xffff0000, v143
    v_and_b32 v14, 0xffff0000, v139
    v_add_f32 v167, v167, v12
    v_fma_f32 v167, v167, v13, v14
    v_cvt_pk_bf16_f32 v168, v160, v161
    v_cvt_pk_bf16_f32 v169, v162, v163
    v_cvt_pk_bf16_f32 v170, v164, v165
    v_cvt_pk_bf16_f32 v171, v166, v167
    buffer_store_dwordx4 v[168:171], v11, s[36:39], 0 offen
    s_branch K4_RDONE
K4_TWO:
    s_waitcnt vmcnt(12)
    v_lshlrev_b32 v160, 16, v16
    v_and_b32 v161, 0xffff0000, v16
    v_lshlrev_b32 v162, 16, v17
    v_and_b32 v163, 0xffff0000, v17
    v_lshlrev_b32 v164, 16, v18
    v_and_b32 v165, 0xffff0000, v18
    v_lshlrev_b32 v166, 16, v19
    v_and_b32 v167, 0xffff0000, v19
    v_dot2c_f32_bf16 v160, v20, v174
    v_dot2c_f32_bf16 v161, v20, v175
    v_dot2c_f32_bf16 v162, v21, v174
    v_dot2c_f32_bf16 v163, v21, v175
    v_dot2c_f32_bf16 v164, v22, v174
    v_dot2c_f32_bf16 v165, v22, v175
    v_dot2c_f32_bf16 v166, v23, v174
    v_dot2c_f32_bf16 v167, v23, v175
    v_dot2c_f32_bf16 v160, v24, v174
    v_dot2c_f32_bf16 v161, v24, v175
    v_dot2c_f32_bf16 v162, v25, v174
    v_dot2c_f32_bf16 v163, v25, v175
    v_dot2c_f32_bf16 v164, v26, v174
    v_dot2c_f32_bf16 v165, v26, v175
    v_dot2c_f32_bf16 v166, v27, v174
    v_dot2c_f32_bf16 v167, v27, v175
    v_dot2c_f32_bf16 v160, v28, v174
    v_dot2c_f32_bf16 v161, v28, v175
    v_dot2c_f32_bf16 v162, v29, v174
    v_dot2c_f32_bf16 v163, v29, v175
    v_dot2c_f32_bf16 v164, v30, v174
    v_dot2c_f32_bf16 v165, v30, v175
    v_dot2c_f32_bf16 v166, v31, v174
    v_dot2c_f32_bf16 v167, v31, v175
    v_dot2c_f32_bf16 v160, v32, v174
    v_dot2c_f32_bf16 v161, v32, v175
    v_dot2c_f32_bf16 v162, v33, v174
    v_dot2c_f32_bf16 v163, v33, v175
    v_dot2c_f32_bf16 v164, v34, v174
    v_dot2c_f32_bf16 v165, v34, v175
    v_dot2c_f32_bf16 v166, v35, v174
    v_dot2c_f32_bf16 v167, v35, v175
    v_dot2c_f32_bf16 v160, v36, v174
    v_dot2c_f32_bf16 v161, v36, v175
    v_dot2c_f32_bf16 v162, v37, v174
    v_dot2c_f32_bf16 v163, v37, v175
    v_dot2c_f32_bf16 v164, v38, v174
    v_dot2c_f32_bf16 v165, v38, v175
    v_dot2c_f32_bf16 v166, v39, v174
    v_dot2c_f32_bf16 v167, v39, v175
    v_dot2c_f32_bf16 v160, v40, v174
    v_dot2c_f32_bf16 v161, v40, v175
    v_dot2c_f32_bf16 v162, v41, v174
    v_dot2c_f32_bf16 v163, v41, v175
    v_dot2c_f32_bf16 v164, v42, v174
    v_dot2c_f32_bf16 v165, v42, v175
    v_dot2c_f32_bf16 v166, v43, v174
    v_dot2c_f32_bf16 v167, v43, v175
    v_dot2c_f32_bf16 v160, v44, v174
    v_dot2c_f32_bf16 v161, v44, v175
    v_dot2c_f32_bf16 v162, v45, v174
    v_dot2c_f32_bf16 v163, v45, v175
    v_dot2c_f32_bf16 v164, v46, v174
    v_dot2c_f32_bf16 v165, v46, v175
    v_dot2c_f32_bf16 v166, v47, v174
    v_dot2c_f32_bf16 v167, v47, v175
    v_permlane32_swap_b32 v160, v164
    v_permlane32_swap_b32 v161, v165
    v_permlane32_swap_b32 v162, v166
    v_permlane32_swap_b32 v163, v167
    v_lshlrev_b32 v12, 16, v120
    v_lshlrev_b32 v13, 16, v116
    v_lshlrev_b32 v14, 16, v112
    v_add_f32 v160, v160, v12
    v_fma_f32 v160, v160, v13, v14
    v_and_b32 v12, 0xffff0000, v120
    v_and_b32 v13, 0xffff0000, v116
    v_and_b32 v14, 0xffff0000, v112
    v_add_f32 v161, v161, v12
    v_fma_f32 v161, v161, v13, v14
    v_lshlrev_b32 v12, 16, v121
    v_lshlrev_b32 v13, 16, v117
    v_lshlrev_b32 v14, 16, v113
    v_add_f32 v162, v162, v12
    v_fma_f32 v162, v162, v13, v14
    v_and_b32 v12, 0xffff0000, v121
    v_and_b32 v13, 0xffff0000, v117
    v_and_b32 v14, 0xffff0000, v113
    v_add_f32 v163, v163, v12
    v_fma_f32 v163, v163, v13, v14
    v_lshlrev_b32 v12, 16, v122
    v_lshlrev_b32 v13, 16, v118
    v_lshlrev_b32 v14, 16, v114
    v_add_f32 v164, v164, v12
    v_fma_f32 v164, v164, v13, v14
    v_and_b32 v12, 0xffff0000, v122
    v_and_b32 v13, 0xffff0000, v118
    v_and_b32 v14, 0xffff0000, v114
    v_add_f32 v165, v165, v12
    v_fma_f32 v165, v165, v13, v14
    v_lshlrev_b32 v12, 16, v123
    v_lshlrev_b32 v13, 16, v119
    v_lshlrev_b32 v14, 16, v115
    v_add_f32 v166, v166, v12
    v_fma_f32 v166, v166, v13, v14
    v_and_b32 v12, 0xffff0000, v123
    v_and_b32 v13, 0xffff0000, v119
    v_and_b32 v14, 0xffff0000, v115
    v_add_f32 v167, v167, v12
    v_fma_f32 v167, v167, v13, v14
    v_cvt_pk_bf16_f32 v168, v160, v161
    v_cvt_pk_bf16_f32 v169, v162, v163
    v_cvt_pk_bf16_f32 v170, v164, v165
    v_cvt_pk_bf16_f32 v171, v166, v167
    buffer_store_dwordx4 v[168:171], v7, s[36:39], 0 offen
    s_waitcnt vmcnt(1)
    v_lshlrev_b32 v160, 16, v48
    v_and_b32 v161, 0xffff0000, v48
    v_lshlrev_b32 v162, 16, v49
    v_and_b32 v163, 0xffff0000, v49
    v_lshlrev_b32 v164, 16, v50
    v_and_b32 v165, 0xffff0000, v50
    v_lshlrev_b32 v166, 16, v51
    v_and_b32 v167, 0xffff0000, v51
    v_dot2c_f32_bf16 v160, v52, v174
    v_dot2c_f32_bf16 v161, v52, v175
    v_dot2c_f32_bf16 v162, v53, v174
    v_dot2c_f32_bf16 v163, v53, v175
    v_dot2c_f32_bf16 v164, v54, v174
    v_dot2c_f32_bf16 v165, v54, v175
    v_dot2c_f32_bf16 v166, v55, v174
    v_dot2c_f32_bf16 v167, v55, v175
    v_dot2c_f32_bf16 v160, v56, v174
    v_dot2c_f32_bf16 v161, v56, v175
    v_dot2c_f32_bf16 v162, v57, v174
    v_dot2c_f32_bf16 v163, v57, v175
    v_dot2c_f32_bf16 v164, v58, v174
    v_dot2c_f32_bf16 v165, v58, v175
    v_dot2c_f32_bf16 v166, v59, v174
    v_dot2c_f32_bf16 v167, v59, v175
    v_dot2c_f32_bf16 v160, v60, v174
    v_dot2c_f32_bf16 v161, v60, v175
    v_dot2c_f32_bf16 v162, v61, v174
    v_dot2c_f32_bf16 v163, v61, v175
    v_dot2c_f32_bf16 v164, v62, v174
    v_dot2c_f32_bf16 v165, v62, v175
    v_dot2c_f32_bf16 v166, v63, v174
    v_dot2c_f32_bf16 v167, v63, v175
    v_dot2c_f32_bf16 v160, v64, v174
    v_dot2c_f32_bf16 v161, v64, v175
    v_dot2c_f32_bf16 v162, v65, v174
    v_dot2c_f32_bf16 v163, v65, v175
    v_dot2c_f32_bf16 v164, v66, v174
    v_dot2c_f32_bf16 v165, v66, v175
    v_dot2c_f32_bf16 v166, v67, v174
    v_dot2c_f32_bf16 v167, v67, v175
    v_dot2c_f32_bf16 v160, v68, v174
    v_dot2c_f32_bf16 v161, v68, v175
    v_dot2c_f32_bf16 v162, v69, v174
    v_dot2c_f32_bf16 v163, v69, v175
    v_dot2c_f32_bf16 v164, v70, v174
    v_dot2c_f32_bf16 v165, v70, v175
    v_dot2c_f32_bf16 v166, v71, v174
    v_dot2c_f32_bf16 v167, v71, v175
    v_dot2c_f32_bf16 v160, v72, v174
    v_dot2c_f32_bf16 v161, v72, v175
    v_dot2c_f32_bf16 v162, v73, v174
    v_dot2c_f32_bf16 v163, v73, v175
    v_dot2c_f32_bf16 v164, v74, v174
    v_dot2c_f32_bf16 v165, v74, v175
    v_dot2c_f32_bf16 v166, v75, v174
    v_dot2c_f32_bf16 v167, v75, v175
    v_dot2c_f32_bf16 v160, v76, v174
    v_dot2c_f32_bf16 v161, v76, v175
    v_dot2c_f32_bf16 v162, v77, v174
    v_dot2c_f32_bf16 v163, v77, v175
    v_dot2c_f32_bf16 v164, v78, v174
    v_dot2c_f32_bf16 v165, v78, v175
    v_dot2c_f32_bf16 v166, v79, v174
    v_dot2c_f32_bf16 v167, v79, v175
    v_permlane32_swap_b32 v160, v164
    v_permlane32_swap_b32 v161, v165
    v_permlane32_swap_b32 v162, v166
    v_permlane32_swap_b32 v163, v167
    v_lshlrev_b32 v12, 16, v132
    v_lshlrev_b32 v13, 16, v128
    v_lshlrev_b32 v14, 16, v124
    v_add_f32 v160, v160, v12
    v_fma_f32 v160, v160, v13, v14
    v_and_b32 v12, 0xffff0000, v132
    v_and_b32 v13, 0xffff0000, v128
    v_and_b32 v14, 0xffff0000, v124
    v_add_f32 v161, v161, v12
    v_fma_f32 v161, v161, v13, v14
    v_lshlrev_b32 v12, 16, v133
    v_lshlrev_b32 v13, 16, v129
    v_lshlrev_b32 v14, 16, v125
    v_add_f32 v162, v162, v12
    v_fma_f32 v162, v162, v13, v14
    v_and_b32 v12, 0xffff0000, v133
    v_and_b32 v13, 0xffff0000, v129
    v_and_b32 v14, 0xffff0000, v125
    v_add_f32 v163, v163, v12
    v_fma_f32 v163, v163, v13, v14
    v_lshlrev_b32 v12, 16, v134
    v_lshlrev_b32 v13, 16, v130
    v_lshlrev_b32 v14, 16, v126
    v_add_f32 v164, v164, v12
    v_fma_f32 v164, v164, v13, v14
    v_and_b32 v12, 0xffff0000, v134
    v_and_b32 v13, 0xffff0000, v130
    v_and_b32 v14, 0xffff0000, v126
    v_add_f32 v165, v165, v12
    v_fma_f32 v165, v165, v13, v14
    v_lshlrev_b32 v12, 16, v135
    v_lshlrev_b32 v13, 16, v131
    v_lshlrev_b32 v14, 16, v127
    v_add_f32 v166, v166, v12
    v_fma_f32 v166, v166, v13, v14
    v_and_b32 v12, 0xffff0000, v135
    v_and_b32 v13, 0xffff0000, v131
    v_and_b32 v14, 0xffff0000, v127
    v_add_f32 v167, v167, v12
    v_fma_f32 v167, v167, v13, v14
    v_cvt_pk_bf16_f32 v168, v160, v161
    v_cvt_pk_bf16_f32 v169, v162, v163
    v_cvt_pk_bf16_f32 v170, v164, v165
    v_cvt_pk_bf16_f32 v171, v166, v167
    buffer_store_dwordx4 v[168:171], v9, s[36:39], 0 offen
    s_branch K4_RDONE
K4_W3:
    v_add_u32 v2, 16384, v1
    s_lshl_b32 s33, s17, 3
    s_add_u32 s33, s33, s16
    s_mul_i32 s33, s33, 73728
    s_add_u32 s33, s33, 0x17b5000
    ds_read_b128 v[16:19], v2 offset:0
    ds_read_b128 v[20:23], v2 offset:1024
    ds_read_b128 v[24:27], v2 offset:2048
    ds_read_b128 v[28:31], v2 offset:3072
    ds_read_b128 v[32:35], v2 offset:4096
    ds_read_b128 v[36:39], v2 offset:5120
    ds_read_b128 v[40:43], v2 offset:6144
    ds_read_b128 v[44:47], v2 offset:7168
    s_waitcnt lgkmcnt(4)
    ds_read_b128 v[48:51], v2 offset:8192
    ds_read_b128 v[52:55], v2 offset:9216
    ds_read_b128 v[56:59], v2 offset:10240
    ds_read_b128 v[60:63], v2 offset:11264
    ds_read_b128 v[64:67], v2 offset:12288
    ds_read_b128 v[68:71], v2 offset:13312
    ds_read_b128 v[72:75], v2 offset:14336
    ds_read_b128 v[76:79], v2 offset:15360
    buffer_store_dwordx4 v[16:19], v1, s[8:11], s33 offen offset:0 sc1
    buffer_store_dwordx4 v[20:23], v1, s[8:11], s33 offen offset:1024 sc1
    buffer_store_dwordx4 v[24:27], v1, s[8:11], s33 offen offset:2048 sc1
    buffer_store_dwordx4 v[28:31], v1, s[8:11], s33 offen offset:3072 sc1
    s_add_u32 s33, s33, 16384
    s_waitcnt lgkmcnt(11)
    buffer_store_dwordx4 v[32:35], v1, s[8:11], s33 offen offset:2048 sc1
    s_waitcnt lgkmcnt(10)
    buffer_store_dwordx4 v[36:39], v1, s[8:11], s33 offen offset:3072 sc1
    s_waitcnt lgkmcnt(9)
    buffer_store_dwordx4 v[40:43], v1, s[8:11], s33 offen offset:0 sc1
    s_waitcnt lgkmcnt(8)
    buffer_store_dwordx4 v[44:47], v1, s[8:11], s33 offen offset:1024 sc1
    s_add_u32 s33, s33, 16384
    s_waitcnt lgkmcnt(7)
    buffer_store_dwordx4 v[48:51], v1, s[8:11], s33 offen offset:0 sc1
    s_waitcnt lgkmcnt(6)
    buffer_store_dwordx4 v[52:55], v1, s[8:11], s33 offen offset:1024 sc1
    s_waitcnt lgkmcnt(5)
    buffer_store_dwordx4 v[56:59], v1, s[8:11], s33 offen offset:2048 sc1
    s_waitcnt lgkmcnt(4)
    buffer_store_dwordx4 v[60:63], v1, s[8:11], s33 offen offset:3072 sc1
    s_add_u32 s33, s33, 16384
    s_waitcnt lgkmcnt(3)
    buffer_store_dwordx4 v[64:67], v1, s[8:11], s33 offen offset:2048 sc1
    s_waitcnt lgkmcnt(2)
    buffer_store_dwordx4 v[68:71], v1, s[8:11], s33 offen offset:3072 sc1
    s_waitcnt lgkmcnt(1)
    buffer_store_dwordx4 v[72:75], v1, s[8:11], s33 offen offset:0 sc1
    s_waitcnt lgkmcnt(0)
    buffer_store_dwordx4 v[76:79], v1, s[8:11], s33 offen offset:1024 sc1
    s_lshl_b32 s40, s16, 1
    s_add_u32 s40, s40, 0
    s_lshr_b32 s41, s40, 2
    s_lshl_b32 s41, s41, 4
    s_add_u32 s41, s41, 12
    s_and_b32 s40, s40, 3
    s_add_u32 s48, s41, s40
    s_lshl_b32 s40, s16, 1
    s_add_u32 s40, s40, 1
    s_lshr_b32 s41, s40, 2
    s_lshl_b32 s41, s41, 4
    s_add_u32 s41, s41, 12
    s_and_b32 s40, s40, 3
    s_add_u32 s49, s41, s40
    s_waitcnt vmcnt(0)
    v_mov_b32 v14, 1
    s_mov_b64 exec, 1
    buffer_store_dword v14, v15, s[8:11], s46 offen offset:4 sc1
    s_mov_b64 exec, -1
    s_mov_b64 exec, 0xff
    s_mov_b32 s35, 16384
K4_POLL2:
    buffer_load_dword v14, v5, s[8:11], s47 offen offset:4 sc1
    s_waitcnt vmcnt(0)
    v_cmp_ne_u32 vcc, 1, v14
    s_sub_u32 s35, s35, 1
    s_cmp_eq_u32 s35, 0
    s_cbranch_scc1 K4_POLL2_X
    s_nop 0
    s_cbranch_vccnz K4_POLL2
K4_POLL2_X:
    s_mov_b64 exec, -1
    s_lshl_b32 s41, s48, 10
    s_add_u32 s41, s41, s34
    buffer_load_dwordx4 v[16:19], v1, s[8:11], s41 offen sc1
    s_add_u32 s41, s41, 73728
    buffer_load_dwordx4 v[20:23], v1, s[8:11], s41 offen sc1
    s_add_u32 s41, s41, 73728
    buffer_load_dwordx4 v[24:27], v1, s[8:11], s41 offen sc1
    s_add_u32 s41, s41, 73728
    buffer_load_dwordx4 v[28:31], v1, s[8:11], s41 offen sc1
    s_add_u32 s41, s41, 73728
    buffer_load_dwordx4 v[32:35], v1, s[8:11], s41 offen sc1
    s_add_u32 s41, s41, 73728
    buffer_load_dwordx4 v[36:39], v1, s[8:11], s41 offen sc1
    s_add_u32 s41, s41, 73728
    buffer_load_dwordx4 v[40:43], v1, s[8:11], s41 offen sc1
    s_add_u32 s41, s41, 73728
    buffer_load_dwordx4 v[44:47], v1, s[8:11], s41 offen sc1
    s_lshr_b32 s42, s48, 2
    s_lshl_b32 s42, s42, 6
    s_and_b32 s43, s48, 1
    s_lshl_b32 s43, s43, 5
    s_add_u32 s42, s42, s43
    s_bfe_u32 s43, s48, 0x10001
    s_lshl_b32 s43, s43, 5
    s_lshl_b32 s44, s17, 6
    s_add_u32 s43, s43, s44
    s_mul_i32 s43, s43, 1152
    s_add_u32 s43, s43, s42
    v_add_u32 v6, s42, v4
    v_add_u32 v7, v3, v4
    v_add_u32 v7, s43, v7
    s_mov_b32 s45, 0xf680
    v_lshlrev_b32 v12, 11, v6
    s_bfe_u32 s44, s48, 0x10001
    s_lshl_b32 s44, s44, 5
    s_lshl_b32 s51, s17, 6
    s_add_u32 s44, s44, s51
    s_lshl_b32 s44, s44, 3
    s_add_u32 s44, s44, 0x6d2000
    v_add_u32 v12, v12, v172
    v_add_u32 v13, 16384, v12
    buffer_load_dwordx2 v[112:113], v12, s[8:11], s44 offen
    buffer_load_dwordx2 v[114:115], v13, s[8:11], s44 offen
    buffer_load_dwordx4 v[116:119], v6, s[8:11], s45 offen
    buffer_load_dwordx4 v[120:123], v6, s[12:15], 0 offen
    s_lshl_b32 s41, s49, 10
    s_add_u32 s41, s41, s34
    buffer_load_dwordx4 v[48:51], v1, s[8:11], s41 offen sc1
    s_add_u32 s41, s41, 73728
    buffer_load_dwordx4 v[52:55], v1, s[8:11], s41 offen sc1
    s_add_u32 s41, s41, 73728
    buffer_load_dwordx4 v[56:59], v1, s[8:11], s41 offen sc1
    s_add_u32 s41, s41, 73728
    buffer_load_dwordx4 v[60:63], v1, s[8:11], s41 offen sc1
    s_add_u32 s41, s41, 73728
    buffer_load_dwordx4 v[64:67], v1, s[8:11], s41 offen sc1
    s_add_u32 s41, s41, 73728
    buffer_load_dwordx4 v[68:71], v1, s[8:11], s41 offen sc1
    s_add_u32 s41, s41, 73728
    buffer_load_dwordx4 v[72:75], v1, s[8:11], s41 offen sc1
    s_add_u32 s41, s41, 73728
    buffer_load_dwordx4 v[76:79], v1, s[8:11], s41 offen sc1
    s_lshr_b32 s42, s49, 2
    s_lshl_b32 s42, s42, 6
    s_and_b32 s43, s49, 1
    s_lshl_b32 s43, s43, 5
    s_add_u32 s42, s42, s43
    s_bfe_u32 s43, s49, 0x10001
    s_lshl_b32 s43, s43, 5
    s_lshl_b32 s44, s17, 6
    s_add_u32 s43, s43, s44
    s_mul_i32 s43, s43, 1152
    s_add_u32 s43, s43, s42
    v_add_u32 v8, s42, v4
    v_add_u32 v9, v3, v4
    v_add_u32 v9, s43, v9
    s_mov_b32 s45, 0xf680
    v_lshlrev_b32 v12, 11, v8
    s_bfe_u32 s44, s49, 0x10001
    s_lshl_b32 s44, s44, 5
    s_lshl_b32 s51, s17, 6
    s_add_u32 s44, s44, s51
    s_lshl_b32 s44, s44, 3
    s_add_u32 s44, s44, 0x6d2000
    v_add_u32 v12, v12, v172
    v_add_u32 v13, 16384, v12
    buffer_load_dwordx2 v[124:125], v12, s[8:11], s44 offen
    buffer_load_dwordx2 v[126:127], v13, s[8:11], s44 offen
    buffer_load_dwordx4 v[128:131], v8, s[8:11], s45 offen
    buffer_load_dwordx4 v[132:135], v8, s[12:15], 0 offen
    s_waitcnt vmcnt(12)
    v_lshlrev_b32 v160, 16, v16
    v_and_b32 v161, 0xffff0000, v16
    v_lshlrev_b32 v162, 16, v17
    v_and_b32 v163, 0xffff0000, v17
    v_lshlrev_b32 v164, 16, v18
    v_and_b32 v165, 0xffff0000, v18
    v_lshlrev_b32 v166, 16, v19
    v_and_b32 v167, 0xffff0000, v19
    v_dot2c_f32_bf16 v160, v20, v174
    v_dot2c_f32_bf16 v161, v20, v175
    v_dot2c_f32_bf16 v162, v21, v174
    v_dot2c_f32_bf16 v163, v21, v175
    v_dot2c_f32_bf16 v164, v22, v174
    v_dot2c_f32_bf16 v165, v22, v175
    v_dot2c_f32_bf16 v166, v23, v174
    v_dot2c_f32_bf16 v167, v23, v175
    v_dot2c_f32_bf16 v160, v24, v174
    v_dot2c_f32_bf16 v161, v24, v175
    v_dot2c_f32_bf16 v162, v25, v174
    v_dot2c_f32_bf16 v163, v25, v175
    v_dot2c_f32_bf16 v164, v26, v174
    v_dot2c_f32_bf16 v165, v26, v175
    v_dot2c_f32_bf16 v166, v27, v174
    v_dot2c_f32_bf16 v167, v27, v175
    v_dot2c_f32_bf16 v160, v28, v174
    v_dot2c_f32_bf16 v161, v28, v175
    v_dot2c_f32_bf16 v162, v29, v174
    v_dot2c_f32_bf16 v163, v29, v175
    v_dot2c_f32_bf16 v164, v30, v174
    v_dot2c_f32_bf16 v165, v30, v175
    v_dot2c_f32_bf16 v166, v31, v174
    v_dot2c_f32_bf16 v167, v31, v175
    v_dot2c_f32_bf16 v160, v32, v174
    v_dot2c_f32_bf16 v161, v32, v175
    v_dot2c_f32_bf16 v162, v33, v174
    v_dot2c_f32_bf16 v163, v33, v175
    v_dot2c_f32_bf16 v164, v34, v174
    v_dot2c_f32_bf16 v165, v34, v175
    v_dot2c_f32_bf16 v166, v35, v174
    v_dot2c_f32_bf16 v167, v35, v175
    v_dot2c_f32_bf16 v160, v36, v174
    v_dot2c_f32_bf16 v161, v36, v175
    v_dot2c_f32_bf16 v162, v37, v174
    v_dot2c_f32_bf16 v163, v37, v175
    v_dot2c_f32_bf16 v164, v38, v174
    v_dot2c_f32_bf16 v165, v38, v175
    v_dot2c_f32_bf16 v166, v39, v174
    v_dot2c_f32_bf16 v167, v39, v175
    v_dot2c_f32_bf16 v160, v40, v174
    v_dot2c_f32_bf16 v161, v40, v175
    v_dot2c_f32_bf16 v162, v41, v174
    v_dot2c_f32_bf16 v163, v41, v175
    v_dot2c_f32_bf16 v164, v42, v174
    v_dot2c_f32_bf16 v165, v42, v175
    v_dot2c_f32_bf16 v166, v43, v174
    v_dot2c_f32_bf16 v167, v43, v175
    v_dot2c_f32_bf16 v160, v44, v174
    v_dot2c_f32_bf16 v161, v44, v175
    v_dot2c_f32_bf16 v162, v45, v174
    v_dot2c_f32_bf16 v163, v45, v175
    v_dot2c_f32_bf16 v164, v46, v174
    v_dot2c_f32_bf16 v165, v46, v175
    v_dot2c_f32_bf16 v166, v47, v174
    v_dot2c_f32_bf16 v167, v47, v175
    v_permlane32_swap_b32 v160, v164
    v_permlane32_swap_b32 v161, v165
    v_permlane32_swap_b32 v162, v166
    v_permlane32_swap_b32 v163, v167
    v_lshlrev_b32 v12, 16, v120
    v_lshlrev_b32 v13, 16, v116
    v_lshlrev_b32 v14, 16, v112
    v_add_f32 v160, v160, v12
    v_fma_f32 v160, v160, v13, v14
    v_and_b32 v12, 0xffff0000, v120
    v_and_b32 v13, 0xffff0000, v116
    v_and_b32 v14, 0xffff0000, v112
    v_add_f32 v161, v161, v12
    v_fma_f32 v161, v161, v13, v14
    v_lshlrev_b32 v12, 16, v121
    v_lshlrev_b32 v13, 16, v117
    v_lshlrev_b32 v14, 16, v113
    v_add_f32 v162, v162, v12
    v_fma_f32 v162, v162, v13, v14
    v_and_b32 v12, 0xffff0000, v121
    v_and_b32 v13, 0xffff0000, v117
    v_and_b32 v14, 0xffff0000, v113
    v_add_f32 v163, v163, v12
    v_fma_f32 v163, v163, v13, v14
    v_lshlrev_b32 v12, 16, v122
    v_lshlrev_b32 v13, 16, v118
    v_lshlrev_b32 v14, 16, v114
    v_add_f32 v164, v164, v12
    v_fma_f32 v164, v164, v13, v14
    v_and_b32 v12, 0xffff0000, v122
    v_and_b32 v13, 0xffff0000, v118
    v_and_b32 v14, 0xffff0000, v114
    v_add_f32 v165, v165, v12
    v_fma_f32 v165, v165, v13, v14
    v_lshlrev_b32 v12, 16, v123
    v_lshlrev_b32 v13, 16, v119
    v_lshlrev_b32 v14, 16, v115
    v_add_f32 v166, v166, v12
    v_fma_f32 v166, v166, v13, v14
    v_and_b32 v12, 0xffff0000, v123
    v_and_b32 v13, 0xffff0000, v119
    v_and_b32 v14, 0xffff0000, v115
    v_add_f32 v167, v167, v12
    v_fma_f32 v167, v167, v13, v14
    v_cvt_pk_bf16_f32 v168, v160, v161
    v_cvt_pk_bf16_f32 v169, v162, v163
    v_cvt_pk_bf16_f32 v170, v164, v165
    v_cvt_pk_bf16_f32 v171, v166, v167
    buffer_store_dwordx4 v[168:171], v7, s[36:39], 0 offen
    s_waitcnt vmcnt(1)
    v_lshlrev_b32 v160, 16, v48
    v_and_b32 v161, 0xffff0000, v48
    v_lshlrev_b32 v162, 16, v49
    v_and_b32 v163, 0xffff0000, v49
    v_lshlrev_b32 v164, 16, v50
    v_and_b32 v165, 0xffff0000, v50
    v_lshlrev_b32 v166, 16, v51
    v_and_b32 v167, 0xffff0000, v51
    v_dot2c_f32_bf16 v160, v52, v174
    v_dot2c_f32_bf16 v161, v52, v175
    v_dot2c_f32_bf16 v162, v53, v174
    v_dot2c_f32_bf16 v163, v53, v175
    v_dot2c_f32_bf16 v164, v54, v174
    v_dot2c_f32_bf16 v165, v54, v175
    v_dot2c_f32_bf16 v166, v55, v174
    v_dot2c_f32_bf16 v167, v55, v175
    v_dot2c_f32_bf16 v160, v56, v174
    v_dot2c_f32_bf16 v161, v56, v175
    v_dot2c_f32_bf16 v162, v57, v174
    v_dot2c_f32_bf16 v163, v57, v175
    v_dot2c_f32_bf16 v164, v58, v174
    v_dot2c_f32_bf16 v165, v58, v175
    v_dot2c_f32_bf16 v166, v59, v174
    v_dot2c_f32_bf16 v167, v59, v175
    v_dot2c_f32_bf16 v160, v60, v174
    v_dot2c_f32_bf16 v161, v60, v175
    v_dot2c_f32_bf16 v162, v61, v174
    v_dot2c_f32_bf16 v163, v61, v175
    v_dot2c_f32_bf16 v164, v62, v174
    v_dot2c_f32_bf16 v165, v62, v175
    v_dot2c_f32_bf16 v166, v63, v174
    v_dot2c_f32_bf16 v167, v63, v175
    v_dot2c_f32_bf16 v160, v64, v174
    v_dot2c_f32_bf16 v161, v64, v175
    v_dot2c_f32_bf16 v162, v65, v174
    v_dot2c_f32_bf16 v163, v65, v175
    v_dot2c_f32_bf16 v164, v66, v174
    v_dot2c_f32_bf16 v165, v66, v175
    v_dot2c_f32_bf16 v166, v67, v174
    v_dot2c_f32_bf16 v167, v67, v175
    v_dot2c_f32_bf16 v160, v68, v174
    v_dot2c_f32_bf16 v161, v68, v175
    v_dot2c_f32_bf16 v162, v69, v174
    v_dot2c_f32_bf16 v163, v69, v175
    v_dot2c_f32_bf16 v164, v70, v174
    v_dot2c_f32_bf16 v165, v70, v175
    v_dot2c_f32_bf16 v166, v71, v174
    v_dot2c_f32_bf16 v167, v71, v175
    v_dot2c_f32_bf16 v160, v72, v174
    v_dot2c_f32_bf16 v161, v72, v175
    v_dot2c_f32_bf16 v162, v73, v174
    v_dot2c_f32_bf16 v163, v73, v175
    v_dot2c_f32_bf16 v164, v74, v174
    v_dot2c_f32_bf16 v165, v74, v175
    v_dot2c_f32_bf16 v166, v75, v174
    v_dot2c_f32_bf16 v167, v75, v175
    v_dot2c_f32_bf16 v160, v76, v174
    v_dot2c_f32_bf16 v161, v76, v175
    v_dot2c_f32_bf16 v162, v77, v174
    v_dot2c_f32_bf16 v163, v77, v175
    v_dot2c_f32_bf16 v164, v78, v174
    v_dot2c_f32_bf16 v165, v78, v175
    v_dot2c_f32_bf16 v166, v79, v174
    v_dot2c_f32_bf16 v167, v79, v175
    v_permlane32_swap_b32 v160, v164
    v_permlane32_swap_b32 v161, v165
    v_permlane32_swap_b32 v162, v166
    v_permlane32_swap_b32 v163, v167
    v_lshlrev_b32 v12, 16, v132
    v_lshlrev_b32 v13, 16, v128
    v_lshlrev_b32 v14, 16, v124
    v_add_f32 v160, v160, v12
    v_fma_f32 v160, v160, v13, v14
    v_and_b32 v12, 0xffff0000, v132
    v_and_b32 v13, 0xffff0000, v128
    v_and_b32 v14, 0xffff0000, v124
    v_add_f32 v161, v161, v12
    v_fma_f32 v161, v161, v13, v14
    v_lshlrev_b32 v12, 16, v133
    v_lshlrev_b32 v13, 16, v129
    v_lshlrev_b32 v14, 16, v125
    v_add_f32 v162, v162, v12
    v_fma_f32 v162, v162, v13, v14
    v_and_b32 v12, 0xffff0000, v133
    v_and_b32 v13, 0xffff0000, v129
    v_and_b32 v14, 0xffff0000, v125
    v_add_f32 v163, v163, v12
    v_fma_f32 v163, v163, v13, v14
    v_lshlrev_b32 v12, 16, v134
    v_lshlrev_b32 v13, 16, v130
    v_lshlrev_b32 v14, 16, v126
    v_add_f32 v164, v164, v12
    v_fma_f32 v164, v164, v13, v14
    v_and_b32 v12, 0xffff0000, v134
    v_and_b32 v13, 0xffff0000, v130
    v_and_b32 v14, 0xffff0000, v126
    v_add_f32 v165, v165, v12
    v_fma_f32 v165, v165, v13, v14
    v_lshlrev_b32 v12, 16, v135
    v_lshlrev_b32 v13, 16, v131
    v_lshlrev_b32 v14, 16, v127
    v_add_f32 v166, v166, v12
    v_fma_f32 v166, v166, v13, v14
    v_and_b32 v12, 0xffff0000, v135
    v_and_b32 v13, 0xffff0000, v131
    v_and_b32 v14, 0xffff0000, v127
    v_add_f32 v167, v167, v12
    v_fma_f32 v167, v167, v13, v14
    v_cvt_pk_bf16_f32 v168, v160, v161
    v_cvt_pk_bf16_f32 v169, v162, v163
    v_cvt_pk_bf16_f32 v170, v164, v165
    v_cvt_pk_bf16_f32 v171, v166, v167
    buffer_store_dwordx4 v[168:171], v9, s[36:39], 0 offen
K4_RDONE:
K4_END:
    s_endpgm
.fill 17, 4, 0xbf800000
.section .rodata,"a"
.p2align 6
.amdhsa_kernel k1_prep_kernel
  .amdhsa_next_free_vgpr 72
  .amdhsa_next_free_sgpr 80
  .amdhsa_accum_offset 72
  .amdhsa_group_segment_fixed_size 0
  .amdhsa_kernarg_size 136
  .amdhsa_user_sgpr_count 2
  .amdhsa_user_sgpr_kernarg_segment_ptr 1
  .amdhsa_system_sgpr_workgroup_id_x 1
.end_amdhsa_kernel
.p2align 6
.amdhsa_kernel k2_conv_kernel
  .amdhsa_next_free_vgpr 216
  .amdhsa_next_free_sgpr 64
  .amdhsa_accum_offset 216
  .amdhsa_group_segment_fixed_size 0
  .amdhsa_kernarg_size 136
  .amdhsa_user_sgpr_count 2
  .amdhsa_user_sgpr_kernarg_segment_ptr 1
  .amdhsa_system_sgpr_workgroup_id_x 1
.end_amdhsa_kernel
.p2align 6
.amdhsa_kernel k4_mlp_kernel
  .amdhsa_next_free_vgpr 512
  .amdhsa_next_free_sgpr 80
  .amdhsa_accum_offset 256
  .amdhsa_group_segment_fixed_size 0
  .amdhsa_kernarg_size 136
  .amdhsa_user_sgpr_count 2
  .amdhsa_user_sgpr_kernarg_segment_ptr 1
  .amdhsa_system_sgpr_workgroup_id_x 1
.end_amdhsa_kernel
```
